```python
import torch

def _softmax(x, axis=-1):
    return torch.softmax(x, dim=axis)
def _gelu(x):
    return torch.nn.functional.gelu(x, approximate="tanh")
def _silu(x):
    return torch.nn.functional.silu(x)
def _sigmoid(x):
    return torch.sigmoid(x)
def _layernorm(x, axis=-1, eps=1e-5):
    m = x.mean(dim=axis, keepdim=True)
    v = x.var(dim=axis, keepdim=True, unbiased=False)
    return (x - m) / torch.sqrt(v + eps)
def _scatter_add(tgt, idx, src, axis=0):
    return tgt.clone().index_add_(axis, idx, src)
def _segment_sum(src, seg, n):
    out = torch.zeros((n,) + src.shape[1:], dtype=src.dtype)
    return out.index_add_(0, seg, src)
def _pad(x, pw):
    flat = tuple(v for pair in reversed(pw) for v in pair)
    return torch.nn.functional.pad(x, flat)

kernel_name = 'parallel_sum__spectral_gfnet__mixer_token_mlp__prompt'

def setup_inputs():

    _w = (lambda a: (lambda t: t.to(torch.bfloat16) if t.is_floating_point() else t)(torch.as_tensor(a)))
    def _A_setup():
        B, S, D = 1, 2048, 1024
        Df = D // 2 + 1
        return {
            "x": _w((lambda *s: torch.randn(*s, dtype=torch.bfloat16) * 0.05)(B, S, D)),
            "w_r": _w((lambda *s: torch.randn(*s, dtype=torch.bfloat16) * 1.6)(S, Df) * 0.02),
            "w_i": _w((lambda *s: torch.randn(*s, dtype=torch.bfloat16) * 1.6)(S, Df) * 0.02),
        }
    _A_in = _A_setup()

    def _B_setup():
        B, S, D, F = 1, 2048, 1024, 3584
        return {
            "x": _w((lambda *s: torch.randn(*s, dtype=torch.bfloat16) * 0.05)(B, S, D)),
            "w1": _w((lambda *s: torch.randn(*s, dtype=torch.bfloat16) * 0.4)(S, F) * (S ** -0.5)),
            "b1": _w((lambda *s: torch.randn(*s, dtype=torch.bfloat16) * 3.2)(F) * 0.02),
            "w2": _w((lambda *s: torch.randn(*s, dtype=torch.bfloat16) * 0.8)(F, S) * (F ** -0.5)),
            "b2": _w((lambda *s: torch.randn(*s, dtype=torch.bfloat16) * 3.2)(S) * 0.02),
        }
    _B_in = _B_setup()

    return {
        "A_x": _A_in["x"],
        "A_w_r": _A_in["w_r"],
        "A_w_i": _A_in["w_i"],
        "B_x": _B_in["x"],
        "B_w1": _B_in["w1"],
        "B_b1": _B_in["b1"],
        "B_w2": _B_in["w2"],
        "B_b2": _B_in["b2"],
    }

def reference(A_x, A_w_r, A_w_i, B_x, B_w1, B_b1, B_w2, B_b2):
    def _A_ref(x, w_r, w_i):
        B, S, D = x.shape
        X = (lambda x, axes=(-2,-1): torch.fft.rfft2(x.float(), dim=axes))(x, axes=(-2, -1))
        W = w_r + 1j * w_i
        X = X * W
        y = (lambda x, s, axes=(-2,-1): torch.fft.irfft2(x, s=s, dim=axes).to(torch.bfloat16))(X, (S, D), axes=(-2, -1))
        return y

    def _B_ref(x, w1, b1, w2, b2):
        B, S, D = x.shape
        h = _layernorm(x, axis=-1)
        u = torch.einsum("bsd,sf->bdf", h, w1) + b1
        u = _gelu(u)
        y = torch.einsum("bdf,fs->bds", u, w2) + b2
        return (lambda x, *d: x.permute(*d))(y, 0, 2, 1)

    x = A_x
    xn = _layernorm(x, axis=-1)
    return x + _A_ref(xn, A_w_r, A_w_i) + _B_ref(xn, B_w1, B_b1, B_w2, B_b2)
```

```asm
; @launch grid=(256,1,1) block=(512,1,1) lds=163840
.amdgcn_target "amdgcn-amd-amdhsa--gfx950"
.text
.globl parallel_sum__spectral_gfnet__mixer_token_mlp__prompt_kernel
.p2align 8
.type parallel_sum__spectral_gfnet__mixer_token_mlp__prompt_kernel,@function
parallel_sum__spectral_gfnet__mixer_token_mlp__prompt_kernel:
    s_cmp_ge_u32 s2, 256
    s_cbranch_scc1 END
    s_load_dwordx4 s[4:7], s[0:1], 0
    s_load_dwordx2 s[8:9], s[0:1], 16
    s_load_dwordx2 s[10:11], s[0:1], 80
    s_load_dwordx4 s[44:47], s[0:1], 32
    v_lshrrev_b32 v2, 6, v0
    v_and_b32 v1, 63, v0
    v_readfirstlane_b32 s12, v2
    v_lshlrev_b32 v2, 4, v1
    v_lshrrev_b32 v3, 4, v1
    v_bfe_u32 v4, v1, 2, 2
    v_and_b32 v5, 3, v1
    s_and_b32 s54, s2, 7
    s_lshr_b32 s55, s2, 5
    s_bfe_u32 s56, s2, 0x20003
    s_lshr_b32 s13, s54, 1
    s_mul_i32 s58, s13, 7
    s_add_u32 s58, s58, s55
    s_and_b32 s13, s54, 1
    s_lshl_b32 s57, s13, 2
    s_add_u32 s57, s57, s56
    s_add_u32 s59, s55, s56
    s_and_b32 s59, s59, 3
    s_lshl_b32 s13, s13, 2
    s_add_u32 s59, s59, s13
    s_cmp_ge_u32 s12, 4
    s_cbranch_scc1 L_entry
    s_lshr_b32 s13, s2, 5
    s_lshl_b32 s13, s13, 19
    s_lshl_b32 s14, s12, 17
    s_add_u32 s13, s13, s14
    s_and_b32 s14, s2, 31
    s_lshl_b32 s14, s14, 12
    s_add_u32 s13, s13, s14
    s_waitcnt lgkmcnt(0)
    s_mov_b32 s24, s4
    s_and_b32 s25, s5, 0xffff
    s_mov_b32 s26, 0x400000
    s_mov_b32 s27, 0x20000
    buffer_load_dwordx4 v[64:67], v2, s[24:27], s13 offen offset:0 nt
    buffer_load_dwordx4 v[68:71], v2, s[24:27], s13 offen offset:1024 nt
    buffer_load_dwordx4 v[72:75], v2, s[24:27], s13 offen offset:2048 nt
    buffer_load_dwordx4 v[76:79], v2, s[24:27], s13 offen offset:3072 nt
    s_mov_b32 s28, s10
    s_and_b32 s29, s11, 0xffff
    s_mov_b32 s30, 0x3200000
    s_mov_b32 s31, 0x20000
    s_add_u32 s10, s10, 0x3000040
    s_addc_u32 s11, s11, 0
    s_load_dword s3, s[10:11], 0
    s_mul_i32 s14, s12, 4224
    s_add_u32 s14, s14, 81920
    v_add_u32 v6, s14, v2
    v_lshrrev_b32 v16, 1, v3
    v_lshl_add_u32 v16, v16, 3, v4
    v_lshlrev_b32 v16, 6, v16
    v_and_b32 v17, 1, v3
    v_lshl_add_u32 v16, v17, 5, v16
    v_lshl_add_u32 v16, v5, 3, v16
    v_add_u32 v7, s14, v16
    s_mul_i32 s14, s12, 4160
    s_add_u32 s14, s14, 98816
    v_lshlrev_b32 v16, 3, v1
    v_add_u32 v8, s14, v16
    v_add_u32 v16, 65536, v2
    v_mul_u32_u24 v9, 2112, v4
    v_lshl_add_u32 v9, v3, 5, v9
    v_lshl_add_u32 v9, v5, 3, v9
    s_lshl_b32 s14, s12, 8
    s_add_u32 s14, s14, 81920
    v_add_u32 v9, s14, v9
    v_mul_u32_u24 v10, 4160, v4
    v_and_b32 v18, 1, v5
    v_mul_u32_u24 v18, 2080, v18
    v_lshl_add_u32 v10, v3, 4, v10
    v_lshrrev_b32 v19, 1, v5
    v_lshl_add_u32 v18, v19, 3, v18
    s_lshl_b32 s14, s12, 7
    s_add_u32 s14, s14, 98816
    v_add3_u32 v10, v10, v18, s14
    s_bfe_u32 s14, s2, 0x30001
    v_and_b32 v18, 7, v1
    v_xor_b32 v18, s14, v18
    v_lshlrev_b32 v18, 4, v18
    v_lshrrev_b32 v11, 3, v1
    v_mul_u32_u24 v11, 0x8000, v11
    v_add_u32 v11, v11, v18
    s_mul_i32 s14, s12, 0x80000
    s_lshl_b32 s48, s2, 7
    s_add_u32 s48, s48, s14
    s_lshl_b32 s14, s12, 19
    s_add_u32 s48, s48, 0x2000000
    s_lshl_b32 s49, s2, 11
    s_add_u32 s49, s49, s14
    v_mov_b32 v12, 155648
    v_mov_b32 v13, 1
    s_barrier
    ds_read_b128 v[96:99], v16 offset:0
    ds_read_b128 v[100:103], v16 offset:1024
    ds_read_b128 v[104:107], v16 offset:2048
    ds_read_b128 v[108:111], v16 offset:3072
    ds_read_b128 v[112:115], v16 offset:4096
    ds_read_b128 v[116:119], v16 offset:5120
    ds_read_b128 v[120:123], v16 offset:6144
    ds_read_b128 v[124:127], v16 offset:7168
    ds_read_b128 v[128:131], v16 offset:8192
    ds_read_b128 v[132:135], v16 offset:9216
    ds_read_b128 v[136:139], v16 offset:10240
    ds_read_b128 v[140:143], v16 offset:11264
    ds_read_b128 v[144:147], v16 offset:12288
    ds_read_b128 v[148:151], v16 offset:13312
    ds_read_b128 v[152:155], v16 offset:14336
    ds_read_b128 v[156:159], v16 offset:15360
    s_waitcnt vmcnt(2)
    v_lshlrev_b32 v32, 16, v64
    v_and_b32 v33, 0xffff0000, v64
    v_lshlrev_b32 v34, 16, v65
    v_and_b32 v35, 0xffff0000, v65
    v_lshlrev_b32 v36, 16, v66
    v_and_b32 v37, 0xffff0000, v66
    v_lshlrev_b32 v38, 16, v67
    v_and_b32 v39, 0xffff0000, v67
    v_lshlrev_b32 v40, 16, v68
    v_and_b32 v41, 0xffff0000, v68
    v_lshlrev_b32 v42, 16, v69
    v_and_b32 v43, 0xffff0000, v69
    v_lshlrev_b32 v44, 16, v70
    v_and_b32 v45, 0xffff0000, v70
    v_lshlrev_b32 v46, 16, v71
    v_and_b32 v47, 0xffff0000, v71
    v_pk_add_f32 v[18:19], v[32:33], v[34:35]
    v_pk_mul_f32 v[20:21], v[32:33], v[32:33]
    v_pk_fma_f32 v[20:21], v[34:35], v[34:35], v[20:21]
    v_pk_add_f32 v[18:19], v[18:19], v[36:37]
    v_pk_fma_f32 v[20:21], v[36:37], v[36:37], v[20:21]
    v_pk_add_f32 v[18:19], v[18:19], v[38:39]
    v_pk_fma_f32 v[20:21], v[38:39], v[38:39], v[20:21]
    v_pk_add_f32 v[18:19], v[18:19], v[40:41]
    v_pk_fma_f32 v[20:21], v[40:41], v[40:41], v[20:21]
    v_pk_add_f32 v[18:19], v[18:19], v[42:43]
    v_pk_fma_f32 v[20:21], v[42:43], v[42:43], v[20:21]
    v_pk_add_f32 v[18:19], v[18:19], v[44:45]
    v_pk_fma_f32 v[20:21], v[44:45], v[44:45], v[20:21]
    v_pk_add_f32 v[18:19], v[18:19], v[46:47]
    v_pk_fma_f32 v[20:21], v[46:47], v[46:47], v[20:21]
    s_waitcnt vmcnt(0)
    v_lshlrev_b32 v48, 16, v72
    v_and_b32 v49, 0xffff0000, v72
    v_lshlrev_b32 v50, 16, v73
    v_and_b32 v51, 0xffff0000, v73
    v_lshlrev_b32 v52, 16, v74
    v_and_b32 v53, 0xffff0000, v74
    v_lshlrev_b32 v54, 16, v75
    v_and_b32 v55, 0xffff0000, v75
    v_lshlrev_b32 v56, 16, v76
    v_and_b32 v57, 0xffff0000, v76
    v_lshlrev_b32 v58, 16, v77
    v_and_b32 v59, 0xffff0000, v77
    v_lshlrev_b32 v60, 16, v78
    v_and_b32 v61, 0xffff0000, v78
    v_lshlrev_b32 v62, 16, v79
    v_and_b32 v63, 0xffff0000, v79
    v_pk_add_f32 v[22:23], v[48:49], v[50:51]
    v_pk_mul_f32 v[24:25], v[48:49], v[48:49]
    v_pk_fma_f32 v[24:25], v[50:51], v[50:51], v[24:25]
    v_pk_add_f32 v[22:23], v[22:23], v[52:53]
    v_pk_fma_f32 v[24:25], v[52:53], v[52:53], v[24:25]
    v_pk_add_f32 v[22:23], v[22:23], v[54:55]
    v_pk_fma_f32 v[24:25], v[54:55], v[54:55], v[24:25]
    v_pk_add_f32 v[22:23], v[22:23], v[56:57]
    v_pk_fma_f32 v[24:25], v[56:57], v[56:57], v[24:25]
    v_pk_add_f32 v[22:23], v[22:23], v[58:59]
    v_pk_fma_f32 v[24:25], v[58:59], v[58:59], v[24:25]
    v_pk_add_f32 v[22:23], v[22:23], v[60:61]
    v_pk_fma_f32 v[24:25], v[60:61], v[60:61], v[24:25]
    v_pk_add_f32 v[22:23], v[22:23], v[62:63]
    v_pk_fma_f32 v[24:25], v[62:63], v[62:63], v[24:25]
    v_sub_f32 v26, v18, v19
    v_sub_f32 v27, v22, v23
    v_add_f32 v18, v18, v19
    v_add_f32 v22, v22, v23
    v_add_f32 v20, v20, v21
    v_add_f32 v24, v24, v25
    v_permlane32_swap_b32 v26, v27
    v_permlane32_swap_b32 v18, v22
    v_permlane32_swap_b32 v20, v24
    v_add_f32 v26, v26, v27
    v_add_f32 v18, v18, v22
    v_add_f32 v20, v20, v24
    s_nop 1
    v_permlane16_swap_b32 v18, v20
    v_add_f32_dpp v26, v26, v26 quad_perm:[1,0,3,2] row_mask:0xf bank_mask:0xf
    v_add_f32 v18, v18, v20
    s_nop 0
    v_add_f32_dpp v26, v26, v26 quad_perm:[2,3,0,1] row_mask:0xf bank_mask:0xf
    v_add_f32_dpp v18, v18, v18 quad_perm:[1,0,3,2] row_mask:0xf bank_mask:0xf
    s_nop 0
    v_add_f32_dpp v26, v26, v26 row_half_mirror row_mask:0xf bank_mask:0xf
    v_add_f32_dpp v18, v18, v18 quad_perm:[2,3,0,1] row_mask:0xf bank_mask:0xf
    s_nop 0
    v_add_f32_dpp v26, v26, v26 row_mirror row_mask:0xf bank_mask:0xf
    v_add_f32_dpp v18, v18, v18 row_half_mirror row_mask:0xf bank_mask:0xf
    s_nop 0
    v_add_f32_dpp v26, v26, v26 row_bcast:15 row_mask:0xa bank_mask:0xf
    v_add_f32_dpp v18, v18, v18 row_mirror row_mask:0xf bank_mask:0xf
    s_nop 0
    v_readlane_b32 s16, v18, 0
    v_readlane_b32 s17, v18, 16
    v_readlane_b32 s18, v18, 32
    v_readlane_b32 s19, v18, 48
    v_readlane_b32 s20, v26, 31
    v_readlane_b32 s21, v26, 63
    v_mov_b32 v19, 0x3a800000
    v_mul_f32 v23, s16, v19
    v_mul_f32 v21, s17, v19
    v_mov_b32 v25, 0x3a800000
    v_mul_f32 v29, s18, v25
    v_mul_f32 v27, s19, v25
    v_fma_f32 v21, -v23, v23, v21
    v_fma_f32 v27, -v29, v29, v27
    v_max_f32 v21, 0, v21
    v_max_f32 v27, 0, v27
    v_add_f32 v18, 0x3727c5ac, v21
    v_add_f32 v24, 0x3727c5ac, v27
    v_rsq_f32 v18, v18
    v_rsq_f32 v24, v24
    v_mul_f32 v21, v21, v18
    v_mul_f32 v20, -v23, v18
    v_mul_f32 v27, v27, v24
    v_mul_f32 v26, -v29, v24
    v_fmaak_f32 v21, v21, v18, 0x3727c5ac
    v_mul_f32 v19, s20, v18
    v_fmaak_f32 v27, v27, v24, 0x3727c5ac
    v_mul_f32 v25, s21, v24
    v_rsq_f32 v22, v21
    v_rsq_f32 v28, v27
    v_pk_fma_f32 v[32:33], v[32:33], v[18:19], v[20:21] op_sel_hi:[1,0,0]
    v_pk_fma_f32 v[34:35], v[34:35], v[18:19], v[20:21] op_sel_hi:[1,0,0]
    v_pk_fma_f32 v[36:37], v[36:37], v[18:19], v[20:21] op_sel_hi:[1,0,0]
    v_pk_fma_f32 v[38:39], v[38:39], v[18:19], v[20:21] op_sel_hi:[1,0,0]
    v_pk_fma_f32 v[40:41], v[40:41], v[18:19], v[20:21] op_sel_hi:[1,0,0]
    v_pk_fma_f32 v[42:43], v[42:43], v[18:19], v[20:21] op_sel_hi:[1,0,0]
    v_pk_fma_f32 v[44:45], v[44:45], v[18:19], v[20:21] op_sel_hi:[1,0,0]
    v_pk_fma_f32 v[46:47], v[46:47], v[18:19], v[20:21] op_sel_hi:[1,0,0]
    v_cvt_pk_bf16_f32 v80, v32, v33
    v_cvt_pk_bf16_f32 v81, v34, v35
    v_cvt_pk_bf16_f32 v82, v36, v37
    v_cvt_pk_bf16_f32 v83, v38, v39
    v_cvt_pk_bf16_f32 v84, v40, v41
    v_cvt_pk_bf16_f32 v85, v42, v43
    v_cvt_pk_bf16_f32 v86, v44, v45
    v_cvt_pk_bf16_f32 v87, v46, v47
    ds_write_b128 v6, v[80:83] offset:0
    ds_write_b128 v6, v[84:87] offset:1024
    ds_read_b64_tr_b16 v[64:65], v7 offset:0
    ds_read_b64_tr_b16 v[66:67], v7 offset:256
    ds_read_b64_tr_b16 v[68:69], v7 offset:1024
    ds_read_b64_tr_b16 v[70:71], v7 offset:1280
    v_pk_fma_f32 v[48:49], v[48:49], v[24:25], v[26:27] op_sel_hi:[1,0,0]
    v_pk_fma_f32 v[50:51], v[50:51], v[24:25], v[26:27] op_sel_hi:[1,0,0]
    v_pk_fma_f32 v[52:53], v[52:53], v[24:25], v[26:27] op_sel_hi:[1,0,0]
    v_pk_fma_f32 v[54:55], v[54:55], v[24:25], v[26:27] op_sel_hi:[1,0,0]
    v_pk_fma_f32 v[56:57], v[56:57], v[24:25], v[26:27] op_sel_hi:[1,0,0]
    v_pk_fma_f32 v[58:59], v[58:59], v[24:25], v[26:27] op_sel_hi:[1,0,0]
    v_pk_fma_f32 v[60:61], v[60:61], v[24:25], v[26:27] op_sel_hi:[1,0,0]
    v_pk_fma_f32 v[62:63], v[62:63], v[24:25], v[26:27] op_sel_hi:[1,0,0]
    v_cvt_pk_bf16_f32 v88, v48, v49
    v_cvt_pk_bf16_f32 v89, v50, v51
    v_cvt_pk_bf16_f32 v90, v52, v53
    v_cvt_pk_bf16_f32 v91, v54, v55
    v_cvt_pk_bf16_f32 v92, v56, v57
    v_cvt_pk_bf16_f32 v93, v58, v59
    v_cvt_pk_bf16_f32 v94, v60, v61
    v_cvt_pk_bf16_f32 v95, v62, v63
    ds_write_b128 v6, v[88:91] offset:2112
    ds_write_b128 v6, v[92:95] offset:3136
    ds_read_b64_tr_b16 v[72:73], v7 offset:2112
    ds_read_b64_tr_b16 v[74:75], v7 offset:2368
    ds_read_b64_tr_b16 v[76:77], v7 offset:3136
    ds_read_b64_tr_b16 v[78:79], v7 offset:3392
    s_waitcnt lgkmcnt(6)
    v_mfma_f32_32x32x16_bf16 v[160:175], v[64:67], v[96:99], 0
    v_mul_f32 v32, v32, v22
    v_mul_f32 v33, v33, v22
    v_mul_f32 v34, v34, v22
    v_mul_f32 v35, v35, v22
    v_mul_f32 v36, v36, v22
    v_mul_f32 v37, v37, v22
    v_mfma_f32_32x32x16_bf16 v[176:191], v[64:67], v[104:107], 0
    v_mul_f32 v38, v38, v22
    v_mul_f32 v39, v39, v22
    v_mul_f32 v40, v40, v22
    v_mul_f32 v41, v41, v22
    v_mul_f32 v42, v42, v22
    v_mul_f32 v43, v43, v22
    v_mul_f32 v44, v44, v22
    v_mfma_f32_32x32x16_bf16 v[160:175], v[68:71], v[100:103], v[160:175]
    v_mul_f32 v45, v45, v22
    v_mul_f32 v46, v46, v22
    v_mul_f32 v47, v47, v22
    v_cvt_pk_bf16_f32 v80, v32, v33
    v_cvt_pk_bf16_f32 v81, v34, v35
    v_cvt_pk_bf16_f32 v82, v36, v37
    v_mfma_f32_32x32x16_bf16 v[176:191], v[68:71], v[108:111], v[176:191]
    v_cvt_pk_bf16_f32 v83, v38, v39
    v_cvt_pk_bf16_f32 v84, v40, v41
    v_cvt_pk_bf16_f32 v85, v42, v43
    v_cvt_pk_bf16_f32 v86, v44, v45
    v_cvt_pk_bf16_f32 v87, v46, v47
    ds_write_b128 v6, v[80:83] offset:0
    ds_write_b128 v6, v[84:87] offset:1024
    s_waitcnt lgkmcnt(2)
    v_mfma_f32_32x32x16_bf16 v[192:207], v[72:75], v[96:99], 0
    v_mul_f32 v48, v48, v28
    v_mul_f32 v49, v49, v28
    v_mul_f32 v50, v50, v28
    v_mul_f32 v51, v51, v28
    v_mul_f32 v52, v52, v28
    v_mul_f32 v53, v53, v28
    v_mfma_f32_32x32x16_bf16 v[208:223], v[72:75], v[104:107], 0
    v_mul_f32 v54, v54, v28
    v_mul_f32 v55, v55, v28
    v_mul_f32 v56, v56, v28
    v_mul_f32 v57, v57, v28
    v_mul_f32 v58, v58, v28
    v_mul_f32 v59, v59, v28
    v_mul_f32 v60, v60, v28
    v_mfma_f32_32x32x16_bf16 v[192:207], v[76:79], v[100:103], v[192:207]
    v_mul_f32 v61, v61, v28
    v_mul_f32 v62, v62, v28
    v_mul_f32 v63, v63, v28
    v_cvt_pk_bf16_f32 v88, v48, v49
    v_cvt_pk_bf16_f32 v89, v50, v51
    v_cvt_pk_bf16_f32 v90, v52, v53
    v_mfma_f32_32x32x16_bf16 v[208:223], v[76:79], v[108:111], v[208:223]
    v_cvt_pk_bf16_f32 v91, v54, v55
    v_cvt_pk_bf16_f32 v92, v56, v57
    v_cvt_pk_bf16_f32 v93, v58, v59
    v_cvt_pk_bf16_f32 v94, v60, v61
    v_cvt_pk_bf16_f32 v95, v62, v63
    ds_write_b128 v6, v[88:91] offset:2112
    ds_write_b128 v6, v[92:95] offset:3136
    v_cvt_pk_bf16_f32 v19, v19, v25
    s_lshl_b32 s14, s12, 1
    s_add_u32 s14, s14, 115456
    v_mov_b32 v18, s14
    v_mov_b32 v20, 0
    s_mov_b64 exec, 1
    ds_write_b16 v18, v19
    ds_write_b16_d16_hi v18, v19 offset:16
    ds_write_b16 v18, v20 offset:8
    ds_write_b16 v18, v20 offset:24
    s_mov_b64 exec, -1
    v_pk_mul_f32 v[32:33], v[160:161], v[128:129]
    v_pk_mul_f32 v[36:37], v[176:177], v[128:129]
    v_pk_mul_f32 v[34:35], v[162:163], v[130:131]
    v_pk_mul_f32 v[38:39], v[178:179], v[130:131]
    v_pk_fma_f32 v[32:33], v[176:177], v[144:145], v[32:33]
    v_pk_fma_f32 v[36:37], v[160:161], v[144:145], v[36:37] neg_lo:[1,0,0] neg_hi:[1,0,0]
    v_pk_fma_f32 v[34:35], v[178:179], v[146:147], v[34:35]
    v_pk_fma_f32 v[38:39], v[162:163], v[146:147], v[38:39] neg_lo:[1,0,0] neg_hi:[1,0,0]
    v_cvt_pk_bf16_f32 v224, v32, v33
    v_cvt_pk_bf16_f32 v225, v34, v35
    v_cvt_pk_bf16_f32 v226, v36, v37
    v_cvt_pk_bf16_f32 v227, v38, v39
    v_pk_mul_f32 v[32:33], v[164:165], v[132:133]
    v_pk_mul_f32 v[36:37], v[180:181], v[132:133]
    v_pk_mul_f32 v[34:35], v[166:167], v[134:135]
    v_pk_mul_f32 v[38:39], v[182:183], v[134:135]
    v_pk_fma_f32 v[32:33], v[180:181], v[148:149], v[32:33]
    v_pk_fma_f32 v[36:37], v[164:165], v[148:149], v[36:37] neg_lo:[1,0,0] neg_hi:[1,0,0]
    v_pk_fma_f32 v[34:35], v[182:183], v[150:151], v[34:35]
    v_pk_fma_f32 v[38:39], v[166:167], v[150:151], v[38:39] neg_lo:[1,0,0] neg_hi:[1,0,0]
    v_cvt_pk_bf16_f32 v228, v32, v33
    v_cvt_pk_bf16_f32 v229, v34, v35
    v_cvt_pk_bf16_f32 v230, v36, v37
    v_cvt_pk_bf16_f32 v231, v38, v39
    v_pk_mul_f32 v[32:33], v[168:169], v[136:137]
    v_pk_mul_f32 v[36:37], v[184:185], v[136:137]
    v_pk_mul_f32 v[34:35], v[170:171], v[138:139]
    v_pk_mul_f32 v[38:39], v[186:187], v[138:139]
    v_pk_fma_f32 v[32:33], v[184:185], v[152:153], v[32:33]
    v_pk_fma_f32 v[36:37], v[168:169], v[152:153], v[36:37] neg_lo:[1,0,0] neg_hi:[1,0,0]
    v_pk_fma_f32 v[34:35], v[186:187], v[154:155], v[34:35]
    v_pk_fma_f32 v[38:39], v[170:171], v[154:155], v[38:39] neg_lo:[1,0,0] neg_hi:[1,0,0]
    v_cvt_pk_bf16_f32 v232, v32, v33
    v_cvt_pk_bf16_f32 v233, v34, v35
    v_cvt_pk_bf16_f32 v234, v36, v37
    v_cvt_pk_bf16_f32 v235, v38, v39
    v_pk_mul_f32 v[32:33], v[172:173], v[140:141]
    v_pk_mul_f32 v[36:37], v[188:189], v[140:141]
    v_pk_mul_f32 v[34:35], v[174:175], v[142:143]
    v_pk_mul_f32 v[38:39], v[190:191], v[142:143]
    v_pk_fma_f32 v[32:33], v[188:189], v[156:157], v[32:33]
    v_pk_fma_f32 v[36:37], v[172:173], v[156:157], v[36:37] neg_lo:[1,0,0] neg_hi:[1,0,0]
    v_pk_fma_f32 v[34:35], v[190:191], v[158:159], v[34:35]
    v_pk_fma_f32 v[38:39], v[174:175], v[158:159], v[38:39] neg_lo:[1,0,0] neg_hi:[1,0,0]
    v_cvt_pk_bf16_f32 v236, v32, v33
    v_cvt_pk_bf16_f32 v237, v34, v35
    v_cvt_pk_bf16_f32 v238, v36, v37
    v_cvt_pk_bf16_f32 v239, v38, v39
    v_mfma_f32_32x32x16_bf16 v[160:175], v[112:115], v[224:227], 0
    v_mul_f32 v32, v192, v128
    v_mul_f32 v33, v193, v129
    v_mul_f32 v34, v194, v130
    v_mul_f32 v35, v195, v131
    v_mul_f32 v36, v208, v128
    v_mfma_f32_32x32x16_bf16 v[160:175], v[116:119], v[228:231], v[160:175]
    v_mul_f32 v37, v209, v129
    v_mul_f32 v38, v210, v130
    v_mul_f32 v39, v211, v131
    v_fmac_f32 v32, v208, v144
    v_fmac_f32 v33, v209, v145
    v_mfma_f32_32x32x16_bf16 v[160:175], v[120:123], v[232:235], v[160:175]
    v_fmac_f32 v34, v210, v146
    v_fmac_f32 v35, v211, v147
    v_fma_f32 v36, -v192, v144, v36
    v_fma_f32 v37, -v193, v145, v37
    v_fma_f32 v38, -v194, v146, v38
    v_mfma_f32_32x32x16_bf16 v[160:175], v[124:127], v[236:239], v[160:175]
    v_fma_f32 v39, -v195, v147, v39
    v_cvt_pk_bf16_f32 v240, v32, v33
    v_cvt_pk_bf16_f32 v241, v34, v35
    v_cvt_pk_bf16_f32 v242, v36, v37
    v_cvt_pk_bf16_f32 v243, v38, v39
    v_pk_mul_f32 v[32:33], v[196:197], v[132:133]
    v_pk_mul_f32 v[36:37], v[212:213], v[132:133]
    v_pk_mul_f32 v[34:35], v[198:199], v[134:135]
    v_pk_mul_f32 v[38:39], v[214:215], v[134:135]
    v_pk_fma_f32 v[32:33], v[212:213], v[148:149], v[32:33]
    v_pk_fma_f32 v[36:37], v[196:197], v[148:149], v[36:37] neg_lo:[1,0,0] neg_hi:[1,0,0]
    v_pk_fma_f32 v[34:35], v[214:215], v[150:151], v[34:35]
    v_pk_fma_f32 v[38:39], v[198:199], v[150:151], v[38:39] neg_lo:[1,0,0] neg_hi:[1,0,0]
    v_cvt_pk_bf16_f32 v244, v32, v33
    v_cvt_pk_bf16_f32 v245, v34, v35
    v_cvt_pk_bf16_f32 v246, v36, v37
    v_cvt_pk_bf16_f32 v247, v38, v39
    v_pk_mul_f32 v[32:33], v[200:201], v[136:137]
    v_pk_mul_f32 v[36:37], v[216:217], v[136:137]
    v_pk_mul_f32 v[34:35], v[202:203], v[138:139]
    v_pk_mul_f32 v[38:39], v[218:219], v[138:139]
    v_pk_fma_f32 v[32:33], v[216:217], v[152:153], v[32:33]
    v_pk_fma_f32 v[36:37], v[200:201], v[152:153], v[36:37] neg_lo:[1,0,0] neg_hi:[1,0,0]
    v_pk_fma_f32 v[34:35], v[218:219], v[154:155], v[34:35]
    v_pk_fma_f32 v[38:39], v[202:203], v[154:155], v[38:39] neg_lo:[1,0,0] neg_hi:[1,0,0]
    v_cvt_pk_bf16_f32 v248, v32, v33
    v_cvt_pk_bf16_f32 v249, v34, v35
    v_cvt_pk_bf16_f32 v250, v36, v37
    v_cvt_pk_bf16_f32 v251, v38, v39
    v_pk_mul_f32 v[32:33], v[204:205], v[140:141]
    v_pk_mul_f32 v[36:37], v[220:221], v[140:141]
    v_pk_mul_f32 v[34:35], v[206:207], v[142:143]
    v_pk_mul_f32 v[38:39], v[222:223], v[142:143]
    v_pk_fma_f32 v[32:33], v[220:221], v[156:157], v[32:33]
    v_pk_fma_f32 v[36:37], v[204:205], v[156:157], v[36:37] neg_lo:[1,0,0] neg_hi:[1,0,0]
    v_pk_fma_f32 v[34:35], v[222:223], v[158:159], v[34:35]
    v_pk_fma_f32 v[38:39], v[206:207], v[158:159], v[38:39] neg_lo:[1,0,0] neg_hi:[1,0,0]
    v_cvt_pk_bf16_f32 v252, v32, v33
    v_cvt_pk_bf16_f32 v253, v34, v35
    v_cvt_pk_bf16_f32 v254, v36, v37
    v_cvt_pk_bf16_f32 v255, v38, v39
    v_mfma_f32_32x32x16_bf16 v[192:207], v[112:115], v[240:243], 0
    v_cvt_pk_bf16_f32 v80, v160, v161
    v_cvt_pk_bf16_f32 v81, v162, v163
    ds_write_b64 v8, v[80:81] offset:0
    v_mfma_f32_32x32x16_bf16 v[192:207], v[116:119], v[244:247], v[192:207]
    v_cvt_pk_bf16_f32 v82, v164, v165
    v_cvt_pk_bf16_f32 v83, v166, v167
    ds_write_b64 v8, v[82:83] offset:512
    v_mfma_f32_32x32x16_bf16 v[192:207], v[120:123], v[248:251], v[192:207]
    v_cvt_pk_bf16_f32 v84, v168, v169
    v_cvt_pk_bf16_f32 v85, v170, v171
    ds_write_b64 v8, v[84:85] offset:1024
    v_mfma_f32_32x32x16_bf16 v[192:207], v[124:127], v[252:255], v[192:207]
    v_cvt_pk_bf16_f32 v86, v172, v173
    v_cvt_pk_bf16_f32 v87, v174, v175
    ds_write_b64 v8, v[86:87] offset:1536
    s_nop 8
    v_cvt_pk_bf16_f32 v88, v192, v193
    v_cvt_pk_bf16_f32 v89, v194, v195
    ds_write_b64 v8, v[88:89] offset:2080
    v_cvt_pk_bf16_f32 v90, v196, v197
    v_cvt_pk_bf16_f32 v91, v198, v199
    ds_write_b64 v8, v[90:91] offset:2592
    v_cvt_pk_bf16_f32 v92, v200, v201
    v_cvt_pk_bf16_f32 v93, v202, v203
    ds_write_b64 v8, v[92:93] offset:3104
    v_cvt_pk_bf16_f32 v94, v204, v205
    v_cvt_pk_bf16_f32 v95, v206, v207
    ds_write_b64 v8, v[94:95] offset:3616
    s_mov_b64 exec, 1
    ds_add_u32 v12, v13
    s_mov_b64 exec, -1
    s_mov_b32 s14, 3200000
FIN_sp:
    ds_read_b32 v16, v12 offset:0
    s_sub_u32 s14, s14, 1
    s_cbranch_scc1 FIN_sp_out
    s_waitcnt lgkmcnt(0)
    v_cmp_ne_u32 vcc, 4, v16
    s_cbranch_vccnz FIN_sp
FIN_sp_out:
    s_add_u32 s3, s3, 1
    ds_read_b64_tr_b16 v[96:97], v9 offset:0
    ds_read_b64_tr_b16 v[98:99], v9 offset:8448
    ds_read_b64_tr_b16 v[100:101], v9 offset:128
    ds_read_b64_tr_b16 v[102:103], v9 offset:8576
    ds_read_b64_tr_b16 v[104:105], v9 offset:1024
    ds_read_b64_tr_b16 v[106:107], v9 offset:9472
    ds_read_b64_tr_b16 v[108:109], v9 offset:1152
    ds_read_b64_tr_b16 v[110:111], v9 offset:9600
    ds_read_b64_tr_b16 v[112:113], v10 offset:0
    ds_read_b64_tr_b16 v[114:115], v10 offset:1024
    ds_read_b64_tr_b16 v[116:117], v10 offset:64
    ds_read_b64_tr_b16 v[118:119], v10 offset:1088
    ds_read_b64_tr_b16 v[120:121], v10 offset:512
    ds_read_b64_tr_b16 v[122:123], v10 offset:1536
    ds_read_b64_tr_b16 v[124:125], v10 offset:576
    ds_read_b64_tr_b16 v[126:127], v10 offset:1600
    s_add_u32 s50, s49, 0x200000
    s_waitcnt lgkmcnt(14)
    buffer_store_dwordx4 v[96:99], v2, s[28:31], s49 offen offset:0 sc1
    s_waitcnt lgkmcnt(12)
    buffer_store_dwordx4 v[100:103], v2, s[28:31], s49 offen offset:1024 sc1
    s_waitcnt lgkmcnt(10)
    buffer_store_dwordx4 v[104:107], v2, s[28:31], s50 offen offset:0 sc1
    s_waitcnt lgkmcnt(8)
    buffer_store_dwordx4 v[108:111], v2, s[28:31], s50 offen offset:1024 sc1
    s_waitcnt lgkmcnt(6)
    buffer_store_dwordx4 v[112:115], v11, s[28:31], s48 offen sc1
    s_add_u32 s48, s48, 0x40000
    s_waitcnt lgkmcnt(4)
    buffer_store_dwordx4 v[116:119], v11, s[28:31], s48 offen sc1
    s_add_u32 s48, s48, 0x1c0000
    s_waitcnt lgkmcnt(2)
    buffer_store_dwordx4 v[120:123], v11, s[28:31], s48 offen sc1
    s_add_u32 s48, s48, 0x40000
    s_waitcnt lgkmcnt(0)
    buffer_store_dwordx4 v[124:127], v11, s[28:31], s48 offen sc1
    s_cmp_lg_u32 s12, 0
    s_cbranch_scc1 FIN_nn
    s_mov_b64 exec, 3
    v_add_u32 v16, 115456, v2
    ds_read_b128 v[64:67], v16
    s_lshl_b32 s16, s2, 5
    s_add_u32 s16, s16, 0x800000
    s_waitcnt lgkmcnt(0)
    buffer_store_dwordx4 v[64:67], v2, s[28:31], s16 offen sc1
    s_mov_b64 exec, -1
FIN_nn:
    s_mov_b32 s24, s46
    s_and_b32 s25, s47, 0xffff
    s_mov_b32 s26, 0x1c00
    s_mov_b32 s27, 0x20000
    s_and_b32 s40, s12, 1
    s_lshl_b32 s45, s40, 7
    s_lshl_b32 s44, s58, 8
    s_add_u32 s45, s45, s44
    v_lshlrev_b32 v24, 3, v3
    buffer_load_dwordx2 v[128:129], v24, s[24:27], s45 offen offset:0
    buffer_load_dwordx2 v[130:131], v24, s[24:27], s45 offen offset:32
    buffer_load_dwordx2 v[132:133], v24, s[24:27], s45 offen offset:64
    buffer_load_dwordx2 v[134:135], v24, s[24:27], s45 offen offset:96
    s_cmp_lt_u32 s2, 224
    s_cbranch_scc1 FIN_nt
    s_mov_b32 s14, 3200000
FIN_ct:
    ds_read_b32 v16, v12 offset:12
    s_sub_u32 s14, s14, 1
    s_cbranch_scc1 FIN_ct_out
    s_waitcnt lgkmcnt(0)
    v_cmp_ne_u32 vcc, 4, v16
    s_cbranch_vccnz FIN_ct
FIN_ct_out:
    v_add_u32 v16, 73728, v2
    ds_read_b128 v[160:163], v2 offset:0
    ds_read_b128 v[164:167], v2 offset:1024
    ds_read_b128 v[168:171], v2 offset:2048
    ds_read_b128 v[172:175], v2 offset:3072
    ds_read_b128 v[176:179], v2 offset:4096
    ds_read_b128 v[180:183], v2 offset:5120
    ds_read_b128 v[184:187], v2 offset:6144
    ds_read_b128 v[188:191], v2 offset:7168
    ds_read_b128 v[192:195], v16 offset:0
    ds_read_b128 v[196:199], v16 offset:1024
    ds_read_b128 v[200:203], v16 offset:2048
    ds_read_b128 v[204:207], v16 offset:3072
    ds_read_b128 v[208:211], v16 offset:4096
    ds_read_b128 v[212:215], v16 offset:5120
    ds_read_b128 v[216:219], v16 offset:6144
    ds_read_b128 v[220:223], v16 offset:7168
    ds_read_b128 v[224:227], v2 offset:8192
    ds_read_b128 v[228:231], v2 offset:9216
    ds_read_b128 v[232:235], v2 offset:10240
    ds_read_b128 v[236:239], v2 offset:11264
    ds_read_b128 v[240:243], v2 offset:12288
    ds_read_b128 v[244:247], v2 offset:13312
    ds_read_b128 v[248:251], v2 offset:14336
    ds_read_b128 v[252:255], v2 offset:15360
FIN_nt:
    s_waitcnt vmcnt(4) lgkmcnt(0)
    s_mov_b64 exec, 1
    ds_add_rtn_u32 v16, v12, v13 offset:4
    s_waitcnt lgkmcnt(0)
    v_cmp_ne_u32 vcc, 7, v16
    s_mov_b64 exec, -1
    s_cbranch_vccnz FIN_na
    s_lshr_b32 s15, s2, 3
    s_mul_i32 s15, s15, 96
    s_lshl2_add_u32 s15, s2, s15
    s_add_u32 s15, s15, 0x30c0000
    v_lshlrev_b32 v17, 12, v1
    s_mov_b64 exec, 0xff
    v_mov_b32 v16, s3
    buffer_store_dword v16, v17, s[28:31], s15 offen sc1
    s_mov_b64 exec, -1
FIN_na:
FIN_g1:
    s_cmp_ge_u32 s2, 224
    s_cbranch_scc1 COL_j
    v_mov_b32 v12, v1
    s_and_b32 s40, s12, 1
    s_lshr_b32 s41, s12, 1
    v_bfe_u32 v13, v12, 2, 2
    v_lshrrev_b32 v14, 4, v12
    v_lshl_add_u32 v7, v14, 3, v13
    v_lshlrev_b32 v7, 8, v7
    v_lshlrev_b32 v11, 11, v14
    s_lshl_b32 s42, s40, 1
    v_xor_b32 v13, s42, v13
    v_lshl_add_u32 v7, v13, 6, v7
    v_and_b32 v13, 1, v14
    v_lshl_add_u32 v7, v13, 5, v7
    v_and_b32 v13, 3, v12
    v_lshl_add_u32 v7, v13, 3, v7
    v_xor_b32 v8, 32, v7
    v_xor_b32 v9, 64, v7
    v_xor_b32 v10, 96, v7
    v_and_b32 v13, 15, v12
    v_lshl_add_u32 v11, v13, 4, v11
    s_lshl_b32 s42, s41, 10
    s_add_u32 s42, s42, 65536
    v_add_u32 v11, s42, v11
    s_waitcnt vmcnt(0)
    v_lshlrev_b32 v64, 16, v128
    v_and_b32 v65, 0xffff0000, v128
    v_lshlrev_b32 v66, 16, v129
    v_and_b32 v67, 0xffff0000, v129
    v_mov_b32 v68, v64
    v_mov_b32 v69, v65
    v_mov_b32 v70, v66
    v_mov_b32 v71, v67
    v_mov_b32 v72, v64
    v_mov_b32 v73, v65
    v_mov_b32 v74, v66
    v_mov_b32 v75, v67
    v_mov_b32 v76, v64
    v_mov_b32 v77, v65
    v_mov_b32 v78, v66
    v_mov_b32 v79, v67
    v_lshlrev_b32 v80, 16, v130
    v_and_b32 v81, 0xffff0000, v130
    v_lshlrev_b32 v82, 16, v131
    v_and_b32 v83, 0xffff0000, v131
    v_mov_b32 v84, v80
    v_mov_b32 v85, v81
    v_mov_b32 v86, v82
    v_mov_b32 v87, v83
    v_mov_b32 v88, v80
    v_mov_b32 v89, v81
    v_mov_b32 v90, v82
    v_mov_b32 v91, v83
    v_mov_b32 v92, v80
    v_mov_b32 v93, v81
    v_mov_b32 v94, v82
    v_mov_b32 v95, v83
    v_lshlrev_b32 v96, 16, v132
    v_and_b32 v97, 0xffff0000, v132
    v_lshlrev_b32 v98, 16, v133
    v_and_b32 v99, 0xffff0000, v133
    v_mov_b32 v100, v96
    v_mov_b32 v101, v97
    v_mov_b32 v102, v98
    v_mov_b32 v103, v99
    v_mov_b32 v104, v96
    v_mov_b32 v105, v97
    v_mov_b32 v106, v98
    v_mov_b32 v107, v99
    v_mov_b32 v108, v96
    v_mov_b32 v109, v97
    v_mov_b32 v110, v98
    v_mov_b32 v111, v99
    v_lshlrev_b32 v112, 16, v134
    v_and_b32 v113, 0xffff0000, v134
    v_lshlrev_b32 v114, 16, v135
    v_and_b32 v115, 0xffff0000, v135
    v_mov_b32 v116, v112
    v_mov_b32 v117, v113
    v_mov_b32 v118, v114
    v_mov_b32 v119, v115
    v_mov_b32 v120, v112
    v_mov_b32 v121, v113
    v_mov_b32 v122, v114
    v_mov_b32 v123, v115
    v_mov_b32 v124, v112
    v_mov_b32 v125, v113
    v_mov_b32 v126, v114
    v_mov_b32 v127, v115
    v_mov_b32 v22, 0xc0135761
    v_mov_b32 v23, 0xc0135761
    v_mov_b32 v24, 0xbdd2d3e8
    v_mov_b32 v25, 0xbdd2d3e8
    v_mov_b32 v26, 1.0
    v_mov_b32 v27, 1.0
    v_lshrrev_b32 v20, 5, v12
    v_lshlrev_b32 v20, 11, v20
    v_and_b32 v21, 31, v12
    v_lshl_add_u32 v20, v21, 4, v20
    s_mul_i32 s45, s57, 917504
    s_lshl_b32 s46, s58, 15
    s_add_u32 s45, s45, s46
    s_lshl_b32 s46, s40, 14
    s_add_u32 s45, s45, s46
    s_lshl_b32 s46, s41, 10
    s_add_u32 s45, s45, s46
    s_add_u32 s45, s45, 0x1000000
    s_lshl_b32 s47, s40, 14
    s_add_u32 s46, s46, s47
    s_add_u32 s46, s46, 65536
    v_add_u32 v28, s46, v20
    v_mov_b32 v2, v7
    v_mov_b32 v3, v8
    v_mov_b32 v4, v9
    v_mov_b32 v5, v10
    v_mov_b32 v6, v11
    s_mov_b32 s43, 0
    s_mov_b32 s44, 31
    s_waitcnt lgkmcnt(0)
    s_barrier
    ds_read_b64_tr_b16 v[128:129], v2 offset:0
    ds_read_b64_tr_b16 v[130:131], v2 offset:1024
    ds_read_b128 v[144:147], v6 offset:0
    ds_read_b128 v[148:151], v6 offset:256
    ds_read_b128 v[152:155], v6 offset:512
    ds_read_b128 v[156:159], v6 offset:768
    ds_read_b64_tr_b16 v[132:133], v3 offset:0
    ds_read_b64_tr_b16 v[134:135], v3 offset:1024
    ds_read_b64_tr_b16 v[136:137], v4 offset:0
    ds_read_b64_tr_b16 v[138:139], v4 offset:1024
    ds_read_b64_tr_b16 v[140:141], v5 offset:0
    ds_read_b64_tr_b16 v[142:143], v5 offset:1024
.p2align 6
G1_loop:
    s_waitcnt lgkmcnt(9)
    v_mfma_f32_16x16x32_bf16 v[64:67], v[128:131], v[144:147], v[64:67]
    ds_read_b64_tr_b16 v[160:161], v2 offset:8192
    s_waitcnt lgkmcnt(9)
    v_mfma_f32_16x16x32_bf16 v[68:71], v[128:131], v[148:151], v[68:71]
    ds_read_b64_tr_b16 v[162:163], v2 offset:9216
    s_waitcnt lgkmcnt(9)
    v_mfma_f32_16x16x32_bf16 v[72:75], v[128:131], v[152:155], v[72:75]
    ds_read_b128 v[176:179], v6 offset:8192
    s_waitcnt lgkmcnt(9)
    v_mfma_f32_16x16x32_bf16 v[76:79], v[128:131], v[156:159], v[76:79]
    ds_read_b128 v[180:183], v6 offset:8448
    s_waitcnt lgkmcnt(8)
    v_mfma_f32_16x16x32_bf16 v[80:83], v[132:135], v[144:147], v[80:83]
    ds_read_b128 v[184:187], v6 offset:8704
    v_mfma_f32_16x16x32_bf16 v[84:87], v[132:135], v[148:151], v[84:87]
    ds_read_b128 v[188:191], v6 offset:8960
    v_mfma_f32_16x16x32_bf16 v[88:91], v[132:135], v[152:155], v[88:91]
    ds_read_b64_tr_b16 v[164:165], v3 offset:8192
    v_mfma_f32_16x16x32_bf16 v[92:95], v[132:135], v[156:159], v[92:95]
    ds_read_b64_tr_b16 v[166:167], v3 offset:9216
    s_waitcnt lgkmcnt(10)
    v_mfma_f32_16x16x32_bf16 v[96:99], v[136:139], v[144:147], v[96:99]
    ds_read_b64_tr_b16 v[168:169], v4 offset:8192
    v_mfma_f32_16x16x32_bf16 v[100:103], v[136:139], v[148:151], v[100:103]
    ds_read_b64_tr_b16 v[170:171], v4 offset:9216
    v_mfma_f32_16x16x32_bf16 v[104:107], v[136:139], v[152:155], v[104:107]
    ds_read_b64_tr_b16 v[172:173], v5 offset:8192
    v_mfma_f32_16x16x32_bf16 v[108:111], v[136:139], v[156:159], v[108:111]
    ds_read_b64_tr_b16 v[174:175], v5 offset:9216
    s_waitcnt lgkmcnt(12)
    v_mfma_f32_16x16x32_bf16 v[112:115], v[140:143], v[144:147], v[112:115]
    s_add_u32 s43, s43, 16384
    s_and_b32 s43, s43, 0xffff
    s_sub_u32 s44, s44, 1
    v_mfma_f32_16x16x32_bf16 v[116:119], v[140:143], v[148:151], v[116:119]
    v_add_u32 v2, s43, v7
    v_add_u32 v3, s43, v8
    v_mfma_f32_16x16x32_bf16 v[120:123], v[140:143], v[152:155], v[120:123]
    v_add_u32 v4, s43, v9
    v_add_u32 v5, s43, v10
    v_mfma_f32_16x16x32_bf16 v[124:127], v[140:143], v[156:159], v[124:127]
    v_add_u32 v6, s43, v11
    s_waitcnt lgkmcnt(9)
    v_mfma_f32_16x16x32_bf16 v[64:67], v[160:163], v[176:179], v[64:67]
    s_waitcnt lgkmcnt(8)
    v_mfma_f32_16x16x32_bf16 v[68:71], v[160:163], v[180:183], v[68:71]
    s_waitcnt lgkmcnt(0)
    s_barrier
    ds_read_b64_tr_b16 v[128:129], v2 offset:0
    v_mfma_f32_16x16x32_bf16 v[72:75], v[160:163], v[184:187], v[72:75]
    ds_read_b64_tr_b16 v[130:131], v2 offset:1024
    v_mfma_f32_16x16x32_bf16 v[76:79], v[160:163], v[188:191], v[76:79]
    ds_read_b128 v[144:147], v6 offset:0
    v_mfma_f32_16x16x32_bf16 v[80:83], v[164:167], v[176:179], v[80:83]
    ds_read_b128 v[148:151], v6 offset:256
    v_mfma_f32_16x16x32_bf16 v[84:87], v[164:167], v[180:183], v[84:87]
    ds_read_b128 v[152:155], v6 offset:512
    v_mfma_f32_16x16x32_bf16 v[88:91], v[164:167], v[184:187], v[88:91]
    ds_read_b128 v[156:159], v6 offset:768
    v_mfma_f32_16x16x32_bf16 v[92:95], v[164:167], v[188:191], v[92:95]
    ds_read_b64_tr_b16 v[132:133], v3 offset:0
    v_mfma_f32_16x16x32_bf16 v[96:99], v[168:171], v[176:179], v[96:99]
    ds_read_b64_tr_b16 v[134:135], v3 offset:1024
    v_mfma_f32_16x16x32_bf16 v[100:103], v[168:171], v[180:183], v[100:103]
    ds_read_b64_tr_b16 v[136:137], v4 offset:0
    v_mfma_f32_16x16x32_bf16 v[104:107], v[168:171], v[184:187], v[104:107]
    ds_read_b64_tr_b16 v[138:139], v4 offset:1024
    v_mfma_f32_16x16x32_bf16 v[108:111], v[168:171], v[188:191], v[108:111]
    ds_read_b64_tr_b16 v[140:141], v5 offset:0
    v_mfma_f32_16x16x32_bf16 v[112:115], v[172:175], v[176:179], v[112:115]
    ds_read_b64_tr_b16 v[142:143], v5 offset:1024
    v_mfma_f32_16x16x32_bf16 v[116:119], v[172:175], v[180:183], v[116:119]
    v_mfma_f32_16x16x32_bf16 v[120:123], v[172:175], v[184:187], v[120:123]
    s_cmp_lg_u32 s44, 0
    v_mfma_f32_16x16x32_bf16 v[124:127], v[172:175], v[188:191], v[124:127]
    s_cbranch_scc1 G1_loop
    s_waitcnt lgkmcnt(9)
    v_mfma_f32_16x16x32_bf16 v[64:67], v[128:131], v[144:147], v[64:67]
    ds_read_b64_tr_b16 v[160:161], v2 offset:8192
    s_waitcnt lgkmcnt(9)
    v_mfma_f32_16x16x32_bf16 v[68:71], v[128:131], v[148:151], v[68:71]
    ds_read_b64_tr_b16 v[162:163], v2 offset:9216
    s_waitcnt lgkmcnt(9)
    v_mfma_f32_16x16x32_bf16 v[72:75], v[128:131], v[152:155], v[72:75]
    ds_read_b128 v[176:179], v6 offset:8192
    s_waitcnt lgkmcnt(9)
    v_mfma_f32_16x16x32_bf16 v[76:79], v[128:131], v[156:159], v[76:79]
    ds_read_b128 v[180:183], v6 offset:8448
    s_waitcnt lgkmcnt(8)
    v_mfma_f32_16x16x32_bf16 v[80:83], v[132:135], v[144:147], v[80:83]
    ds_read_b128 v[184:187], v6 offset:8704
    v_mfma_f32_16x16x32_bf16 v[84:87], v[132:135], v[148:151], v[84:87]
    ds_read_b128 v[188:191], v6 offset:8960
    v_mfma_f32_16x16x32_bf16 v[88:91], v[132:135], v[152:155], v[88:91]
    ds_read_b64_tr_b16 v[164:165], v3 offset:8192
    v_mfma_f32_16x16x32_bf16 v[92:95], v[132:135], v[156:159], v[92:95]
    ds_read_b64_tr_b16 v[166:167], v3 offset:9216
    s_waitcnt lgkmcnt(10)
    v_mfma_f32_16x16x32_bf16 v[96:99], v[136:139], v[144:147], v[96:99]
    ds_read_b64_tr_b16 v[168:169], v4 offset:8192
    v_mfma_f32_16x16x32_bf16 v[100:103], v[136:139], v[148:151], v[100:103]
    ds_read_b64_tr_b16 v[170:171], v4 offset:9216
    v_mfma_f32_16x16x32_bf16 v[104:107], v[136:139], v[152:155], v[104:107]
    ds_read_b64_tr_b16 v[172:173], v5 offset:8192
    v_mfma_f32_16x16x32_bf16 v[108:111], v[136:139], v[156:159], v[108:111]
    ds_read_b64_tr_b16 v[174:175], v5 offset:9216
    s_waitcnt lgkmcnt(12)
    v_mfma_f32_16x16x32_bf16 v[112:115], v[140:143], v[144:147], v[112:115]
    v_mfma_f32_16x16x32_bf16 v[116:119], v[140:143], v[148:151], v[116:119]
    v_mfma_f32_16x16x32_bf16 v[120:123], v[140:143], v[152:155], v[120:123]
    v_mfma_f32_16x16x32_bf16 v[124:127], v[140:143], v[156:159], v[124:127]
    s_waitcnt lgkmcnt(9)
    v_mfma_f32_16x16x32_bf16 v[64:67], v[160:163], v[176:179], v[64:67]
    s_waitcnt lgkmcnt(8)
    v_mfma_f32_16x16x32_bf16 v[68:71], v[160:163], v[180:183], v[68:71]
    s_waitcnt lgkmcnt(7)
    v_mfma_f32_16x16x32_bf16 v[72:75], v[160:163], v[184:187], v[72:75]
    s_waitcnt lgkmcnt(6)
    v_mfma_f32_16x16x32_bf16 v[76:79], v[160:163], v[188:191], v[76:79]
    s_waitcnt lgkmcnt(4)
    v_mfma_f32_16x16x32_bf16 v[80:83], v[164:167], v[176:179], v[80:83]
    v_mfma_f32_16x16x32_bf16 v[84:87], v[164:167], v[180:183], v[84:87]
    v_mfma_f32_16x16x32_bf16 v[88:91], v[164:167], v[184:187], v[88:91]
    v_mfma_f32_16x16x32_bf16 v[92:95], v[164:167], v[188:191], v[92:95]
    s_waitcnt lgkmcnt(2)
    v_mfma_f32_16x16x32_bf16 v[96:99], v[168:171], v[176:179], v[96:99]
    v_mfma_f32_16x16x32_bf16 v[100:103], v[168:171], v[180:183], v[100:103]
    v_mfma_f32_16x16x32_bf16 v[104:107], v[168:171], v[184:187], v[104:107]
    v_mfma_f32_16x16x32_bf16 v[108:111], v[168:171], v[188:191], v[108:111]
    s_waitcnt lgkmcnt(0)
    v_mfma_f32_16x16x32_bf16 v[112:115], v[172:175], v[176:179], v[112:115]
    v_mfma_f32_16x16x32_bf16 v[116:119], v[172:175], v[180:183], v[116:119]
    v_mfma_f32_16x16x32_bf16 v[120:123], v[172:175], v[184:187], v[120:123]
    v_mfma_f32_16x16x32_bf16 v[124:127], v[172:175], v[188:191], v[124:127]
    v_pk_mul_f32 v[128:129], v[64:65], v[64:65]
    v_pk_mul_f32 v[130:131], v[66:67], v[66:67]
    v_pk_mul_f32 v[132:133], v[68:69], v[68:69]
    v_pk_mul_f32 v[134:135], v[70:71], v[70:71]
    v_pk_fma_f32 v[128:129], v[128:129], v[24:25], v[22:23]
    v_pk_fma_f32 v[130:131], v[130:131], v[24:25], v[22:23]
    v_pk_fma_f32 v[132:133], v[132:133], v[24:25], v[22:23]
    v_pk_fma_f32 v[134:135], v[134:135], v[24:25], v[22:23]
    v_pk_mul_f32 v[128:129], v[128:129], v[64:65]
    v_pk_mul_f32 v[130:131], v[130:131], v[66:67]
    v_pk_mul_f32 v[132:133], v[132:133], v[68:69]
    v_pk_mul_f32 v[134:135], v[134:135], v[70:71]
    v_exp_f32 v128, v128
    v_exp_f32 v129, v129
    v_exp_f32 v130, v130
    v_exp_f32 v131, v131
    v_exp_f32 v132, v132
    v_exp_f32 v133, v133
    v_exp_f32 v134, v134
    v_exp_f32 v135, v135
    v_pk_add_f32 v[128:129], v[128:129], v[26:27]
    v_pk_add_f32 v[130:131], v[130:131], v[26:27]
    v_pk_add_f32 v[132:133], v[132:133], v[26:27]
    v_pk_add_f32 v[134:135], v[134:135], v[26:27]
    v_rcp_f32 v128, v128
    v_rcp_f32 v129, v129
    v_rcp_f32 v130, v130
    v_rcp_f32 v131, v131
    v_rcp_f32 v132, v132
    v_rcp_f32 v133, v133
    v_rcp_f32 v134, v134
    v_rcp_f32 v135, v135
    v_pk_mul_f32 v[128:129], v[128:129], v[64:65]
    v_pk_mul_f32 v[130:131], v[130:131], v[66:67]
    v_pk_mul_f32 v[132:133], v[132:133], v[68:69]
    v_pk_mul_f32 v[134:135], v[134:135], v[70:71]
    v_cvt_pk_bf16_f32 v136, v128, v129
    v_cvt_pk_bf16_f32 v137, v130, v131
    v_cvt_pk_bf16_f32 v138, v132, v133
    v_cvt_pk_bf16_f32 v139, v134, v135
    s_nop 0
    v_permlane16_swap_b32 v136, v138
    v_permlane16_swap_b32 v137, v139
    s_add_u32 s46, s45, 0
    buffer_store_dwordx4 v[136:139], v20, s[28:31], s46 offen offset:0 sc1
    ds_write_b128 v28, v[136:139] offset:0
    v_pk_mul_f32 v[144:145], v[72:73], v[72:73]
    v_pk_mul_f32 v[146:147], v[74:75], v[74:75]
    v_pk_mul_f32 v[148:149], v[76:77], v[76:77]
    v_pk_mul_f32 v[150:151], v[78:79], v[78:79]
    v_pk_fma_f32 v[144:145], v[144:145], v[24:25], v[22:23]
    v_pk_fma_f32 v[146:147], v[146:147], v[24:25], v[22:23]
    v_pk_fma_f32 v[148:149], v[148:149], v[24:25], v[22:23]
    v_pk_fma_f32 v[150:151], v[150:151], v[24:25], v[22:23]
    v_pk_mul_f32 v[144:145], v[144:145], v[72:73]
    v_pk_mul_f32 v[146:147], v[146:147], v[74:75]
    v_pk_mul_f32 v[148:149], v[148:149], v[76:77]
    v_pk_mul_f32 v[150:151], v[150:151], v[78:79]
    v_exp_f32 v144, v144
    v_exp_f32 v145, v145
    v_exp_f32 v146, v146
    v_exp_f32 v147, v147
    v_exp_f32 v148, v148
    v_exp_f32 v149, v149
    v_exp_f32 v150, v150
    v_exp_f32 v151, v151
    v_pk_add_f32 v[144:145], v[144:145], v[26:27]
    v_pk_add_f32 v[146:147], v[146:147], v[26:27]
    v_pk_add_f32 v[148:149], v[148:149], v[26:27]
    v_pk_add_f32 v[150:151], v[150:151], v[26:27]
    v_rcp_f32 v144, v144
    v_rcp_f32 v145, v145
    v_rcp_f32 v146, v146
    v_rcp_f32 v147, v147
    v_rcp_f32 v148, v148
    v_rcp_f32 v149, v149
    v_rcp_f32 v150, v150
    v_rcp_f32 v151, v151
    v_pk_mul_f32 v[144:145], v[144:145], v[72:73]
    v_pk_mul_f32 v[146:147], v[146:147], v[74:75]
    v_pk_mul_f32 v[148:149], v[148:149], v[76:77]
    v_pk_mul_f32 v[150:151], v[150:151], v[78:79]
    v_cvt_pk_bf16_f32 v152, v144, v145
    v_cvt_pk_bf16_f32 v153, v146, v147
    v_cvt_pk_bf16_f32 v154, v148, v149
    v_cvt_pk_bf16_f32 v155, v150, v151
    s_nop 0
    v_permlane16_swap_b32 v152, v154
    v_permlane16_swap_b32 v153, v155
    s_add_u32 s46, s45, 0
    buffer_store_dwordx4 v[152:155], v20, s[28:31], s46 offen offset:512 sc1
    ds_write_b128 v28, v[152:155] offset:512
    v_pk_mul_f32 v[160:161], v[80:81], v[80:81]
    v_pk_mul_f32 v[162:163], v[82:83], v[82:83]
    v_pk_mul_f32 v[164:165], v[84:85], v[84:85]
    v_pk_mul_f32 v[166:167], v[86:87], v[86:87]
    v_pk_fma_f32 v[160:161], v[160:161], v[24:25], v[22:23]
    v_pk_fma_f32 v[162:163], v[162:163], v[24:25], v[22:23]
    v_pk_fma_f32 v[164:165], v[164:165], v[24:25], v[22:23]
    v_pk_fma_f32 v[166:167], v[166:167], v[24:25], v[22:23]
    v_pk_mul_f32 v[160:161], v[160:161], v[80:81]
    v_pk_mul_f32 v[162:163], v[162:163], v[82:83]
    v_pk_mul_f32 v[164:165], v[164:165], v[84:85]
    v_pk_mul_f32 v[166:167], v[166:167], v[86:87]
    v_exp_f32 v160, v160
    v_exp_f32 v161, v161
    v_exp_f32 v162, v162
    v_exp_f32 v163, v163
    v_exp_f32 v164, v164
    v_exp_f32 v165, v165
    v_exp_f32 v166, v166
    v_exp_f32 v167, v167
    v_pk_add_f32 v[160:161], v[160:161], v[26:27]
    v_pk_add_f32 v[162:163], v[162:163], v[26:27]
    v_pk_add_f32 v[164:165], v[164:165], v[26:27]
    v_pk_add_f32 v[166:167], v[166:167], v[26:27]
    v_rcp_f32 v160, v160
    v_rcp_f32 v161, v161
    v_rcp_f32 v162, v162
    v_rcp_f32 v163, v163
    v_rcp_f32 v164, v164
    v_rcp_f32 v165, v165
    v_rcp_f32 v166, v166
    v_rcp_f32 v167, v167
    v_pk_mul_f32 v[160:161], v[160:161], v[80:81]
    v_pk_mul_f32 v[162:163], v[162:163], v[82:83]
    v_pk_mul_f32 v[164:165], v[164:165], v[84:85]
    v_pk_mul_f32 v[166:167], v[166:167], v[86:87]
    v_cvt_pk_bf16_f32 v168, v160, v161
    v_cvt_pk_bf16_f32 v169, v162, v163
    v_cvt_pk_bf16_f32 v170, v164, v165
    v_cvt_pk_bf16_f32 v171, v166, v167
    s_nop 0
    v_permlane16_swap_b32 v168, v170
    v_permlane16_swap_b32 v169, v171
    s_add_u32 s46, s45, 4096
    buffer_store_dwordx4 v[168:171], v20, s[28:31], s46 offen offset:0 sc1
    ds_write_b128 v28, v[168:171] offset:4096
    v_pk_mul_f32 v[176:177], v[88:89], v[88:89]
    v_pk_mul_f32 v[178:179], v[90:91], v[90:91]
    v_pk_mul_f32 v[180:181], v[92:93], v[92:93]
    v_pk_mul_f32 v[182:183], v[94:95], v[94:95]
    v_pk_fma_f32 v[176:177], v[176:177], v[24:25], v[22:23]
    v_pk_fma_f32 v[178:179], v[178:179], v[24:25], v[22:23]
    v_pk_fma_f32 v[180:181], v[180:181], v[24:25], v[22:23]
    v_pk_fma_f32 v[182:183], v[182:183], v[24:25], v[22:23]
    v_pk_mul_f32 v[176:177], v[176:177], v[88:89]
    v_pk_mul_f32 v[178:179], v[178:179], v[90:91]
    v_pk_mul_f32 v[180:181], v[180:181], v[92:93]
    v_pk_mul_f32 v[182:183], v[182:183], v[94:95]
    v_exp_f32 v176, v176
    v_exp_f32 v177, v177
    v_exp_f32 v178, v178
    v_exp_f32 v179, v179
    v_exp_f32 v180, v180
    v_exp_f32 v181, v181
    v_exp_f32 v182, v182
    v_exp_f32 v183, v183
    v_pk_add_f32 v[176:177], v[176:177], v[26:27]
    v_pk_add_f32 v[178:179], v[178:179], v[26:27]
    v_pk_add_f32 v[180:181], v[180:181], v[26:27]
    v_pk_add_f32 v[182:183], v[182:183], v[26:27]
    v_rcp_f32 v176, v176
    v_rcp_f32 v177, v177
    v_rcp_f32 v178, v178
    v_rcp_f32 v179, v179
    v_rcp_f32 v180, v180
    v_rcp_f32 v181, v181
    v_rcp_f32 v182, v182
    v_rcp_f32 v183, v183
    v_pk_mul_f32 v[176:177], v[176:177], v[88:89]
    v_pk_mul_f32 v[178:179], v[178:179], v[90:91]
    v_pk_mul_f32 v[180:181], v[180:181], v[92:93]
    v_pk_mul_f32 v[182:183], v[182:183], v[94:95]
    v_cvt_pk_bf16_f32 v184, v176, v177
    v_cvt_pk_bf16_f32 v185, v178, v179
    v_cvt_pk_bf16_f32 v186, v180, v181
    v_cvt_pk_bf16_f32 v187, v182, v183
    s_nop 0
    v_permlane16_swap_b32 v184, v186
    v_permlane16_swap_b32 v185, v187
    s_add_u32 s46, s45, 4096
    buffer_store_dwordx4 v[184:187], v20, s[28:31], s46 offen offset:512 sc1
    ds_write_b128 v28, v[184:187] offset:4608
    v_pk_mul_f32 v[128:129], v[96:97], v[96:97]
    v_pk_mul_f32 v[130:131], v[98:99], v[98:99]
    v_pk_mul_f32 v[132:133], v[100:101], v[100:101]
    v_pk_mul_f32 v[134:135], v[102:103], v[102:103]
    v_pk_fma_f32 v[128:129], v[128:129], v[24:25], v[22:23]
    v_pk_fma_f32 v[130:131], v[130:131], v[24:25], v[22:23]
    v_pk_fma_f32 v[132:133], v[132:133], v[24:25], v[22:23]
    v_pk_fma_f32 v[134:135], v[134:135], v[24:25], v[22:23]
    v_pk_mul_f32 v[128:129], v[128:129], v[96:97]
    v_pk_mul_f32 v[130:131], v[130:131], v[98:99]
    v_pk_mul_f32 v[132:133], v[132:133], v[100:101]
    v_pk_mul_f32 v[134:135], v[134:135], v[102:103]
    v_exp_f32 v128, v128
    v_exp_f32 v129, v129
    v_exp_f32 v130, v130
    v_exp_f32 v131, v131
    v_exp_f32 v132, v132
    v_exp_f32 v133, v133
    v_exp_f32 v134, v134
    v_exp_f32 v135, v135
    v_pk_add_f32 v[128:129], v[128:129], v[26:27]
    v_pk_add_f32 v[130:131], v[130:131], v[26:27]
    v_pk_add_f32 v[132:133], v[132:133], v[26:27]
    v_pk_add_f32 v[134:135], v[134:135], v[26:27]
    v_rcp_f32 v128, v128
    v_rcp_f32 v129, v129
    v_rcp_f32 v130, v130
    v_rcp_f32 v131, v131
    v_rcp_f32 v132, v132
    v_rcp_f32 v133, v133
    v_rcp_f32 v134, v134
    v_rcp_f32 v135, v135
    v_pk_mul_f32 v[128:129], v[128:129], v[96:97]
    v_pk_mul_f32 v[130:131], v[130:131], v[98:99]
    v_pk_mul_f32 v[132:133], v[132:133], v[100:101]
    v_pk_mul_f32 v[134:135], v[134:135], v[102:103]
    v_cvt_pk_bf16_f32 v136, v128, v129
    v_cvt_pk_bf16_f32 v137, v130, v131
    v_cvt_pk_bf16_f32 v138, v132, v133
    v_cvt_pk_bf16_f32 v139, v134, v135
    s_nop 0
    v_permlane16_swap_b32 v136, v138
    v_permlane16_swap_b32 v137, v139
    s_add_u32 s46, s45, 8192
    buffer_store_dwordx4 v[136:139], v20, s[28:31], s46 offen offset:0 sc1
    ds_write_b128 v28, v[136:139] offset:8192
    v_pk_mul_f32 v[144:145], v[104:105], v[104:105]
    v_pk_mul_f32 v[146:147], v[106:107], v[106:107]
    v_pk_mul_f32 v[148:149], v[108:109], v[108:109]
    v_pk_mul_f32 v[150:151], v[110:111], v[110:111]
    v_pk_fma_f32 v[144:145], v[144:145], v[24:25], v[22:23]
    v_pk_fma_f32 v[146:147], v[146:147], v[24:25], v[22:23]
    v_pk_fma_f32 v[148:149], v[148:149], v[24:25], v[22:23]
    v_pk_fma_f32 v[150:151], v[150:151], v[24:25], v[22:23]
    v_pk_mul_f32 v[144:145], v[144:145], v[104:105]
    v_pk_mul_f32 v[146:147], v[146:147], v[106:107]
    v_pk_mul_f32 v[148:149], v[148:149], v[108:109]
    v_pk_mul_f32 v[150:151], v[150:151], v[110:111]
    v_exp_f32 v144, v144
    v_exp_f32 v145, v145
    v_exp_f32 v146, v146
    v_exp_f32 v147, v147
    v_exp_f32 v148, v148
    v_exp_f32 v149, v149
    v_exp_f32 v150, v150
    v_exp_f32 v151, v151
    v_pk_add_f32 v[144:145], v[144:145], v[26:27]
    v_pk_add_f32 v[146:147], v[146:147], v[26:27]
    v_pk_add_f32 v[148:149], v[148:149], v[26:27]
    v_pk_add_f32 v[150:151], v[150:151], v[26:27]
    v_rcp_f32 v144, v144
    v_rcp_f32 v145, v145
    v_rcp_f32 v146, v146
    v_rcp_f32 v147, v147
    v_rcp_f32 v148, v148
    v_rcp_f32 v149, v149
    v_rcp_f32 v150, v150
    v_rcp_f32 v151, v151
    v_pk_mul_f32 v[144:145], v[144:145], v[104:105]
    v_pk_mul_f32 v[146:147], v[146:147], v[106:107]
    v_pk_mul_f32 v[148:149], v[148:149], v[108:109]
    v_pk_mul_f32 v[150:151], v[150:151], v[110:111]
    v_cvt_pk_bf16_f32 v152, v144, v145
    v_cvt_pk_bf16_f32 v153, v146, v147
    v_cvt_pk_bf16_f32 v154, v148, v149
    v_cvt_pk_bf16_f32 v155, v150, v151
    s_nop 0
    v_permlane16_swap_b32 v152, v154
    v_permlane16_swap_b32 v153, v155
    s_add_u32 s46, s45, 8192
    buffer_store_dwordx4 v[152:155], v20, s[28:31], s46 offen offset:512 sc1
    ds_write_b128 v28, v[152:155] offset:8704
    v_pk_mul_f32 v[160:161], v[112:113], v[112:113]
    v_pk_mul_f32 v[162:163], v[114:115], v[114:115]
    v_pk_mul_f32 v[164:165], v[116:117], v[116:117]
    v_pk_mul_f32 v[166:167], v[118:119], v[118:119]
    v_pk_fma_f32 v[160:161], v[160:161], v[24:25], v[22:23]
    v_pk_fma_f32 v[162:163], v[162:163], v[24:25], v[22:23]
    v_pk_fma_f32 v[164:165], v[164:165], v[24:25], v[22:23]
    v_pk_fma_f32 v[166:167], v[166:167], v[24:25], v[22:23]
    v_pk_mul_f32 v[160:161], v[160:161], v[112:113]
    v_pk_mul_f32 v[162:163], v[162:163], v[114:115]
    v_pk_mul_f32 v[164:165], v[164:165], v[116:117]
    v_pk_mul_f32 v[166:167], v[166:167], v[118:119]
    v_exp_f32 v160, v160
    v_exp_f32 v161, v161
    v_exp_f32 v162, v162
    v_exp_f32 v163, v163
    v_exp_f32 v164, v164
    v_exp_f32 v165, v165
    v_exp_f32 v166, v166
    v_exp_f32 v167, v167
    v_pk_add_f32 v[160:161], v[160:161], v[26:27]
    v_pk_add_f32 v[162:163], v[162:163], v[26:27]
    v_pk_add_f32 v[164:165], v[164:165], v[26:27]
    v_pk_add_f32 v[166:167], v[166:167], v[26:27]
    v_rcp_f32 v160, v160
    v_rcp_f32 v161, v161
    v_rcp_f32 v162, v162
    v_rcp_f32 v163, v163
    v_rcp_f32 v164, v164
    v_rcp_f32 v165, v165
    v_rcp_f32 v166, v166
    v_rcp_f32 v167, v167
    v_pk_mul_f32 v[160:161], v[160:161], v[112:113]
    v_pk_mul_f32 v[162:163], v[162:163], v[114:115]
    v_pk_mul_f32 v[164:165], v[164:165], v[116:117]
    v_pk_mul_f32 v[166:167], v[166:167], v[118:119]
    v_cvt_pk_bf16_f32 v168, v160, v161
    v_cvt_pk_bf16_f32 v169, v162, v163
    v_cvt_pk_bf16_f32 v170, v164, v165
    v_cvt_pk_bf16_f32 v171, v166, v167
    s_nop 0
    v_permlane16_swap_b32 v168, v170
    v_permlane16_swap_b32 v169, v171
    s_add_u32 s46, s45, 12288
    buffer_store_dwordx4 v[168:171], v20, s[28:31], s46 offen offset:0 sc1
    ds_write_b128 v28, v[168:171] offset:12288
    v_pk_mul_f32 v[176:177], v[120:121], v[120:121]
    v_pk_mul_f32 v[178:179], v[122:123], v[122:123]
    v_pk_mul_f32 v[180:181], v[124:125], v[124:125]
    v_pk_mul_f32 v[182:183], v[126:127], v[126:127]
    v_pk_fma_f32 v[176:177], v[176:177], v[24:25], v[22:23]
    v_pk_fma_f32 v[178:179], v[178:179], v[24:25], v[22:23]
    v_pk_fma_f32 v[180:181], v[180:181], v[24:25], v[22:23]
    v_pk_fma_f32 v[182:183], v[182:183], v[24:25], v[22:23]
    v_pk_mul_f32 v[176:177], v[176:177], v[120:121]
    v_pk_mul_f32 v[178:179], v[178:179], v[122:123]
    v_pk_mul_f32 v[180:181], v[180:181], v[124:125]
    v_pk_mul_f32 v[182:183], v[182:183], v[126:127]
    v_exp_f32 v176, v176
    v_exp_f32 v177, v177
    v_exp_f32 v178, v178
    v_exp_f32 v179, v179
    v_exp_f32 v180, v180
    v_exp_f32 v181, v181
    v_exp_f32 v182, v182
    v_exp_f32 v183, v183
    v_pk_add_f32 v[176:177], v[176:177], v[26:27]
    v_pk_add_f32 v[178:179], v[178:179], v[26:27]
    v_pk_add_f32 v[180:181], v[180:181], v[26:27]
    v_pk_add_f32 v[182:183], v[182:183], v[26:27]
    v_rcp_f32 v176, v176
    v_rcp_f32 v177, v177
    v_rcp_f32 v178, v178
    v_rcp_f32 v179, v179
    v_rcp_f32 v180, v180
    v_rcp_f32 v181, v181
    v_rcp_f32 v182, v182
    v_rcp_f32 v183, v183
    v_pk_mul_f32 v[176:177], v[176:177], v[120:121]
    v_pk_mul_f32 v[178:179], v[178:179], v[122:123]
    v_pk_mul_f32 v[180:181], v[180:181], v[124:125]
    v_pk_mul_f32 v[182:183], v[182:183], v[126:127]
    v_cvt_pk_bf16_f32 v184, v176, v177
    v_cvt_pk_bf16_f32 v185, v178, v179
    v_cvt_pk_bf16_f32 v186, v180, v181
    v_cvt_pk_bf16_f32 v187, v182, v183
    s_nop 0
    v_permlane16_swap_b32 v184, v186
    v_permlane16_swap_b32 v185, v187
    s_add_u32 s46, s45, 12288
    buffer_store_dwordx4 v[184:187], v20, s[28:31], s46 offen offset:512 sc1
    ds_write_b128 v28, v[184:187] offset:12800
    s_lshr_b32 s13, s54, 2
    s_lshl_b32 s24, s57, 1
    s_add_u32 s24, s24, s13
    s_lshl_b32 s24, s24, 4
    s_mul_i32 s13, s13, 14
    s_sub_u32 s13, s58, s13
    s_add_u32 s24, s24, s13
    s_lshl_b32 s24, s24, 5
    s_add_u32 s24, s24, s12
    s_lshl_b32 s24, s24, 2
    s_add_u32 s24, s24, 0x3080000
G2_R:
G2_R2:
    v_mov_b32 v12, v1
    s_and_b32 s40, s12, 1
    s_lshr_b32 s41, s12, 1
    v_bfe_u32 v13, v12, 2, 2
    v_lshrrev_b32 v14, 4, v12
    v_lshl_add_u32 v7, v14, 3, v13
    v_lshlrev_b32 v7, 8, v7
    v_lshlrev_b32 v11, 11, v14
    s_lshl_b32 s42, s40, 1
    v_xor_b32 v13, s42, v13
    v_lshl_add_u32 v7, v13, 6, v7
    v_and_b32 v13, 1, v14
    v_lshl_add_u32 v7, v13, 5, v7
    v_and_b32 v13, 3, v12
    v_lshl_add_u32 v7, v13, 3, v7
    v_xor_b32 v8, 32, v7
    v_xor_b32 v9, 64, v7
    v_xor_b32 v10, 96, v7
    v_and_b32 v13, 15, v12
    v_lshl_add_u32 v11, v13, 4, v11
    s_lshl_b32 s42, s41, 10
    s_add_u32 s42, s42, 65536
    v_add_u32 v11, s42, v11
    s_lshr_b32 s14, s54, 2
    s_bfe_u32 s13, s54, 0x10001
    s_lshl_b32 s13, s13, 3
    s_add_u32 s13, s13, s55
    s_lshl_b32 s15, s13, 1
    s_add_u32 s15, s15, s40
    s_lshl_b32 s16, s15, 17
    s_lshl_b32 s17, s13, 6
    s_mul_i32 s15, s14, 0x1700000
    s_add_u32 s16, s16, s15
    s_lshl_b32 s15, s57, 1
    s_add_u32 s15, s15, s41
    s_lshl_b32 s18, s15, 7
    s_add_u32 s16, s16, s18
    s_add_u32 s16, s16, 0x900000
    s_lshl_b32 s15, s57, 1
    s_add_u32 s15, s15, s14
    s_lshl_b32 s15, s15, 2
    s_add_u32 s17, s17, s15
    s_lshl_b32 s17, s17, 5
    s_add_u32 s17, s17, 0x3010000
    v_mov_b32 v16, 155648
    v_mov_b32 v17, 1
    v_lshlrev_b32 v19, 15, v12
    v_and_b32 v22, 15, v12
    v_lshrrev_b32 v18, 3, v12
    v_and_b32 v21, 7, v12
    v_xor_b32 v20, v21, v18
    v_lshlrev_b32 v21, 4, v21
    v_lshlrev_b32 v20, 4, v20
    s_lshl_b32 s15, s12, 13
    v_lshl_add_u32 v20, v18, 7, v20
    v_lshl_add_u32 v18, v18, 11, v21
    v_add_u32 v21, s15, v20
    v_lshrrev_b32 v20, 5, v12
    v_xor_b32 v20, v20, v22
    v_and_b32 v20, 7, v20
    v_lshlrev_b32 v20, 4, v20
    v_lshl_add_u32 v20, v22, 7, v20
    v_bfe_u32 v22, v12, 4, 1
    v_lshl_add_u32 v20, v22, 3, v20
    v_add_u32 v20, s15, v20
    v_xor_b32 v25, 32, v20
    v_xor_b32 v26, 64, v20
    v_xor_b32 v27, 96, v20
    v_mov_b32 v64, 0
    v_mov_b32 v65, 0
    v_mov_b32 v66, 0
    v_mov_b32 v67, 0
    v_mov_b32 v68, 0
    v_mov_b32 v69, 0
    v_mov_b32 v70, 0
    v_mov_b32 v71, 0
    v_mov_b32 v72, 0
    v_mov_b32 v73, 0
    v_mov_b32 v74, 0
    v_mov_b32 v75, 0
    v_mov_b32 v76, 0
    v_mov_b32 v77, 0
    v_mov_b32 v78, 0
    v_mov_b32 v79, 0
    v_mov_b32 v80, 0
    v_mov_b32 v81, 0
    v_mov_b32 v82, 0
    v_mov_b32 v83, 0
    v_mov_b32 v84, 0
    v_mov_b32 v85, 0
    v_mov_b32 v86, 0
    v_mov_b32 v87, 0
    v_mov_b32 v88, 0
    v_mov_b32 v89, 0
    v_mov_b32 v90, 0
    v_mov_b32 v91, 0
    v_mov_b32 v92, 0
    v_mov_b32 v93, 0
    v_mov_b32 v94, 0
    v_mov_b32 v95, 0
    v_mov_b32 v96, 0
    v_mov_b32 v97, 0
    v_mov_b32 v98, 0
    v_mov_b32 v99, 0
    v_mov_b32 v100, 0
    v_mov_b32 v101, 0
    v_mov_b32 v102, 0
    v_mov_b32 v103, 0
    v_mov_b32 v104, 0
    v_mov_b32 v105, 0
    v_mov_b32 v106, 0
    v_mov_b32 v107, 0
    v_mov_b32 v108, 0
    v_mov_b32 v109, 0
    v_mov_b32 v110, 0
    v_mov_b32 v111, 0
    v_mov_b32 v112, 0
    v_mov_b32 v113, 0
    v_mov_b32 v114, 0
    v_mov_b32 v115, 0
    v_mov_b32 v116, 0
    v_mov_b32 v117, 0
    v_mov_b32 v118, 0
    v_mov_b32 v119, 0
    v_mov_b32 v120, 0
    v_mov_b32 v121, 0
    v_mov_b32 v122, 0
    v_mov_b32 v123, 0
    v_mov_b32 v124, 0
    v_mov_b32 v125, 0
    v_mov_b32 v126, 0
    v_mov_b32 v127, 0
    v_mov_b32 v2, v7
    v_mov_b32 v3, v8
    v_mov_b32 v4, v9
    v_mov_b32 v5, v10
    v_mov_b32 v6, v11
    s_mov_b32 s43, 0
    s_mov_b32 s44, 27
    s_waitcnt lgkmcnt(0)
    s_barrier
    ds_read_b64_tr_b16 v[128:129], v2 offset:0
    ds_read_b64_tr_b16 v[130:131], v2 offset:1024
    ds_read_b128 v[144:147], v6 offset:0
    ds_read_b128 v[148:151], v6 offset:256
    ds_read_b128 v[152:155], v6 offset:512
    ds_read_b128 v[156:159], v6 offset:768
    ds_read_b64_tr_b16 v[132:133], v3 offset:0
    ds_read_b64_tr_b16 v[134:135], v3 offset:1024
    ds_read_b64_tr_b16 v[136:137], v4 offset:0
    ds_read_b64_tr_b16 v[138:139], v4 offset:1024
    ds_read_b64_tr_b16 v[140:141], v5 offset:0
    ds_read_b64_tr_b16 v[142:143], v5 offset:1024
.p2align 6
G2_loop:
    s_waitcnt lgkmcnt(9)
    v_mfma_f32_16x16x32_bf16 v[64:67], v[144:147], v[128:131], v[64:67]
    ds_read_b64_tr_b16 v[160:161], v2 offset:8192
    s_waitcnt lgkmcnt(9)
    v_mfma_f32_16x16x32_bf16 v[68:71], v[148:151], v[128:131], v[68:71]
    ds_read_b64_tr_b16 v[162:163], v2 offset:9216
    s_waitcnt lgkmcnt(9)
    v_mfma_f32_16x16x32_bf16 v[72:75], v[152:155], v[128:131], v[72:75]
    ds_read_b128 v[176:179], v6 offset:8192
    s_waitcnt lgkmcnt(9)
    v_mfma_f32_16x16x32_bf16 v[76:79], v[156:159], v[128:131], v[76:79]
    ds_read_b128 v[180:183], v6 offset:8448
    s_waitcnt lgkmcnt(8)
    v_mfma_f32_16x16x32_bf16 v[80:83], v[144:147], v[132:135], v[80:83]
    ds_read_b128 v[184:187], v6 offset:8704
    v_mfma_f32_16x16x32_bf16 v[84:87], v[148:151], v[132:135], v[84:87]
    ds_read_b128 v[188:191], v6 offset:8960
    v_mfma_f32_16x16x32_bf16 v[88:91], v[152:155], v[132:135], v[88:91]
    ds_read_b64_tr_b16 v[164:165], v3 offset:8192
    v_mfma_f32_16x16x32_bf16 v[92:95], v[156:159], v[132:135], v[92:95]
    ds_read_b64_tr_b16 v[166:167], v3 offset:9216
    s_waitcnt lgkmcnt(10)
    v_mfma_f32_16x16x32_bf16 v[96:99], v[144:147], v[136:139], v[96:99]
    ds_read_b64_tr_b16 v[168:169], v4 offset:8192
    v_mfma_f32_16x16x32_bf16 v[100:103], v[148:151], v[136:139], v[100:103]
    ds_read_b64_tr_b16 v[170:171], v4 offset:9216
    v_mfma_f32_16x16x32_bf16 v[104:107], v[152:155], v[136:139], v[104:107]
    ds_read_b64_tr_b16 v[172:173], v5 offset:8192
    v_mfma_f32_16x16x32_bf16 v[108:111], v[156:159], v[136:139], v[108:111]
    ds_read_b64_tr_b16 v[174:175], v5 offset:9216
    s_waitcnt lgkmcnt(12)
    v_mfma_f32_16x16x32_bf16 v[112:115], v[144:147], v[140:143], v[112:115]
    s_add_u32 s43, s43, 16384
    s_and_b32 s43, s43, 0xffff
    s_sub_u32 s44, s44, 1
    v_mfma_f32_16x16x32_bf16 v[116:119], v[148:151], v[140:143], v[116:119]
    v_add_u32 v2, s43, v7
    v_add_u32 v3, s43, v8
    v_mfma_f32_16x16x32_bf16 v[120:123], v[152:155], v[140:143], v[120:123]
    v_add_u32 v4, s43, v9
    v_add_u32 v5, s43, v10
    v_mfma_f32_16x16x32_bf16 v[124:127], v[156:159], v[140:143], v[124:127]
    v_add_u32 v6, s43, v11
    s_waitcnt lgkmcnt(9)
    v_mfma_f32_16x16x32_bf16 v[64:67], v[176:179], v[160:163], v[64:67]
    s_waitcnt lgkmcnt(8)
    v_mfma_f32_16x16x32_bf16 v[68:71], v[180:183], v[160:163], v[68:71]
    s_cmp_eq_u32 s24, 0
    s_cbranch_scc1 G2_np
    s_waitcnt vmcnt(0)
    s_mov_b64 exec, 1
    v_mov_b32 v30, s3
    v_mov_b32 v31, 0
    buffer_store_dword v30, v31, s[28:31], s24 offen sc1
    s_mov_b64 exec, -1
    s_mov_b32 s24, 0
G2_np:
    s_waitcnt lgkmcnt(0)
    s_barrier
    ds_read_b64_tr_b16 v[128:129], v2 offset:0
    v_mfma_f32_16x16x32_bf16 v[72:75], v[184:187], v[160:163], v[72:75]
    ds_read_b64_tr_b16 v[130:131], v2 offset:1024
    v_mfma_f32_16x16x32_bf16 v[76:79], v[188:191], v[160:163], v[76:79]
    ds_read_b128 v[144:147], v6 offset:0
    v_mfma_f32_16x16x32_bf16 v[80:83], v[176:179], v[164:167], v[80:83]
    ds_read_b128 v[148:151], v6 offset:256
    v_mfma_f32_16x16x32_bf16 v[84:87], v[180:183], v[164:167], v[84:87]
    ds_read_b128 v[152:155], v6 offset:512
    v_mfma_f32_16x16x32_bf16 v[88:91], v[184:187], v[164:167], v[88:91]
    ds_read_b128 v[156:159], v6 offset:768
    v_mfma_f32_16x16x32_bf16 v[92:95], v[188:191], v[164:167], v[92:95]
    ds_read_b64_tr_b16 v[132:133], v3 offset:0
    v_mfma_f32_16x16x32_bf16 v[96:99], v[176:179], v[168:171], v[96:99]
    ds_read_b64_tr_b16 v[134:135], v3 offset:1024
    v_mfma_f32_16x16x32_bf16 v[100:103], v[180:183], v[168:171], v[100:103]
    ds_read_b64_tr_b16 v[136:137], v4 offset:0
    v_mfma_f32_16x16x32_bf16 v[104:107], v[184:187], v[168:171], v[104:107]
    ds_read_b64_tr_b16 v[138:139], v4 offset:1024
    v_mfma_f32_16x16x32_bf16 v[108:111], v[188:191], v[168:171], v[108:111]
    ds_read_b64_tr_b16 v[140:141], v5 offset:0
    v_mfma_f32_16x16x32_bf16 v[112:115], v[176:179], v[172:175], v[112:115]
    ds_read_b64_tr_b16 v[142:143], v5 offset:1024
    v_mfma_f32_16x16x32_bf16 v[116:119], v[180:183], v[172:175], v[116:119]
    v_mfma_f32_16x16x32_bf16 v[120:123], v[184:187], v[172:175], v[120:123]
    s_cmp_lg_u32 s44, 0
    v_mfma_f32_16x16x32_bf16 v[124:127], v[188:191], v[172:175], v[124:127]
    s_cbranch_scc1 G2_loop
    s_waitcnt lgkmcnt(9)
    v_mfma_f32_16x16x32_bf16 v[64:67], v[144:147], v[128:131], v[64:67]
    ds_read_b64_tr_b16 v[160:161], v2 offset:8192
    s_waitcnt lgkmcnt(9)
    v_mfma_f32_16x16x32_bf16 v[68:71], v[148:151], v[128:131], v[68:71]
    ds_read_b64_tr_b16 v[162:163], v2 offset:9216
    s_waitcnt lgkmcnt(9)
    v_mfma_f32_16x16x32_bf16 v[72:75], v[152:155], v[128:131], v[72:75]
    ds_read_b128 v[176:179], v6 offset:8192
    s_waitcnt lgkmcnt(9)
    v_mfma_f32_16x16x32_bf16 v[76:79], v[156:159], v[128:131], v[76:79]
    ds_read_b128 v[180:183], v6 offset:8448
    s_waitcnt lgkmcnt(8)
    v_mfma_f32_16x16x32_bf16 v[80:83], v[144:147], v[132:135], v[80:83]
    ds_read_b128 v[184:187], v6 offset:8704
    v_mfma_f32_16x16x32_bf16 v[84:87], v[148:151], v[132:135], v[84:87]
    ds_read_b128 v[188:191], v6 offset:8960
    v_mfma_f32_16x16x32_bf16 v[88:91], v[152:155], v[132:135], v[88:91]
    ds_read_b64_tr_b16 v[164:165], v3 offset:8192
    v_mfma_f32_16x16x32_bf16 v[92:95], v[156:159], v[132:135], v[92:95]
    ds_read_b64_tr_b16 v[166:167], v3 offset:9216
    s_waitcnt lgkmcnt(10)
    v_mfma_f32_16x16x32_bf16 v[96:99], v[144:147], v[136:139], v[96:99]
    ds_read_b64_tr_b16 v[168:169], v4 offset:8192
    v_mfma_f32_16x16x32_bf16 v[100:103], v[148:151], v[136:139], v[100:103]
    ds_read_b64_tr_b16 v[170:171], v4 offset:9216
    v_mfma_f32_16x16x32_bf16 v[104:107], v[152:155], v[136:139], v[104:107]
    ds_read_b64_tr_b16 v[172:173], v5 offset:8192
    v_mfma_f32_16x16x32_bf16 v[108:111], v[156:159], v[136:139], v[108:111]
    ds_read_b64_tr_b16 v[174:175], v5 offset:9216
    s_waitcnt lgkmcnt(12)
    v_mfma_f32_16x16x32_bf16 v[112:115], v[144:147], v[140:143], v[112:115]
    v_mfma_f32_16x16x32_bf16 v[116:119], v[148:151], v[140:143], v[116:119]
    v_mfma_f32_16x16x32_bf16 v[120:123], v[152:155], v[140:143], v[120:123]
    v_mfma_f32_16x16x32_bf16 v[124:127], v[156:159], v[140:143], v[124:127]
    s_waitcnt lgkmcnt(9)
    v_mfma_f32_16x16x32_bf16 v[64:67], v[176:179], v[160:163], v[64:67]
    s_waitcnt lgkmcnt(8)
    v_mfma_f32_16x16x32_bf16 v[68:71], v[180:183], v[160:163], v[68:71]
    s_waitcnt lgkmcnt(7)
    v_mfma_f32_16x16x32_bf16 v[72:75], v[184:187], v[160:163], v[72:75]
    s_waitcnt lgkmcnt(6)
    v_mfma_f32_16x16x32_bf16 v[76:79], v[188:191], v[160:163], v[76:79]
    s_waitcnt lgkmcnt(4)
    v_mfma_f32_16x16x32_bf16 v[80:83], v[176:179], v[164:167], v[80:83]
    v_mfma_f32_16x16x32_bf16 v[84:87], v[180:183], v[164:167], v[84:87]
    v_mfma_f32_16x16x32_bf16 v[88:91], v[184:187], v[164:167], v[88:91]
    v_mfma_f32_16x16x32_bf16 v[92:95], v[188:191], v[164:167], v[92:95]
    s_waitcnt lgkmcnt(2)
    v_mfma_f32_16x16x32_bf16 v[96:99], v[176:179], v[168:171], v[96:99]
    v_mfma_f32_16x16x32_bf16 v[100:103], v[180:183], v[168:171], v[100:103]
    v_mfma_f32_16x16x32_bf16 v[104:107], v[184:187], v[168:171], v[104:107]
    v_mfma_f32_16x16x32_bf16 v[108:111], v[188:191], v[168:171], v[108:111]
    s_waitcnt lgkmcnt(0)
    v_mfma_f32_16x16x32_bf16 v[112:115], v[176:179], v[172:175], v[112:115]
    v_mfma_f32_16x16x32_bf16 v[116:119], v[180:183], v[172:175], v[116:119]
    v_mfma_f32_16x16x32_bf16 v[120:123], v[184:187], v[172:175], v[120:123]
    v_mfma_f32_16x16x32_bf16 v[124:127], v[188:191], v[172:175], v[124:127]
    v_cvt_pk_bf16_f32 v64, v64, v65
    v_cvt_pk_bf16_f32 v65, v66, v67
    ds_write_b64 v20, v[64:65] offset:0
    v_cvt_pk_bf16_f32 v68, v68, v69
    v_cvt_pk_bf16_f32 v69, v70, v71
    ds_write_b64 v25, v[68:69] offset:0
    v_cvt_pk_bf16_f32 v72, v72, v73
    v_cvt_pk_bf16_f32 v73, v74, v75
    ds_write_b64 v26, v[72:73] offset:0
    v_cvt_pk_bf16_f32 v76, v76, v77
    v_cvt_pk_bf16_f32 v77, v78, v79
    ds_write_b64 v27, v[76:77] offset:0
    ds_read_b128 v[128:131], v21 offset:0
    ds_read_b128 v[132:135], v21 offset:1024
    v_cvt_pk_bf16_f32 v80, v80, v81
    v_cvt_pk_bf16_f32 v81, v82, v83
    ds_write_b64 v20, v[80:81] offset:2048
    v_cvt_pk_bf16_f32 v84, v84, v85
    v_cvt_pk_bf16_f32 v85, v86, v87
    ds_write_b64 v25, v[84:85] offset:2048
    v_cvt_pk_bf16_f32 v88, v88, v89
    v_cvt_pk_bf16_f32 v89, v90, v91
    ds_write_b64 v26, v[88:89] offset:2048
    v_cvt_pk_bf16_f32 v92, v92, v93
    v_cvt_pk_bf16_f32 v93, v94, v95
    ds_write_b64 v27, v[92:93] offset:2048
    ds_read_b128 v[136:139], v21 offset:2048
    ds_read_b128 v[140:143], v21 offset:3072
    s_waitcnt lgkmcnt(7)
    buffer_store_dwordx4 v[128:131], v18, s[28:31], s16 offen sc1
    s_add_u32 s16, s16, 16384
    s_waitcnt lgkmcnt(6)
    buffer_store_dwordx4 v[132:135], v18, s[28:31], s16 offen sc1
    s_add_u32 s16, s16, 16384
    v_cvt_pk_bf16_f32 v96, v96, v97
    v_cvt_pk_bf16_f32 v97, v98, v99
    ds_write_b64 v20, v[96:97] offset:4096
    v_cvt_pk_bf16_f32 v100, v100, v101
    v_cvt_pk_bf16_f32 v101, v102, v103
    ds_write_b64 v25, v[100:101] offset:4096
    v_cvt_pk_bf16_f32 v104, v104, v105
    v_cvt_pk_bf16_f32 v105, v106, v107
    ds_write_b64 v26, v[104:105] offset:4096
    v_cvt_pk_bf16_f32 v108, v108, v109
    v_cvt_pk_bf16_f32 v109, v110, v111
    ds_write_b64 v27, v[108:109] offset:4096
    ds_read_b128 v[144:147], v21 offset:4096
    ds_read_b128 v[148:151], v21 offset:5120
    s_waitcnt lgkmcnt(7)
    buffer_store_dwordx4 v[136:139], v18, s[28:31], s16 offen sc1
    s_add_u32 s16, s16, 16384
    s_waitcnt lgkmcnt(6)
    buffer_store_dwordx4 v[140:143], v18, s[28:31], s16 offen sc1
    s_add_u32 s16, s16, 16384
    v_cvt_pk_bf16_f32 v112, v112, v113
    v_cvt_pk_bf16_f32 v113, v114, v115
    ds_write_b64 v20, v[112:113] offset:6144
    v_cvt_pk_bf16_f32 v116, v116, v117
    v_cvt_pk_bf16_f32 v117, v118, v119
    ds_write_b64 v25, v[116:117] offset:6144
    v_cvt_pk_bf16_f32 v120, v120, v121
    v_cvt_pk_bf16_f32 v121, v122, v123
    ds_write_b64 v26, v[120:121] offset:6144
    v_cvt_pk_bf16_f32 v124, v124, v125
    v_cvt_pk_bf16_f32 v125, v126, v127
    ds_write_b64 v27, v[124:125] offset:6144
    ds_read_b128 v[152:155], v21 offset:6144
    ds_read_b128 v[156:159], v21 offset:7168
    s_waitcnt lgkmcnt(7)
    buffer_store_dwordx4 v[144:147], v18, s[28:31], s16 offen sc1
    s_add_u32 s16, s16, 16384
    s_waitcnt lgkmcnt(6)
    buffer_store_dwordx4 v[148:151], v18, s[28:31], s16 offen sc1
    s_add_u32 s16, s16, 16384
    s_waitcnt lgkmcnt(1)
    buffer_store_dwordx4 v[152:155], v18, s[28:31], s16 offen sc1
    s_add_u32 s16, s16, 16384
    s_waitcnt lgkmcnt(0)
    buffer_store_dwordx4 v[156:159], v18, s[28:31], s16 offen sc1
    s_waitcnt vmcnt(0)
    s_mov_b64 exec, 1
    ds_add_rtn_u32 v24, v16, v17 offset:40
    s_waitcnt lgkmcnt(0)
    v_cmp_ne_u32 vcc, 3, v24
    s_cbranch_vccnz G2_end
    s_mov_b64 exec, 0xff
    v_mov_b32 v24, s3
    buffer_store_dword v24, v19, s[28:31], s17 offen sc1
    s_mov_b64 exec, -1
G2_end:
    s_endpgm
L_entry:
    s_setprio 2
    s_getpc_b64 s[40:41]
TABPC_l:
    s_add_u32 s40, s40, fft_tables-TABPC_l
    s_addc_u32 s41, s41, 0
    s_and_b32 s41, s41, 0xffff
    s_mov_b32 s42, 0x9000
    s_mov_b32 s43, 0x20000
    s_and_b32 s13, s12, 3
    s_lshl_b32 s14, s13, 12
    s_add_u32 m0, s14, 65536
    s_nop 0
    buffer_load_dwordx4 v2, s[40:43], s14 offen offset:0 lds
    buffer_load_dwordx4 v2, s[40:43], s14 offen offset:1024 lds
    buffer_load_dwordx4 v2, s[40:43], s14 offen offset:2048 lds
    buffer_load_dwordx4 v2, s[40:43], s14 offen offset:3072 lds
    s_and_b32 s15, s13, 1
    s_lshr_b32 s16, s13, 1
    s_and_b32 s17, s2, 3
    s_bfe_u32 s18, s2, 0x30002
    s_lshr_b32 s19, s2, 5
    s_xor_b32 s19, s19, 7
    s_lshl_b32 s20, s17, 1
    s_add_u32 s20, s20, s16
    s_lshl_b32 s20, s20, 2
    s_lshl_b32 s21, s18, 1
    s_add_u32 s21, s21, s15
    s_lshl_b32 s21, s21, 6
    s_add_u32 s21, s21, s20
    s_mul_i32 s21, s21, 1026
    s_lshl_b32 s22, s19, 7
    s_add_u32 s22, s22, s21
    s_add_u32 s23, s22, 1050624
    v_bfe_u32 v26, v1, 3, 2
    v_lshrrev_b32 v27, 5, v1
    v_lshl_add_u32 v26, v27, 5, v26
    v_mul_u32_u24 v26, 1026, v26
    v_and_b32 v27, 7, v1
    v_lshl_add_u32 v26, v27, 4, v26
    s_waitcnt lgkmcnt(0)
    s_mov_b32 s32, s6
    s_and_b32 s33, s7, 0xffff
    s_mov_b32 s34, 0x201000
    s_mov_b32 s35, 0x20000
    s_mov_b32 s36, s8
    s_and_b32 s37, s9, 0xffff
    s_mov_b32 s38, 0x201000
    s_mov_b32 s39, 0x20000
    buffer_load_dwordx4 v[36:39], v26, s[32:35], s22 offen nt
    buffer_load_dwordx4 v[40:43], v26, s[36:39], s22 offen nt
    buffer_load_dwordx4 v[44:47], v26, s[32:35], s23 offen nt
    buffer_load_dwordx4 v[48:51], v26, s[36:39], s23 offen nt
    v_mov_b32 v12, 155648
    v_mov_b32 v13, 1
    v_mov_b32 v14, 0
    v_mov_b32 v15, 0
    ds_write_b64 v12, v[14:15] offset:0
    ds_write_b64 v12, v[14:15] offset:8
    ds_write_b64 v12, v[14:15] offset:16
    ds_write_b64 v12, v[14:15] offset:24
    ds_write_b64 v12, v[14:15] offset:32
    ds_write_b64 v12, v[14:15] offset:40
    ds_write_b64 v12, v[14:15] offset:48
    ds_write_b64 v12, v[14:15] offset:56
    ds_write_b64 v12, v[14:15] offset:64
    ds_write_b64 v12, v[14:15] offset:72
    ds_write_b64 v12, v[14:15] offset:80
    ds_write_b64 v12, v[14:15] offset:88
    s_mov_b32 s28, s10
    s_and_b32 s29, s11, 0xffff
    s_mov_b32 s30, 0x3200000
    s_mov_b32 s31, 0x20000
    s_add_u32 s10, s10, 0x3000040
    s_addc_u32 s11, s11, 0
    s_load_dword s3, s[10:11], 0
    s_load_dwordx2 s[6:7], s[0:1], 48
    s_load_dwordx2 s[8:9], s[0:1], 64
    s_lshr_b32 s48, s18, 1
    s_lshl_b32 s48, s48, 1
    s_add_u32 s48, s48, s15
    s_lshl_b32 s48, s48, 10
    s_and_b32 s49, s18, 1
    s_lshl_b32 s49, s49, 5
    s_add_u32 s49, s49, s20
    s_lshl_b32 s49, s49, 4
    s_add_u32 s48, s48, s49
    s_lshl_b32 s48, s48, 1
    s_add_u32 s48, s48, 0x900000
    s_mul_i32 s49, s13, 6144
    s_add_u32 s49, s49, 131072
    v_lshrrev_b32 v28, 3, v1
    v_mul_u32_u24 v28, 192, v28
    v_lshl_add_u32 v28, v27, 4, v28
    v_add_u32 v28, s49, v28
    v_mul_u32_u24 v29, 192, v4
    v_lshl_add_u32 v29, v3, 5, v29
    v_lshl_add_u32 v29, v5, 3, v29
    v_add_u32 v29, s49, v29
    v_lshlrev_b32 v30, 5, v1
    v_add_u32 v30, s49, v30
    v_lshl_add_u32 v31, v3, 2, v5
    v_lshlrev_b32 v31, 5, v31
    v_lshl_add_u32 v31, v4, 3, v31
    v_add_u32 v31, s49, v31
    v_lshrrev_b32 v32, 3, v1
    v_mul_u32_u24 v32, 0x4000, v32
    v_and_b32 v33, 7, v1
    v_lshl_add_u32 v32, v33, 4, v32
    s_mov_b32 s53, s19
    s_waitcnt vmcnt(4) lgkmcnt(0)
    s_barrier
    s_load_dwordx2 s[10:11], s[0:1], 56
    s_add_u32 s3, s3, 1
    s_waitcnt vmcnt(0)
    s_cmp_lg_u32 s19, 0
    s_cbranch_scc1 WJ_l0
    s_add_u32 m0, s14, 0
    s_add_u32 s16, s14, 16384
    buffer_load_dwordx4 v2, s[40:43], s16 offen offset:0 lds
    buffer_load_dwordx4 v2, s[40:43], s16 offen offset:1024 lds
    buffer_load_dwordx4 v2, s[40:43], s16 offen offset:2048 lds
    buffer_load_dwordx4 v2, s[40:43], s16 offen offset:3072 lds
WJ_l0:
    s_cmp_lg_u32 s19, 7
    s_cbranch_scc1 WJ_nl
    s_mov_b32 exec_lo, 0x80808080
    s_mov_b32 exec_hi, 0x80808080
    buffer_load_ushort v52, v26, s[32:35], s22 offen offset:16 nt
    buffer_load_ushort v53, v26, s[36:39], s22 offen offset:16 nt
    buffer_load_ushort v54, v26, s[32:35], s23 offen offset:16 nt
    buffer_load_ushort v55, v26, s[36:39], s23 offen offset:16 nt
    s_mov_b64 exec, -1
WJ_nl:
    ds_write_b128 v28, v[36:39] offset:0
    ds_write_b128 v28, v[40:43] offset:1536
    ds_write_b128 v28, v[44:47] offset:3072
    ds_write_b128 v28, v[48:51] offset:4608
    s_add_u32 s50, s48, 0x400000
    ds_read_b64_tr_b16 v[96:97], v29 offset:0
    ds_read_b64_tr_b16 v[98:99], v29 offset:768
    ds_read_b64_tr_b16 v[100:101], v29 offset:1536
    ds_read_b64_tr_b16 v[102:103], v29 offset:2304
    ds_read_b64_tr_b16 v[104:105], v29 offset:3072
    ds_read_b64_tr_b16 v[106:107], v29 offset:3840
    ds_read_b64_tr_b16 v[108:109], v29 offset:4608
    ds_read_b64_tr_b16 v[110:111], v29 offset:5376
    s_waitcnt lgkmcnt(0)
    ds_write_b64 v30, v[96:97] offset:0
    ds_write_b64 v30, v[98:99] offset:2048
    ds_write_b64 v30, v[100:101] offset:8
    ds_write_b64 v30, v[102:103] offset:2056
    ds_write_b64 v30, v[104:105] offset:16
    ds_write_b64 v30, v[106:107] offset:2064
    ds_write_b64 v30, v[108:109] offset:24
    ds_write_b64 v30, v[110:111] offset:2072
    ds_read_b64_tr_b16 v[112:113], v31 offset:0
    ds_read_b64_tr_b16 v[114:115], v31 offset:2048
    ds_read_b64_tr_b16 v[116:117], v31 offset:512
    ds_read_b64_tr_b16 v[118:119], v31 offset:2560
    ds_read_b64_tr_b16 v[120:121], v31 offset:1024
    ds_read_b64_tr_b16 v[122:123], v31 offset:3072
    ds_read_b64_tr_b16 v[124:125], v31 offset:1536
    ds_read_b64_tr_b16 v[126:127], v31 offset:3584
    s_mul_i32 s49, s53, 0x80000
    s_add_u32 s48, s48, s49
    s_waitcnt lgkmcnt(6)
    buffer_store_dwordx4 v[112:115], v32, s[28:31], s48 offen sc1
    s_add_u32 s48, s48, 0x20000
    s_waitcnt lgkmcnt(4)
    buffer_store_dwordx4 v[116:119], v32, s[28:31], s48 offen sc1
    s_add_u32 s48, s48, 0x20000
    s_waitcnt lgkmcnt(2)
    buffer_store_dwordx4 v[120:123], v32, s[28:31], s48 offen sc1
    s_add_u32 s48, s48, 0x20000
    s_waitcnt lgkmcnt(0)
    buffer_store_dwordx4 v[124:127], v32, s[28:31], s48 offen sc1
    s_mov_b32 s24, s44
    s_and_b32 s25, s45, 0xffff
    s_mov_b32 s26, 0xe00000
    s_mov_b32 s27, 0x20000
    s_mov_b32 s15, 16384
    s_mov_b32 s16, 20480
    s_mov_b64 s[20:21], s[40:41]
    s_mov_b32 s22, s42
    s_mov_b32 s23, 0x20000
    s_mov_b32 s42, s14
    s_lshl_b32 s17, s58, 8
    s_lshl_b32 s18, s57, 19
    v_lshrrev_b32 v24, 4, v1
    v_lshlrev_b32 v25, 2, v24
    v_xor_b32 v25, v25, v1
    v_and_b32 v25, 15, v25
    v_lshlrev_b32 v25, 4, v25
    s_lshr_b32 s40, s42, 12
    v_and_b32 v246, 1, v24
    v_lshrrev_b32 v24, 1, v24
    v_lshl_add_u32 v24, v24, 6, v246
    s_mul_i32 s41, s40, 28672
    s_add_u32 s41, s41, s17
    v_mul_u32_u24 v24, 7168, v24
    v_add3_u32 v246, v24, v25, s41
    v_xor_b32 v25, 32, v25
    v_add3_u32 v25, v24, v25, s41
    v_add_u32 v247, 0xdfc00, v246
    v_add_u32 v248, 0x3000, v25
    v_add_u32 v249, 0xe2c00, v25
    s_add_u32 s41, s42, s18
    v_lshlrev_b32 v245, 4, v1
    v_add_u32 v245, s41, v245
    s_cmp_lg_u32 s59, 0
    s_cbranch_scc1 G1_phi0
    s_mov_b32 s68, 0x8040100
    s_mov_b32 s60, 0x20100100
    s_mov_b32 s69, 0x6050302
    s_mov_b32 s61, 0x12110302
    s_mov_b32 s70, 0x100c0907
    s_mov_b32 s62, 0x40302113
    s_mov_b32 s71, 0xe0d0b0a
    s_mov_b32 s63, 0x32312322
    s_mov_b32 s72, 0x1814110f
    s_mov_b32 s64, 0x60504133
    s_mov_b32 s73, 0x16151312
    s_mov_b32 s65, 0x52514342
    s_mov_b32 s74, 0x1a1c1917
    s_mov_b32 s66, 0x62706153
    s_mov_b32 s75, 0x1f1e1d1b
    s_mov_b32 s67, 0x73727163
G1_phi0:
    s_cmp_lg_u32 s59, 1
    s_cbranch_scc1 G1_phi1
    s_mov_b32 s68, 0x5020001
    s_mov_b32 s60, 0x11020001
    s_mov_b32 s69, 0x6040309
    s_mov_b32 s61, 0x12100321
    s_mov_b32 s70, 0xd0a0807
    s_mov_b32 s62, 0x31222013
    s_mov_b32 s71, 0xe0c0b11
    s_mov_b32 s63, 0x32302341
    s_mov_b32 s72, 0x1512100f
    s_mov_b32 s64, 0x51424033
    s_mov_b32 s73, 0x16141319
    s_mov_b32 s65, 0x52504361
    s_mov_b32 s74, 0x1d1a1817
    s_mov_b32 s66, 0x71626053
    s_mov_b32 s75, 0x1f1e1c1b
    s_mov_b32 s67, 0x73727063
G1_phi1:
    s_cmp_lg_u32 s59, 2
    s_cbranch_scc1 G1_phi2
    s_mov_b32 s68, 0x3010002
    s_mov_b32 s60, 0x3010002
    s_mov_b32 s69, 0x5040a06
    s_mov_b32 s61, 0x11102212
    s_mov_b32 s70, 0xb090807
    s_mov_b32 s62, 0x23212013
    s_mov_b32 s71, 0xd0c120e
    s_mov_b32 s63, 0x31304232
    s_mov_b32 s72, 0x1311100f
    s_mov_b32 s64, 0x43414033
    s_mov_b32 s73, 0x15141a16
    s_mov_b32 s65, 0x51506252
    s_mov_b32 s74, 0x1b191817
    s_mov_b32 s66, 0x63616053
    s_mov_b32 s75, 0x1f1d1c1e
    s_mov_b32 s67, 0x73717072
G1_phi2:
    s_cmp_lg_u32 s59, 3
    s_cbranch_scc1 G1_phi3
    s_mov_b32 s68, 0x2010003
    s_mov_b32 s60, 0x2010003
    s_mov_b32 s69, 0x50b0704
    s_mov_b32 s61, 0x11231310
    s_mov_b32 s70, 0xa090806
    s_mov_b32 s62, 0x22212012
    s_mov_b32 s71, 0xd130f0c
    s_mov_b32 s63, 0x31433330
    s_mov_b32 s72, 0x1211100e
    s_mov_b32 s64, 0x42414032
    s_mov_b32 s73, 0x151b1714
    s_mov_b32 s65, 0x51635350
    s_mov_b32 s74, 0x1a191816
    s_mov_b32 s66, 0x62616052
    s_mov_b32 s75, 0x1e1d1f1c
    s_mov_b32 s67, 0x72717370
G1_phi3:
    s_cmp_lg_u32 s59, 4
    s_cbranch_scc1 G1_phi4
    s_mov_b32 s68, 0x2010400
    s_mov_b32 s60, 0x2011000
    s_mov_b32 s69, 0xc080503
    s_mov_b32 s61, 0x30201103
    s_mov_b32 s70, 0xa090706
    s_mov_b32 s62, 0x22211312
    s_mov_b32 s71, 0x14100d0b
    s_mov_b32 s63, 0x50403123
    s_mov_b32 s72, 0x12110f0e
    s_mov_b32 s64, 0x42413332
    s_mov_b32 s73, 0x1c181513
    s_mov_b32 s65, 0x70605143
    s_mov_b32 s74, 0x1a191716
    s_mov_b32 s66, 0x62615352
    s_mov_b32 s75, 0x1f1e1d1b
    s_mov_b32 s67, 0x73727163
G1_phi4:
    s_cmp_lg_u32 s59, 5
    s_cbranch_scc1 G1_phi5
    s_mov_b32 s68, 0x2000501
    s_mov_b32 s60, 0x2001101
    s_mov_b32 s69, 0x9060403
    s_mov_b32 s61, 0x21121003
    s_mov_b32 s70, 0xa08070d
    s_mov_b32 s62, 0x22201331
    s_mov_b32 s71, 0x110e0c0b
    s_mov_b32 s63, 0x41323023
    s_mov_b32 s72, 0x12100f15
    s_mov_b32 s64, 0x42403351
    s_mov_b32 s73, 0x19161413
    s_mov_b32 s65, 0x61525043
    s_mov_b32 s74, 0x1a18171d
    s_mov_b32 s66, 0x62605371
    s_mov_b32 s75, 0x1f1e1c1b
    s_mov_b32 s67, 0x73727063
G1_phi5:
    s_cmp_lg_u32 s59, 6
    s_cbranch_scc1 G1_phi6
    s_mov_b32 s68, 0x1000602
    s_mov_b32 s60, 0x1001202
    s_mov_b32 s69, 0x7050403
    s_mov_b32 s61, 0x13111003
    s_mov_b32 s70, 0x9080e0a
    s_mov_b32 s62, 0x21203222
    s_mov_b32 s71, 0xf0d0c0b
    s_mov_b32 s63, 0x33313023
    s_mov_b32 s72, 0x11101612
    s_mov_b32 s64, 0x41405242
    s_mov_b32 s73, 0x17151413
    s_mov_b32 s65, 0x53515043
    s_mov_b32 s74, 0x19181e1a
    s_mov_b32 s66, 0x61607262
    s_mov_b32 s75, 0x1f1d1c1b
    s_mov_b32 s67, 0x73717063
G1_phi6:
    s_cmp_lg_u32 s59, 7
    s_cbranch_scc1 G1_phi7
    s_mov_b32 s68, 0x1070300
    s_mov_b32 s60, 0x1130300
    s_mov_b32 s69, 0x6050402
    s_mov_b32 s61, 0x12111002
    s_mov_b32 s70, 0x90f0b08
    s_mov_b32 s62, 0x21332320
    s_mov_b32 s71, 0xe0d0c0a
    s_mov_b32 s63, 0x32313022
    s_mov_b32 s72, 0x11171310
    s_mov_b32 s64, 0x41534340
    s_mov_b32 s73, 0x16151412
    s_mov_b32 s65, 0x52515042
    s_mov_b32 s74, 0x191f1b18
    s_mov_b32 s66, 0x61736360
    s_mov_b32 s75, 0x1e1d1c1a
    s_mov_b32 s67, 0x72717062
G1_phi7:
    s_cmp_ge_u32 s2, 224
    s_cbranch_scc1 LA_col
    s_mov_b32 s36, s4
    s_and_b32 s37, s5, 0xffff
    s_mov_b32 s38, 0x400000
    s_mov_b32 s39, 0x20000
    s_and_b32 s18, s2, 31
    s_lshr_b32 s19, s2, 5
    s_lshl_b32 s19, s19, 7
    s_add_u32 s18, s18, s19
    s_lshl_b32 s18, s18, 12
    s_lshl_b32 s19, s42, 5
    s_add_u32 s18, s18, s19
    v_lshlrev_b32 v25, 4, v1
    buffer_load_dwordx4 v[72:75], v25, s[36:39], s18 offen offset:0 nt
    buffer_load_dwordx4 v[76:79], v25, s[36:39], s18 offen offset:1024 nt
    buffer_load_dwordx4 v[80:83], v25, s[36:39], s18 offen offset:2048 nt
    buffer_load_dwordx4 v[84:87], v25, s[36:39], s18 offen offset:3072 nt
    buffer_load_dwordx4 v[160:163], v2, s[20:23], s15 offen offset:0
    buffer_load_dwordx4 v[164:167], v2, s[20:23], s15 offen offset:1024
    buffer_load_dwordx4 v[168:171], v2, s[20:23], s15 offen offset:2048
    buffer_load_dwordx4 v[172:175], v2, s[20:23], s15 offen offset:3072
    buffer_load_dwordx4 v[176:179], v2, s[20:23], s16 offen offset:0
    buffer_load_dwordx4 v[180:183], v2, s[20:23], s16 offen offset:1024
    v_add_u32 v24, 73728, v2
    ds_read_b128 v[192:195], v24 offset:0
    ds_read_b128 v[196:199], v24 offset:1024
    ds_read_b128 v[200:203], v24 offset:2048
    ds_read_b128 v[204:207], v24 offset:3072
    ds_read_b128 v[208:211], v24 offset:4096
    ds_read_b128 v[212:215], v24 offset:5120
    ds_read_b128 v[216:219], v24 offset:6144
    ds_read_b128 v[220:223], v24 offset:7168
    s_waitcnt lgkmcnt(0)
    s_mov_b64 exec, 1
    ds_add_rtn_u32 v24, v12, v13 offset:4
    s_waitcnt lgkmcnt(0)
    v_cmp_ne_u32 vcc, 7, v24
    s_mov_b64 exec, -1
    s_cbranch_vccnz LA_na
    s_lshr_b32 s15, s2, 3
    s_mul_i32 s15, s15, 96
    s_lshl2_add_u32 s15, s2, s15
    s_add_u32 s15, s15, 0x30c0000
    v_lshlrev_b32 v25, 12, v1
    s_mov_b64 exec, 0xff
    v_mov_b32 v24, s3
    buffer_store_dword v24, v25, s[28:31], s15 offen sc1
    s_mov_b64 exec, -1
LA_na:
    s_cmp_lg_u32 s53, 7
    s_cbranch_scc1 WJ_no512
    v_bfe_u32 v34, v1, 3, 2
    v_lshlrev_b32 v34, 4, v34
    v_lshrrev_b32 v35, 5, v1
    v_lshl_add_u32 v34, v35, 3, v34
    s_mov_b32 exec_lo, 0x80808080
    s_mov_b32 exec_hi, 0x80808080
    s_waitcnt vmcnt(10)
    buffer_store_short v52, v34, s[28:31], s50 offen offset:0 sc1
    buffer_store_short v53, v34, s[28:31], s50 offen offset:2 sc1
    buffer_store_short v54, v34, s[28:31], s50 offen offset:4 sc1
    buffer_store_short v55, v34, s[28:31], s50 offen offset:6 sc1
    s_mov_b64 exec, -1
    s_waitcnt vmcnt(0)
WJ_no512:
    s_waitcnt vmcnt(10)
    s_xor_b32 s15, s2, 0xe0
    s_lshl_b32 s15, s15, 4
    s_lshl_b32 s16, s13, 2
    s_add_u32 s15, s15, s16
    s_add_u32 s15, s15, 0x3004000
    s_mov_b64 exec, 1
    v_mov_b32 v24, s3
    v_mov_b32 v25, 0
    buffer_store_dword v24, v25, s[28:31], s15 offen sc1
    s_mov_b64 exec, -1
    s_branch LA_j
LA_col:
    s_waitcnt vmcnt(4)
    s_mov_b64 exec, 1
    ds_add_u32 v12, v13 offset:12
    s_mov_b64 exec, -1
    s_mov_b32 s16, 3200000
LA_ct:
    ds_read_b32 v24, v12 offset:12
    s_sub_u32 s16, s16, 1
    s_cbranch_scc1 LA_ct_out
    s_waitcnt lgkmcnt(0)
    v_cmp_ne_u32 vcc, 4, v24
    s_cbranch_vccnz LA_ct
LA_ct_out:
    v_add_u32 v24, 73728, v2
    ds_read_b128 v[160:163], v2 offset:0
    ds_read_b128 v[164:167], v2 offset:1024
    ds_read_b128 v[168:171], v2 offset:2048
    ds_read_b128 v[172:175], v2 offset:3072
    ds_read_b128 v[176:179], v2 offset:4096
    ds_read_b128 v[180:183], v2 offset:5120
    ds_read_b128 v[184:187], v2 offset:6144
    ds_read_b128 v[188:191], v2 offset:7168
    ds_read_b128 v[192:195], v24 offset:0
    ds_read_b128 v[196:199], v24 offset:1024
    ds_read_b128 v[200:203], v24 offset:2048
    ds_read_b128 v[204:207], v24 offset:3072
    ds_read_b128 v[208:211], v24 offset:4096
    ds_read_b128 v[212:215], v24 offset:5120
    ds_read_b128 v[216:219], v24 offset:6144
    ds_read_b128 v[220:223], v24 offset:7168
    ds_read_b128 v[224:227], v2 offset:8192
    ds_read_b128 v[228:231], v2 offset:9216
    ds_read_b128 v[232:235], v2 offset:10240
    ds_read_b128 v[236:239], v2 offset:11264
    ds_read_b128 v[240:243], v2 offset:12288
    ds_read_b128 v[244:247], v2 offset:13312
    ds_read_b128 v[248:251], v2 offset:14336
    ds_read_b128 v[252:255], v2 offset:15360
    s_waitcnt lgkmcnt(0)
    s_mov_b64 exec, 1
    ds_add_rtn_u32 v24, v12, v13 offset:4
    s_waitcnt lgkmcnt(0)
    v_cmp_ne_u32 vcc, 7, v24
    s_mov_b64 exec, -1
    s_cbranch_vccnz LC_na
    s_lshr_b32 s15, s2, 3
    s_mul_i32 s15, s15, 96
    s_lshl2_add_u32 s15, s2, s15
    s_add_u32 s15, s15, 0x30c0000
    v_lshlrev_b32 v25, 12, v1
    s_mov_b64 exec, 0xff
    v_mov_b32 v24, s3
    buffer_store_dword v24, v25, s[28:31], s15 offen sc1
    s_mov_b64 exec, -1
LC_na:
    s_waitcnt vmcnt(0)
    s_xor_b32 s15, s2, 0xe0
    s_lshl_b32 s15, s15, 4
    s_lshl_b32 s16, s13, 2
    s_add_u32 s15, s15, s16
    s_add_u32 s15, s15, 0x3004000
    s_mov_b64 exec, 1
    v_mov_b32 v24, s3
    v_mov_b32 v25, 0
    buffer_store_dword v24, v25, s[28:31], s15 offen sc1
    s_mov_b64 exec, -1
    s_mov_b32 s36, s4
    s_and_b32 s37, s5, 0xffff
    s_mov_b32 s38, 0x400000
    s_mov_b32 s39, 0x20000
    s_and_b32 s18, s2, 31
    s_lshr_b32 s19, s2, 5
    s_lshl_b32 s19, s19, 7
    s_add_u32 s18, s18, s19
    s_lshl_b32 s18, s18, 12
    s_lshl_b32 s19, s42, 5
    s_add_u32 s18, s18, s19
    v_lshlrev_b32 v25, 4, v1
    s_add_u32 m0, s42, 131072
    s_nop 0
    buffer_load_dwordx4 v25, s[36:39], s18 offen offset:0 nt lds
    buffer_load_dwordx4 v25, s[36:39], s18 offen offset:1024 nt lds
    buffer_load_dwordx4 v25, s[36:39], s18 offen offset:2048 nt lds
    buffer_load_dwordx4 v25, s[36:39], s18 offen offset:3072 nt lds
    s_setprio 0
    s_branch COL_j
LA_j:
    s_setprio 0
    s_mov_b32 s16, 3200000
LA_own:
    ds_read_b32 v24, v12 offset:4
    s_sub_u32 s16, s16, 1
    s_cbranch_scc1 LA_own_out
    s_waitcnt lgkmcnt(0)
    v_cmp_ne_u32 vcc, 8, v24
    s_cbranch_vccnz LA_own
LA_own_out:
    s_bfe_u32 s43, s60, 0x80000
    s_mul_i32 s43, s43, 114688
    s_add_u32 m0, s42, 0
    s_nop 0
    buffer_load_dwordx4 v246, s[24:27], s43 offen offset:0  lds
    buffer_load_dwordx4 v247, s[24:27], s43 offen offset:1024  lds
    buffer_load_dwordx4 v248, s[24:27], s43 offen offset:2048  lds
    buffer_load_dwordx4 v249, s[24:27], s43 offen offset:3072  lds
    s_bfe_u32 s43, s60, 0x80008
    s_mul_i32 s43, s43, 114688
    s_add_u32 m0, s42, 16384
    s_nop 0
    buffer_load_dwordx4 v246, s[24:27], s43 offen offset:0  lds
    buffer_load_dwordx4 v247, s[24:27], s43 offen offset:1024  lds
    buffer_load_dwordx4 v248, s[24:27], s43 offen offset:2048  lds
    buffer_load_dwordx4 v249, s[24:27], s43 offen offset:3072  lds
    s_bfe_u32 s43, s60, 0x80010
    s_mul_i32 s43, s43, 114688
    s_add_u32 m0, s42, 32768
    s_nop 0
    buffer_load_dwordx4 v246, s[24:27], s43 offen offset:0  lds
    buffer_load_dwordx4 v247, s[24:27], s43 offen offset:1024  lds
    buffer_load_dwordx4 v248, s[24:27], s43 offen offset:2048  lds
    buffer_load_dwordx4 v249, s[24:27], s43 offen offset:3072  lds
    s_bfe_u32 s43, s60, 0x80018
    s_mul_i32 s43, s43, 114688
    s_add_u32 m0, s42, 49152
    s_nop 0
    buffer_load_dwordx4 v246, s[24:27], s43 offen offset:0  lds
    buffer_load_dwordx4 v247, s[24:27], s43 offen offset:1024  lds
    buffer_load_dwordx4 v248, s[24:27], s43 offen offset:2048  lds
    buffer_load_dwordx4 v249, s[24:27], s43 offen offset:3072  lds
    v_lshrrev_b32 v21, 1, v1
    v_mul_u32_u24 v21, 96, v21
    v_add_u32 v21, v21, v2
    s_lshl_b32 s53, s54, 12
    s_add_u32 s53, s53, 0x30c0000
    s_cmp_eq_u32 s12, 4
    s_cselect_b64 s[22:23], -1, 0
    s_cmp_lg_u32 s12, 4
    s_cbranch_scc1 LGg1_0_a
    s_cmp_eq_u64 s[22:23], 0
    s_cbranch_scc1 GDg1_0_ok
    s_bfe_u32 s44, s68, 0x80000
    s_lshl_b32 s44, s44, 1
    s_mov_b32 s15, 200000
GDg1_0:
    s_lshr_b64 s[16:17], s[22:23], s44
    s_and_b32 s16, s16, 3
    s_cbranch_scc0 GDg1_0_ok
    buffer_load_dwordx4 v[24:27], v21, s[28:31], s53 offen sc1
    s_waitcnt vmcnt(0)
    v_xor_b32 v24, s3, v24
    v_xor_b32 v25, s3, v25
    v_xor_b32 v26, s3, v26
    v_xor_b32 v27, s3, v27
    v_or3_b32 v24, v24, v25, v26
    v_or_b32 v24, v24, v27
    v_cmp_ne_u32 vcc, 0, v24
    s_sub_u32 s15, s15, 1
    s_cselect_b64 s[22:23], 0, vcc
    s_branch GDg1_0
GDg1_0_ok:
    v_mov_b32 v24, 1
    ds_write_b32 v12, v24 offset:8
    s_branch LGg1_0_b
LGg1_0_a:
    s_mov_b32 s16, 3200000
LGg1_0_s:
    ds_read_b32 v24, v12 offset:8
    s_sub_u32 s16, s16, 1
    s_cbranch_scc1 LGg1_0_s_out
    s_waitcnt lgkmcnt(0)
    v_cmp_gt_u32 vcc, 1, v24
    s_cbranch_vccnz LGg1_0_s
LGg1_0_s_out:
LGg1_0_b:
    s_bfe_u32 s44, s68, 0x80000
    s_lshl_b32 s44, s44, 14
    s_add_u32 m0, s42, 65536
    s_nop 0
    buffer_load_dwordx4 v245, s[28:31], s44 offen offset:0 sc1 lds
    buffer_load_dwordx4 v245, s[28:31], s44 offen offset:1024 sc1 lds
    buffer_load_dwordx4 v245, s[28:31], s44 offen offset:2048 sc1 lds
    buffer_load_dwordx4 v245, s[28:31], s44 offen offset:3072 sc1 lds
    s_cmp_lg_u32 s12, 4
    s_cbranch_scc1 LGg1_1_a
    s_cmp_eq_u64 s[22:23], 0
    s_cbranch_scc1 GDg1_1_ok
    s_bfe_u32 s44, s68, 0x80008
    s_lshl_b32 s44, s44, 1
    s_mov_b32 s15, 200000
GDg1_1:
    s_lshr_b64 s[16:17], s[22:23], s44
    s_and_b32 s16, s16, 3
    s_cbranch_scc0 GDg1_1_ok
    buffer_load_dwordx4 v[24:27], v21, s[28:31], s53 offen sc1
    s_waitcnt vmcnt(0)
    v_xor_b32 v24, s3, v24
    v_xor_b32 v25, s3, v25
    v_xor_b32 v26, s3, v26
    v_xor_b32 v27, s3, v27
    v_or3_b32 v24, v24, v25, v26
    v_or_b32 v24, v24, v27
    v_cmp_ne_u32 vcc, 0, v24
    s_sub_u32 s15, s15, 1
    s_cselect_b64 s[22:23], 0, vcc
    s_branch GDg1_1
GDg1_1_ok:
    v_mov_b32 v24, 2
    ds_write_b32 v12, v24 offset:8
    s_branch LGg1_1_b
LGg1_1_a:
    s_mov_b32 s16, 3200000
LGg1_1_s:
    ds_read_b32 v24, v12 offset:8
    s_sub_u32 s16, s16, 1
    s_cbranch_scc1 LGg1_1_s_out
    s_waitcnt lgkmcnt(0)
    v_cmp_gt_u32 vcc, 2, v24
    s_cbranch_vccnz LGg1_1_s
LGg1_1_s_out:
LGg1_1_b:
    s_bfe_u32 s44, s68, 0x80008
    s_lshl_b32 s44, s44, 14
    s_add_u32 m0, s42, 81920
    s_nop 0
    buffer_load_dwordx4 v245, s[28:31], s44 offen offset:0 sc1 lds
    buffer_load_dwordx4 v245, s[28:31], s44 offen offset:1024 sc1 lds
    buffer_load_dwordx4 v245, s[28:31], s44 offen offset:2048 sc1 lds
    buffer_load_dwordx4 v245, s[28:31], s44 offen offset:3072 sc1 lds
    s_cmp_lg_u32 s12, 4
    s_cbranch_scc1 LGg1_2_a
    s_cmp_eq_u64 s[22:23], 0
    s_cbranch_scc1 GDg1_2_ok
    s_bfe_u32 s44, s68, 0x80010
    s_lshl_b32 s44, s44, 1
    s_mov_b32 s15, 200000
GDg1_2:
    s_lshr_b64 s[16:17], s[22:23], s44
    s_and_b32 s16, s16, 3
    s_cbranch_scc0 GDg1_2_ok
    buffer_load_dwordx4 v[24:27], v21, s[28:31], s53 offen sc1
    s_waitcnt vmcnt(0)
    v_xor_b32 v24, s3, v24
    v_xor_b32 v25, s3, v25
    v_xor_b32 v26, s3, v26
    v_xor_b32 v27, s3, v27
    v_or3_b32 v24, v24, v25, v26
    v_or_b32 v24, v24, v27
    v_cmp_ne_u32 vcc, 0, v24
    s_sub_u32 s15, s15, 1
    s_cselect_b64 s[22:23], 0, vcc
    s_branch GDg1_2
GDg1_2_ok:
    v_mov_b32 v24, 3
    ds_write_b32 v12, v24 offset:8
    s_branch LGg1_2_b
LGg1_2_a:
    s_mov_b32 s16, 3200000
LGg1_2_s:
    ds_read_b32 v24, v12 offset:8
    s_sub_u32 s16, s16, 1
    s_cbranch_scc1 LGg1_2_s_out
    s_waitcnt lgkmcnt(0)
    v_cmp_gt_u32 vcc, 3, v24
    s_cbranch_vccnz LGg1_2_s
LGg1_2_s_out:
LGg1_2_b:
    s_bfe_u32 s44, s68, 0x80010
    s_lshl_b32 s44, s44, 14
    s_add_u32 m0, s42, 98304
    s_nop 0
    buffer_load_dwordx4 v245, s[28:31], s44 offen offset:0 sc1 lds
    buffer_load_dwordx4 v245, s[28:31], s44 offen offset:1024 sc1 lds
    buffer_load_dwordx4 v245, s[28:31], s44 offen offset:2048 sc1 lds
    buffer_load_dwordx4 v245, s[28:31], s44 offen offset:3072 sc1 lds
    s_cmp_lg_u32 s12, 4
    s_cbranch_scc1 LGg1_3_a
    s_cmp_eq_u64 s[22:23], 0
    s_cbranch_scc1 GDg1_3_ok
    s_bfe_u32 s44, s68, 0x80018
    s_lshl_b32 s44, s44, 1
    s_mov_b32 s15, 200000
GDg1_3:
    s_lshr_b64 s[16:17], s[22:23], s44
    s_and_b32 s16, s16, 3
    s_cbranch_scc0 GDg1_3_ok
    buffer_load_dwordx4 v[24:27], v21, s[28:31], s53 offen sc1
    s_waitcnt vmcnt(0)
    v_xor_b32 v24, s3, v24
    v_xor_b32 v25, s3, v25
    v_xor_b32 v26, s3, v26
    v_xor_b32 v27, s3, v27
    v_or3_b32 v24, v24, v25, v26
    v_or_b32 v24, v24, v27
    v_cmp_ne_u32 vcc, 0, v24
    s_sub_u32 s15, s15, 1
    s_cselect_b64 s[22:23], 0, vcc
    s_branch GDg1_3
GDg1_3_ok:
    v_mov_b32 v24, 4
    ds_write_b32 v12, v24 offset:8
    s_branch LGg1_3_b
LGg1_3_a:
    s_mov_b32 s16, 3200000
LGg1_3_s:
    ds_read_b32 v24, v12 offset:8
    s_sub_u32 s16, s16, 1
    s_cbranch_scc1 LGg1_3_s_out
    s_waitcnt lgkmcnt(0)
    v_cmp_gt_u32 vcc, 4, v24
    s_cbranch_vccnz LGg1_3_s
LGg1_3_s_out:
LGg1_3_b:
    s_bfe_u32 s44, s68, 0x80018
    s_lshl_b32 s44, s44, 14
    s_add_u32 m0, s42, 114688
    s_nop 0
    buffer_load_dwordx4 v245, s[28:31], s44 offen offset:0 sc1 lds
    buffer_load_dwordx4 v245, s[28:31], s44 offen offset:1024 sc1 lds
    buffer_load_dwordx4 v245, s[28:31], s44 offen offset:2048 sc1 lds
    buffer_load_dwordx4 v245, s[28:31], s44 offen offset:3072 sc1 lds
    s_waitcnt vmcnt(12)
    s_barrier
    buffer_load_dwordx4 v[24:27], v21, s[28:31], s53 offen sc1
    s_waitcnt vmcnt(9)
    s_cmp_eq_u64 s[22:23], 0
    s_cbranch_scc1 GDg1_4_ok
    s_bfe_u32 s44, s69, 0x80000
    s_lshl_b32 s44, s44, 1
    s_mov_b32 s15, 200000
GDg1_4:
    s_lshr_b64 s[16:17], s[22:23], s44
    s_and_b32 s16, s16, 3
    s_cbranch_scc0 GDg1_4_ok
    buffer_load_dwordx4 v[24:27], v21, s[28:31], s53 offen sc1
    s_waitcnt vmcnt(0)
    v_xor_b32 v24, s3, v24
    v_xor_b32 v25, s3, v25
    v_xor_b32 v26, s3, v26
    v_xor_b32 v27, s3, v27
    v_or3_b32 v24, v24, v25, v26
    v_or_b32 v24, v24, v27
    v_cmp_ne_u32 vcc, 0, v24
    s_sub_u32 s15, s15, 1
    s_cselect_b64 s[22:23], 0, vcc
    s_branch GDg1_4
GDg1_4_ok:
    s_barrier
    s_bfe_u32 s43, s61, 0x80000
    s_mul_i32 s43, s43, 114688
    s_add_u32 m0, s42, 0
    s_nop 0
    buffer_load_dwordx4 v246, s[24:27], s43 offen offset:0  lds
    buffer_load_dwordx4 v247, s[24:27], s43 offen offset:1024  lds
    buffer_load_dwordx4 v248, s[24:27], s43 offen offset:2048  lds
    buffer_load_dwordx4 v249, s[24:27], s43 offen offset:3072  lds
    s_bfe_u32 s44, s69, 0x80000
    s_lshl_b32 s44, s44, 14
    s_add_u32 m0, s42, 65536
    s_nop 0
    buffer_load_dwordx4 v245, s[28:31], s44 offen offset:0 sc1 lds
    buffer_load_dwordx4 v245, s[28:31], s44 offen offset:1024 sc1 lds
    buffer_load_dwordx4 v245, s[28:31], s44 offen offset:2048 sc1 lds
    buffer_load_dwordx4 v245, s[28:31], s44 offen offset:3072 sc1 lds
    s_waitcnt vmcnt(13)
    s_waitcnt vmcnt(8)
    v_xor_b32 v24, s3, v24
    v_xor_b32 v25, s3, v25
    v_xor_b32 v26, s3, v26
    v_xor_b32 v27, s3, v27
    v_or3_b32 v24, v24, v25, v26
    v_or_b32 v24, v24, v27
    v_cmp_ne_u32 vcc, 0, v24
    s_nop 0
    s_and_b64 s[22:23], s[22:23], vcc
    s_cmp_eq_u64 s[22:23], 0
    s_cbranch_scc1 GDg1_5_ok
    s_bfe_u32 s44, s69, 0x80008
    s_lshl_b32 s44, s44, 1
    s_mov_b32 s15, 200000
GDg1_5:
    s_lshr_b64 s[16:17], s[22:23], s44
    s_and_b32 s16, s16, 3
    s_cbranch_scc0 GDg1_5_ok
    buffer_load_dwordx4 v[24:27], v21, s[28:31], s53 offen sc1
    s_waitcnt vmcnt(0)
    v_xor_b32 v24, s3, v24
    v_xor_b32 v25, s3, v25
    v_xor_b32 v26, s3, v26
    v_xor_b32 v27, s3, v27
    v_or3_b32 v24, v24, v25, v26
    v_or_b32 v24, v24, v27
    v_cmp_ne_u32 vcc, 0, v24
    s_sub_u32 s15, s15, 1
    s_cselect_b64 s[22:23], 0, vcc
    s_branch GDg1_5
GDg1_5_ok:
    s_barrier
    s_bfe_u32 s43, s61, 0x80008
    s_mul_i32 s43, s43, 114688
    s_add_u32 m0, s42, 16384
    s_nop 0
    buffer_load_dwordx4 v246, s[24:27], s43 offen offset:0  lds
    buffer_load_dwordx4 v247, s[24:27], s43 offen offset:1024  lds
    buffer_load_dwordx4 v248, s[24:27], s43 offen offset:2048  lds
    buffer_load_dwordx4 v249, s[24:27], s43 offen offset:3072  lds
    s_bfe_u32 s44, s69, 0x80008
    s_lshl_b32 s44, s44, 14
    s_add_u32 m0, s42, 81920
    s_nop 0
    buffer_load_dwordx4 v245, s[28:31], s44 offen offset:0 sc1 lds
    buffer_load_dwordx4 v245, s[28:31], s44 offen offset:1024 sc1 lds
    buffer_load_dwordx4 v245, s[28:31], s44 offen offset:2048 sc1 lds
    buffer_load_dwordx4 v245, s[28:31], s44 offen offset:3072 sc1 lds
    s_lshr_b32 s14, s54, 2
    s_bfe_u32 s13, s54, 0x10001
    s_lshl_b32 s13, s13, 3
    s_add_u32 s13, s13, s55
    s_mov_b32 s32, s6
    s_and_b32 s33, s7, 0xffff
    s_mov_b32 s34, 0xe00000
    s_mov_b32 s35, 0x20000
    s_mul_i32 s20, s14, 7340032
    s_lshl_b32 s17, s13, 8
    s_add_u32 s20, s20, s17
    s_mul_i32 s21, s57, 917504
    s_mul_i32 s17, s14, 458752
    s_add_u32 s21, s21, s17
    s_add_u32 s21, s21, 0x1000000
    v_lshrrev_b32 v24, 4, v1
    v_lshlrev_b32 v25, 2, v24
    v_xor_b32 v25, v25, v1
    v_and_b32 v25, 15, v25
    v_lshlrev_b32 v25, 4, v25
    s_lshr_b32 s40, s42, 12
    s_mul_i32 s41, s40, 65536
    s_add_u32 s41, s41, s20
    v_mul_u32_u24 v24, 4096, v24
    v_add3_u32 v240, v24, v25, s41
    v_xor_b32 v25, 32, v25
    v_add3_u32 v25, v24, v25, s41
    v_add_u32 v241, 0x3c00, v240
    v_add_u32 v242, 0x7800, v25
    v_add_u32 v243, 0xb400, v25
    s_add_u32 s41, s42, s21
    v_lshlrev_b32 v244, 4, v1
    v_add_u32 v244, s41, v244
    s_cmp_lg_u32 s59, 0
    s_cbranch_scc1 G2a_phi0
    s_mov_b32 s46, 0x3020100
    s_mov_b32 s47, 0x6050804
    s_mov_b32 s48, 0x100c0907
    s_mov_b32 s49, 0xe0d0b0a
    s_mov_b32 s50, 0x1814110f
    s_mov_b32 s51, 0x16151312
    s_mov_b32 s52, 0x1b1a1917
G2a_phi0:
    s_cmp_lg_u32 s59, 1
    s_cbranch_scc1 G2a_phi1
    s_mov_b32 s46, 0x3020100
    s_mov_b32 s47, 0x6040905
    s_mov_b32 s48, 0xd0a0807
    s_mov_b32 s49, 0xe0c0b11
    s_mov_b32 s50, 0x1512100f
    s_mov_b32 s51, 0x16141319
    s_mov_b32 s52, 0x1b1a1817
G2a_phi1:
    s_cmp_lg_u32 s59, 2
    s_cbranch_scc1 G2a_phi2
    s_mov_b32 s46, 0x3020100
    s_mov_b32 s47, 0x5040a06
    s_mov_b32 s48, 0xb090807
    s_mov_b32 s49, 0xd0c120e
    s_mov_b32 s50, 0x1311100f
    s_mov_b32 s51, 0x15141a16
    s_mov_b32 s52, 0x1b191817
G2a_phi2:
    s_cmp_lg_u32 s59, 3
    s_cbranch_scc1 G2a_phi3
    s_mov_b32 s46, 0x3020100
    s_mov_b32 s47, 0x50b0704
    s_mov_b32 s48, 0xa090806
    s_mov_b32 s49, 0xd130f0c
    s_mov_b32 s50, 0x1211100e
    s_mov_b32 s51, 0x151b1714
    s_mov_b32 s52, 0x1a191816
G2a_phi3:
    s_cmp_lg_u32 s59, 4
    s_cbranch_scc1 G2a_phi4
    s_mov_b32 s46, 0x3020100
    s_mov_b32 s47, 0xc080504
    s_mov_b32 s48, 0xa090706
    s_mov_b32 s49, 0x14100d0b
    s_mov_b32 s50, 0x12110f0e
    s_mov_b32 s51, 0x16181513
    s_mov_b32 s52, 0x1b1a1917
G2a_phi4:
    s_cmp_lg_u32 s59, 5
    s_cbranch_scc1 G2a_phi5
    s_mov_b32 s46, 0x3020100
    s_mov_b32 s47, 0x9060405
    s_mov_b32 s48, 0xa08070d
    s_mov_b32 s49, 0x110e0c0b
    s_mov_b32 s50, 0x12100f15
    s_mov_b32 s51, 0x19161413
    s_mov_b32 s52, 0x1b1a1817
G2a_phi5:
    s_cmp_lg_u32 s59, 6
    s_cbranch_scc1 G2a_phi6
    s_mov_b32 s46, 0x3020100
    s_mov_b32 s47, 0x7050406
    s_mov_b32 s48, 0x9080e0a
    s_mov_b32 s49, 0xf0d0c0b
    s_mov_b32 s50, 0x11101612
    s_mov_b32 s51, 0x17151413
    s_mov_b32 s52, 0x1b19181a
G2a_phi6:
    s_cmp_lg_u32 s59, 7
    s_cbranch_scc1 G2a_phi7
    s_mov_b32 s46, 0x3020100
    s_mov_b32 s47, 0x6050407
    s_mov_b32 s48, 0x90f0b08
    s_mov_b32 s49, 0xe0d0c0a
    s_mov_b32 s50, 0x11171310
    s_mov_b32 s51, 0x16151412
    s_mov_b32 s52, 0x1a191b18
G2a_phi7:
    s_bfe_u32 s17, s54, 0x10001
    s_mul_i32 s17, s17, 7
    s_add_u32 s17, s17, s55
    s_mul_i32 s17, s17, 0x02020202
    s_add_u32 s46, s46, s17
    s_add_u32 s20, s46, 0x64646464
    s_and_b32 s20, s20, 0x80808080
    s_lshr_b32 s20, s20, 7
    s_mul_i32 s20, s20, 28
    s_sub_u32 s46, s46, s20
    s_add_u32 s47, s47, s17
    s_add_u32 s20, s47, 0x64646464
    s_and_b32 s20, s20, 0x80808080
    s_lshr_b32 s20, s20, 7
    s_mul_i32 s20, s20, 28
    s_sub_u32 s47, s47, s20
    s_add_u32 s48, s48, s17
    s_add_u32 s20, s48, 0x64646464
    s_and_b32 s20, s20, 0x80808080
    s_lshr_b32 s20, s20, 7
    s_mul_i32 s20, s20, 28
    s_sub_u32 s48, s48, s20
    s_add_u32 s49, s49, s17
    s_add_u32 s20, s49, 0x64646464
    s_and_b32 s20, s20, 0x80808080
    s_lshr_b32 s20, s20, 7
    s_mul_i32 s20, s20, 28
    s_sub_u32 s49, s49, s20
    s_add_u32 s50, s50, s17
    s_add_u32 s20, s50, 0x64646464
    s_and_b32 s20, s20, 0x80808080
    s_lshr_b32 s20, s20, 7
    s_mul_i32 s20, s20, 28
    s_sub_u32 s50, s50, s20
    s_add_u32 s51, s51, s17
    s_add_u32 s20, s51, 0x64646464
    s_and_b32 s20, s20, 0x80808080
    s_lshr_b32 s20, s20, 7
    s_mul_i32 s20, s20, 28
    s_sub_u32 s51, s51, s20
    s_add_u32 s52, s52, s17
    s_add_u32 s20, s52, 0x64646464
    s_and_b32 s20, s20, 0x80808080
    s_lshr_b32 s20, s20, 7
    s_mul_i32 s20, s20, 28
    s_sub_u32 s52, s52, s20
    s_cmp_eq_u64 s[22:23], 0
    s_cbranch_scc1 GDg1_6_ok
    s_bfe_u32 s44, s69, 0x80010
    s_lshl_b32 s44, s44, 1
    s_mov_b32 s15, 200000
GDg1_6:
    s_lshr_b64 s[16:17], s[22:23], s44
    s_and_b32 s16, s16, 3
    s_cbranch_scc0 GDg1_6_ok
    buffer_load_dwordx4 v[24:27], v21, s[28:31], s53 offen sc1
    s_waitcnt vmcnt(0)
    v_xor_b32 v24, s3, v24
    v_xor_b32 v25, s3, v25
    v_xor_b32 v26, s3, v26
    v_xor_b32 v27, s3, v27
    v_or3_b32 v24, v24, v25, v26
    v_or_b32 v24, v24, v27
    v_cmp_ne_u32 vcc, 0, v24
    s_sub_u32 s15, s15, 1
    s_cselect_b64 s[22:23], 0, vcc
    s_branch GDg1_6
GDg1_6_ok:
    s_barrier
    buffer_load_dwordx4 v[24:27], v21, s[28:31], s53 offen sc1
    s_bfe_u32 s43, s61, 0x80010
    s_mul_i32 s43, s43, 114688
    s_add_u32 m0, s42, 32768
    s_nop 0
    buffer_load_dwordx4 v246, s[24:27], s43 offen offset:0  lds
    buffer_load_dwordx4 v247, s[24:27], s43 offen offset:1024  lds
    buffer_load_dwordx4 v248, s[24:27], s43 offen offset:2048  lds
    buffer_load_dwordx4 v249, s[24:27], s43 offen offset:3072  lds
    s_bfe_u32 s44, s69, 0x80010
    s_lshl_b32 s44, s44, 14
    s_add_u32 m0, s42, 98304
    s_nop 0
    buffer_load_dwordx4 v245, s[28:31], s44 offen offset:0 sc1 lds
    buffer_load_dwordx4 v245, s[28:31], s44 offen offset:1024 sc1 lds
    buffer_load_dwordx4 v245, s[28:31], s44 offen offset:2048 sc1 lds
    buffer_load_dwordx4 v245, s[28:31], s44 offen offset:3072 sc1 lds
    s_waitcnt vmcnt(17)
    s_cmp_eq_u64 s[22:23], 0
    s_cbranch_scc1 GDg1_7_ok
    s_bfe_u32 s44, s69, 0x80018
    s_lshl_b32 s44, s44, 1
    s_mov_b32 s15, 200000
GDg1_7:
    s_lshr_b64 s[16:17], s[22:23], s44
    s_and_b32 s16, s16, 3
    s_cbranch_scc0 GDg1_7_ok
    buffer_load_dwordx4 v[24:27], v21, s[28:31], s53 offen sc1
    s_waitcnt vmcnt(0)
    v_xor_b32 v24, s3, v24
    v_xor_b32 v25, s3, v25
    v_xor_b32 v26, s3, v26
    v_xor_b32 v27, s3, v27
    v_or3_b32 v24, v24, v25, v26
    v_or_b32 v24, v24, v27
    v_cmp_ne_u32 vcc, 0, v24
    s_sub_u32 s15, s15, 1
    s_cselect_b64 s[22:23], 0, vcc
    s_branch GDg1_7
GDg1_7_ok:
    s_barrier
    s_bfe_u32 s43, s61, 0x80018
    s_mul_i32 s43, s43, 114688
    s_add_u32 m0, s42, 49152
    s_nop 0
    buffer_load_dwordx4 v246, s[24:27], s43 offen offset:0  lds
    buffer_load_dwordx4 v247, s[24:27], s43 offen offset:1024  lds
    buffer_load_dwordx4 v248, s[24:27], s43 offen offset:2048  lds
    buffer_load_dwordx4 v249, s[24:27], s43 offen offset:3072  lds
    s_bfe_u32 s44, s69, 0x80018
    s_lshl_b32 s44, s44, 14
    s_add_u32 m0, s42, 114688
    s_nop 0
    buffer_load_dwordx4 v245, s[28:31], s44 offen offset:0 sc1 lds
    buffer_load_dwordx4 v245, s[28:31], s44 offen offset:1024 sc1 lds
    buffer_load_dwordx4 v245, s[28:31], s44 offen offset:2048 sc1 lds
    buffer_load_dwordx4 v245, s[28:31], s44 offen offset:3072 sc1 lds
    s_waitcnt vmcnt(17)
    s_waitcnt vmcnt(16)
    v_xor_b32 v24, s3, v24
    v_xor_b32 v25, s3, v25
    v_xor_b32 v26, s3, v26
    v_xor_b32 v27, s3, v27
    v_or3_b32 v24, v24, v25, v26
    v_or_b32 v24, v24, v27
    v_cmp_ne_u32 vcc, 0, v24
    s_nop 0
    s_and_b64 s[22:23], s[22:23], vcc
    s_cmp_eq_u64 s[22:23], 0
    s_cbranch_scc1 GDg1_8_ok
    s_bfe_u32 s44, s70, 0x80000
    s_lshl_b32 s44, s44, 1
    s_mov_b32 s15, 200000
GDg1_8:
    s_lshr_b64 s[16:17], s[22:23], s44
    s_and_b32 s16, s16, 3
    s_cbranch_scc0 GDg1_8_ok
    buffer_load_dwordx4 v[24:27], v21, s[28:31], s53 offen sc1
    s_waitcnt vmcnt(0)
    v_xor_b32 v24, s3, v24
    v_xor_b32 v25, s3, v25
    v_xor_b32 v26, s3, v26
    v_xor_b32 v27, s3, v27
    v_or3_b32 v24, v24, v25, v26
    v_or_b32 v24, v24, v27
    v_cmp_ne_u32 vcc, 0, v24
    s_sub_u32 s15, s15, 1
    s_cselect_b64 s[22:23], 0, vcc
    s_branch GDg1_8
GDg1_8_ok:
    s_barrier
    s_bfe_u32 s43, s62, 0x80000
    s_mul_i32 s43, s43, 114688
    s_add_u32 m0, s42, 0
    s_nop 0
    buffer_load_dwordx4 v246, s[24:27], s43 offen offset:0  lds
    buffer_load_dwordx4 v247, s[24:27], s43 offen offset:1024  lds
    buffer_load_dwordx4 v248, s[24:27], s43 offen offset:2048  lds
    buffer_load_dwordx4 v249, s[24:27], s43 offen offset:3072  lds
    s_bfe_u32 s44, s70, 0x80000
    s_lshl_b32 s44, s44, 14
    s_add_u32 m0, s42, 65536
    s_nop 0
    buffer_load_dwordx4 v245, s[28:31], s44 offen offset:0 sc1 lds
    buffer_load_dwordx4 v245, s[28:31], s44 offen offset:1024 sc1 lds
    buffer_load_dwordx4 v245, s[28:31], s44 offen offset:2048 sc1 lds
    buffer_load_dwordx4 v245, s[28:31], s44 offen offset:3072 sc1 lds
    s_waitcnt vmcnt(16)
    s_cmp_eq_u64 s[22:23], 0
    s_cbranch_scc1 GDg1_9_ok
    s_bfe_u32 s44, s70, 0x80008
    s_lshl_b32 s44, s44, 1
    s_mov_b32 s15, 200000
GDg1_9:
    s_lshr_b64 s[16:17], s[22:23], s44
    s_and_b32 s16, s16, 3
    s_cbranch_scc0 GDg1_9_ok
    buffer_load_dwordx4 v[24:27], v21, s[28:31], s53 offen sc1
    s_waitcnt vmcnt(0)
    v_xor_b32 v24, s3, v24
    v_xor_b32 v25, s3, v25
    v_xor_b32 v26, s3, v26
    v_xor_b32 v27, s3, v27
    v_or3_b32 v24, v24, v25, v26
    v_or_b32 v24, v24, v27
    v_cmp_ne_u32 vcc, 0, v24
    s_sub_u32 s15, s15, 1
    s_cselect_b64 s[22:23], 0, vcc
    s_branch GDg1_9
GDg1_9_ok:
    s_barrier
    s_bfe_u32 s43, s62, 0x80008
    s_mul_i32 s43, s43, 114688
    s_add_u32 m0, s42, 16384
    s_nop 0
    buffer_load_dwordx4 v246, s[24:27], s43 offen offset:0  lds
    buffer_load_dwordx4 v247, s[24:27], s43 offen offset:1024  lds
    buffer_load_dwordx4 v248, s[24:27], s43 offen offset:2048  lds
    buffer_load_dwordx4 v249, s[24:27], s43 offen offset:3072  lds
    s_bfe_u32 s44, s70, 0x80008
    s_lshl_b32 s44, s44, 14
    s_add_u32 m0, s42, 81920
    s_nop 0
    buffer_load_dwordx4 v245, s[28:31], s44 offen offset:0 sc1 lds
    buffer_load_dwordx4 v245, s[28:31], s44 offen offset:1024 sc1 lds
    buffer_load_dwordx4 v245, s[28:31], s44 offen offset:2048 sc1 lds
    buffer_load_dwordx4 v245, s[28:31], s44 offen offset:3072 sc1 lds
    s_waitcnt vmcnt(16)
    s_cmp_eq_u64 s[22:23], 0
    s_cbranch_scc1 GDg1_10_ok
    s_bfe_u32 s44, s70, 0x80010
    s_lshl_b32 s44, s44, 1
    s_mov_b32 s15, 200000
GDg1_10:
    s_lshr_b64 s[16:17], s[22:23], s44
    s_and_b32 s16, s16, 3
    s_cbranch_scc0 GDg1_10_ok
    buffer_load_dwordx4 v[24:27], v21, s[28:31], s53 offen sc1
    s_waitcnt vmcnt(0)
    v_xor_b32 v24, s3, v24
    v_xor_b32 v25, s3, v25
    v_xor_b32 v26, s3, v26
    v_xor_b32 v27, s3, v27
    v_or3_b32 v24, v24, v25, v26
    v_or_b32 v24, v24, v27
    v_cmp_ne_u32 vcc, 0, v24
    s_sub_u32 s15, s15, 1
    s_cselect_b64 s[22:23], 0, vcc
    s_branch GDg1_10
GDg1_10_ok:
    s_barrier
    s_bfe_u32 s43, s62, 0x80010
    s_mul_i32 s43, s43, 114688
    s_add_u32 m0, s42, 32768
    s_nop 0
    buffer_load_dwordx4 v246, s[24:27], s43 offen offset:0  lds
    buffer_load_dwordx4 v247, s[24:27], s43 offen offset:1024  lds
    buffer_load_dwordx4 v248, s[24:27], s43 offen offset:2048  lds
    buffer_load_dwordx4 v249, s[24:27], s43 offen offset:3072  lds
    s_bfe_u32 s44, s70, 0x80010
    s_lshl_b32 s44, s44, 14
    s_add_u32 m0, s42, 98304
    s_nop 0
    buffer_load_dwordx4 v245, s[28:31], s44 offen offset:0 sc1 lds
    buffer_load_dwordx4 v245, s[28:31], s44 offen offset:1024 sc1 lds
    buffer_load_dwordx4 v245, s[28:31], s44 offen offset:2048 sc1 lds
    buffer_load_dwordx4 v245, s[28:31], s44 offen offset:3072 sc1 lds
    s_waitcnt vmcnt(16)
    s_cmp_eq_u64 s[22:23], 0
    s_cbranch_scc1 GDg1_11_ok
    s_bfe_u32 s44, s70, 0x80018
    s_lshl_b32 s44, s44, 1
    s_mov_b32 s15, 200000
GDg1_11:
    s_lshr_b64 s[16:17], s[22:23], s44
    s_and_b32 s16, s16, 3
    s_cbranch_scc0 GDg1_11_ok
    buffer_load_dwordx4 v[24:27], v21, s[28:31], s53 offen sc1
    s_waitcnt vmcnt(0)
    v_xor_b32 v24, s3, v24
    v_xor_b32 v25, s3, v25
    v_xor_b32 v26, s3, v26
    v_xor_b32 v27, s3, v27
    v_or3_b32 v24, v24, v25, v26
    v_or_b32 v24, v24, v27
    v_cmp_ne_u32 vcc, 0, v24
    s_sub_u32 s15, s15, 1
    s_cselect_b64 s[22:23], 0, vcc
    s_branch GDg1_11
GDg1_11_ok:
    s_barrier
    s_bfe_u32 s43, s62, 0x80018
    s_mul_i32 s43, s43, 114688
    s_add_u32 m0, s42, 49152
    s_nop 0
    buffer_load_dwordx4 v246, s[24:27], s43 offen offset:0  lds
    buffer_load_dwordx4 v247, s[24:27], s43 offen offset:1024  lds
    buffer_load_dwordx4 v248, s[24:27], s43 offen offset:2048  lds
    buffer_load_dwordx4 v249, s[24:27], s43 offen offset:3072  lds
    s_bfe_u32 s44, s70, 0x80018
    s_lshl_b32 s44, s44, 14
    s_add_u32 m0, s42, 114688
    s_nop 0
    buffer_load_dwordx4 v245, s[28:31], s44 offen offset:0 sc1 lds
    buffer_load_dwordx4 v245, s[28:31], s44 offen offset:1024 sc1 lds
    buffer_load_dwordx4 v245, s[28:31], s44 offen offset:2048 sc1 lds
    buffer_load_dwordx4 v245, s[28:31], s44 offen offset:3072 sc1 lds
    s_waitcnt vmcnt(16)
    s_cmp_eq_u64 s[22:23], 0
    s_cbranch_scc1 GDg1_12_ok
    s_bfe_u32 s44, s71, 0x80000
    s_lshl_b32 s44, s44, 1
    s_mov_b32 s15, 200000
GDg1_12:
    s_lshr_b64 s[16:17], s[22:23], s44
    s_and_b32 s16, s16, 3
    s_cbranch_scc0 GDg1_12_ok
    buffer_load_dwordx4 v[24:27], v21, s[28:31], s53 offen sc1
    s_waitcnt vmcnt(0)
    v_xor_b32 v24, s3, v24
    v_xor_b32 v25, s3, v25
    v_xor_b32 v26, s3, v26
    v_xor_b32 v27, s3, v27
    v_or3_b32 v24, v24, v25, v26
    v_or_b32 v24, v24, v27
    v_cmp_ne_u32 vcc, 0, v24
    s_sub_u32 s15, s15, 1
    s_cselect_b64 s[22:23], 0, vcc
    s_branch GDg1_12
GDg1_12_ok:
    s_barrier
    s_bfe_u32 s43, s63, 0x80000
    s_mul_i32 s43, s43, 114688
    s_add_u32 m0, s42, 0
    s_nop 0
    buffer_load_dwordx4 v246, s[24:27], s43 offen offset:0  lds
    buffer_load_dwordx4 v247, s[24:27], s43 offen offset:1024  lds
    buffer_load_dwordx4 v248, s[24:27], s43 offen offset:2048  lds
    buffer_load_dwordx4 v249, s[24:27], s43 offen offset:3072  lds
    s_bfe_u32 s44, s71, 0x80000
    s_lshl_b32 s44, s44, 14
    s_add_u32 m0, s42, 65536
    s_nop 0
    buffer_load_dwordx4 v245, s[28:31], s44 offen offset:0 sc1 lds
    buffer_load_dwordx4 v245, s[28:31], s44 offen offset:1024 sc1 lds
    buffer_load_dwordx4 v245, s[28:31], s44 offen offset:2048 sc1 lds
    buffer_load_dwordx4 v245, s[28:31], s44 offen offset:3072 sc1 lds
    s_waitcnt vmcnt(16)
    s_cmp_eq_u64 s[22:23], 0
    s_cbranch_scc1 GDg1_13_ok
    s_bfe_u32 s44, s71, 0x80008
    s_lshl_b32 s44, s44, 1
    s_mov_b32 s15, 200000
GDg1_13:
    s_lshr_b64 s[16:17], s[22:23], s44
    s_and_b32 s16, s16, 3
    s_cbranch_scc0 GDg1_13_ok
    buffer_load_dwordx4 v[24:27], v21, s[28:31], s53 offen sc1
    s_waitcnt vmcnt(0)
    v_xor_b32 v24, s3, v24
    v_xor_b32 v25, s3, v25
    v_xor_b32 v26, s3, v26
    v_xor_b32 v27, s3, v27
    v_or3_b32 v24, v24, v25, v26
    v_or_b32 v24, v24, v27
    v_cmp_ne_u32 vcc, 0, v24
    s_sub_u32 s15, s15, 1
    s_cselect_b64 s[22:23], 0, vcc
    s_branch GDg1_13
GDg1_13_ok:
    s_barrier
    s_bfe_u32 s43, s63, 0x80008
    s_mul_i32 s43, s43, 114688
    s_add_u32 m0, s42, 16384
    s_nop 0
    buffer_load_dwordx4 v246, s[24:27], s43 offen offset:0  lds
    buffer_load_dwordx4 v247, s[24:27], s43 offen offset:1024  lds
    buffer_load_dwordx4 v248, s[24:27], s43 offen offset:2048  lds
    buffer_load_dwordx4 v249, s[24:27], s43 offen offset:3072  lds
    s_bfe_u32 s44, s71, 0x80008
    s_lshl_b32 s44, s44, 14
    s_add_u32 m0, s42, 81920
    s_nop 0
    buffer_load_dwordx4 v245, s[28:31], s44 offen offset:0 sc1 lds
    buffer_load_dwordx4 v245, s[28:31], s44 offen offset:1024 sc1 lds
    buffer_load_dwordx4 v245, s[28:31], s44 offen offset:2048 sc1 lds
    buffer_load_dwordx4 v245, s[28:31], s44 offen offset:3072 sc1 lds
    s_waitcnt vmcnt(16)
    s_cmp_eq_u64 s[22:23], 0
    s_cbranch_scc1 GDg1_14_ok
    s_bfe_u32 s44, s71, 0x80010
    s_lshl_b32 s44, s44, 1
    s_mov_b32 s15, 200000
GDg1_14:
    s_lshr_b64 s[16:17], s[22:23], s44
    s_and_b32 s16, s16, 3
    s_cbranch_scc0 GDg1_14_ok
    buffer_load_dwordx4 v[24:27], v21, s[28:31], s53 offen sc1
    s_waitcnt vmcnt(0)
    v_xor_b32 v24, s3, v24
    v_xor_b32 v25, s3, v25
    v_xor_b32 v26, s3, v26
    v_xor_b32 v27, s3, v27
    v_or3_b32 v24, v24, v25, v26
    v_or_b32 v24, v24, v27
    v_cmp_ne_u32 vcc, 0, v24
    s_sub_u32 s15, s15, 1
    s_cselect_b64 s[22:23], 0, vcc
    s_branch GDg1_14
GDg1_14_ok:
    s_barrier
    s_bfe_u32 s43, s63, 0x80010
    s_mul_i32 s43, s43, 114688
    s_add_u32 m0, s42, 32768
    s_nop 0
    buffer_load_dwordx4 v246, s[24:27], s43 offen offset:0  lds
    buffer_load_dwordx4 v247, s[24:27], s43 offen offset:1024  lds
    buffer_load_dwordx4 v248, s[24:27], s43 offen offset:2048  lds
    buffer_load_dwordx4 v249, s[24:27], s43 offen offset:3072  lds
    s_bfe_u32 s44, s71, 0x80010
    s_lshl_b32 s44, s44, 14
    s_add_u32 m0, s42, 98304
    s_nop 0
    buffer_load_dwordx4 v245, s[28:31], s44 offen offset:0 sc1 lds
    buffer_load_dwordx4 v245, s[28:31], s44 offen offset:1024 sc1 lds
    buffer_load_dwordx4 v245, s[28:31], s44 offen offset:2048 sc1 lds
    buffer_load_dwordx4 v245, s[28:31], s44 offen offset:3072 sc1 lds
    s_waitcnt vmcnt(16)
    s_cmp_eq_u64 s[22:23], 0
    s_cbranch_scc1 GDg1_15_ok
    s_bfe_u32 s44, s71, 0x80018
    s_lshl_b32 s44, s44, 1
    s_mov_b32 s15, 200000
GDg1_15:
    s_lshr_b64 s[16:17], s[22:23], s44
    s_and_b32 s16, s16, 3
    s_cbranch_scc0 GDg1_15_ok
    buffer_load_dwordx4 v[24:27], v21, s[28:31], s53 offen sc1
    s_waitcnt vmcnt(0)
    v_xor_b32 v24, s3, v24
    v_xor_b32 v25, s3, v25
    v_xor_b32 v26, s3, v26
    v_xor_b32 v27, s3, v27
    v_or3_b32 v24, v24, v25, v26
    v_or_b32 v24, v24, v27
    v_cmp_ne_u32 vcc, 0, v24
    s_sub_u32 s15, s15, 1
    s_cselect_b64 s[22:23], 0, vcc
    s_branch GDg1_15
GDg1_15_ok:
    s_barrier
    s_bfe_u32 s43, s63, 0x80018
    s_mul_i32 s43, s43, 114688
    s_add_u32 m0, s42, 49152
    s_nop 0
    buffer_load_dwordx4 v246, s[24:27], s43 offen offset:0  lds
    buffer_load_dwordx4 v247, s[24:27], s43 offen offset:1024  lds
    buffer_load_dwordx4 v248, s[24:27], s43 offen offset:2048  lds
    buffer_load_dwordx4 v249, s[24:27], s43 offen offset:3072  lds
    s_bfe_u32 s44, s71, 0x80018
    s_lshl_b32 s44, s44, 14
    s_add_u32 m0, s42, 114688
    s_nop 0
    buffer_load_dwordx4 v245, s[28:31], s44 offen offset:0 sc1 lds
    buffer_load_dwordx4 v245, s[28:31], s44 offen offset:1024 sc1 lds
    buffer_load_dwordx4 v245, s[28:31], s44 offen offset:2048 sc1 lds
    buffer_load_dwordx4 v245, s[28:31], s44 offen offset:3072 sc1 lds
    s_waitcnt vmcnt(16)
    s_cmp_eq_u64 s[22:23], 0
    s_cbranch_scc1 GDg1_16_ok
    s_bfe_u32 s44, s72, 0x80000
    s_lshl_b32 s44, s44, 1
    s_mov_b32 s15, 200000
GDg1_16:
    s_lshr_b64 s[16:17], s[22:23], s44
    s_and_b32 s16, s16, 3
    s_cbranch_scc0 GDg1_16_ok
    buffer_load_dwordx4 v[24:27], v21, s[28:31], s53 offen sc1
    s_waitcnt vmcnt(0)
    v_xor_b32 v24, s3, v24
    v_xor_b32 v25, s3, v25
    v_xor_b32 v26, s3, v26
    v_xor_b32 v27, s3, v27
    v_or3_b32 v24, v24, v25, v26
    v_or_b32 v24, v24, v27
    v_cmp_ne_u32 vcc, 0, v24
    s_sub_u32 s15, s15, 1
    s_cselect_b64 s[22:23], 0, vcc
    s_branch GDg1_16
GDg1_16_ok:
    s_barrier
    s_bfe_u32 s43, s64, 0x80000
    s_mul_i32 s43, s43, 114688
    s_add_u32 m0, s42, 0
    s_nop 0
    buffer_load_dwordx4 v246, s[24:27], s43 offen offset:0  lds
    buffer_load_dwordx4 v247, s[24:27], s43 offen offset:1024  lds
    buffer_load_dwordx4 v248, s[24:27], s43 offen offset:2048  lds
    buffer_load_dwordx4 v249, s[24:27], s43 offen offset:3072  lds
    s_bfe_u32 s44, s72, 0x80000
    s_lshl_b32 s44, s44, 14
    s_add_u32 m0, s42, 65536
    s_nop 0
    buffer_load_dwordx4 v245, s[28:31], s44 offen offset:0 sc1 lds
    buffer_load_dwordx4 v245, s[28:31], s44 offen offset:1024 sc1 lds
    buffer_load_dwordx4 v245, s[28:31], s44 offen offset:2048 sc1 lds
    buffer_load_dwordx4 v245, s[28:31], s44 offen offset:3072 sc1 lds
    s_waitcnt vmcnt(16)
    s_cmp_eq_u64 s[22:23], 0
    s_cbranch_scc1 GDg1_17_ok
    s_bfe_u32 s44, s72, 0x80008
    s_lshl_b32 s44, s44, 1
    s_mov_b32 s15, 200000
GDg1_17:
    s_lshr_b64 s[16:17], s[22:23], s44
    s_and_b32 s16, s16, 3
    s_cbranch_scc0 GDg1_17_ok
    buffer_load_dwordx4 v[24:27], v21, s[28:31], s53 offen sc1
    s_waitcnt vmcnt(0)
    v_xor_b32 v24, s3, v24
    v_xor_b32 v25, s3, v25
    v_xor_b32 v26, s3, v26
    v_xor_b32 v27, s3, v27
    v_or3_b32 v24, v24, v25, v26
    v_or_b32 v24, v24, v27
    v_cmp_ne_u32 vcc, 0, v24
    s_sub_u32 s15, s15, 1
    s_cselect_b64 s[22:23], 0, vcc
    s_branch GDg1_17
GDg1_17_ok:
    s_barrier
    s_bfe_u32 s43, s64, 0x80008
    s_mul_i32 s43, s43, 114688
    s_add_u32 m0, s42, 16384
    s_nop 0
    buffer_load_dwordx4 v246, s[24:27], s43 offen offset:0  lds
    buffer_load_dwordx4 v247, s[24:27], s43 offen offset:1024  lds
    buffer_load_dwordx4 v248, s[24:27], s43 offen offset:2048  lds
    buffer_load_dwordx4 v249, s[24:27], s43 offen offset:3072  lds
    s_bfe_u32 s44, s72, 0x80008
    s_lshl_b32 s44, s44, 14
    s_add_u32 m0, s42, 81920
    s_nop 0
    buffer_load_dwordx4 v245, s[28:31], s44 offen offset:0 sc1 lds
    buffer_load_dwordx4 v245, s[28:31], s44 offen offset:1024 sc1 lds
    buffer_load_dwordx4 v245, s[28:31], s44 offen offset:2048 sc1 lds
    buffer_load_dwordx4 v245, s[28:31], s44 offen offset:3072 sc1 lds
    s_waitcnt vmcnt(16)
    s_cmp_eq_u64 s[22:23], 0
    s_cbranch_scc1 GDg1_18_ok
    s_bfe_u32 s44, s72, 0x80010
    s_lshl_b32 s44, s44, 1
    s_mov_b32 s15, 200000
GDg1_18:
    s_lshr_b64 s[16:17], s[22:23], s44
    s_and_b32 s16, s16, 3
    s_cbranch_scc0 GDg1_18_ok
    buffer_load_dwordx4 v[24:27], v21, s[28:31], s53 offen sc1
    s_waitcnt vmcnt(0)
    v_xor_b32 v24, s3, v24
    v_xor_b32 v25, s3, v25
    v_xor_b32 v26, s3, v26
    v_xor_b32 v27, s3, v27
    v_or3_b32 v24, v24, v25, v26
    v_or_b32 v24, v24, v27
    v_cmp_ne_u32 vcc, 0, v24
    s_sub_u32 s15, s15, 1
    s_cselect_b64 s[22:23], 0, vcc
    s_branch GDg1_18
GDg1_18_ok:
    s_barrier
    s_bfe_u32 s43, s64, 0x80010
    s_mul_i32 s43, s43, 114688
    s_add_u32 m0, s42, 32768
    s_nop 0
    buffer_load_dwordx4 v246, s[24:27], s43 offen offset:0  lds
    buffer_load_dwordx4 v247, s[24:27], s43 offen offset:1024  lds
    buffer_load_dwordx4 v248, s[24:27], s43 offen offset:2048  lds
    buffer_load_dwordx4 v249, s[24:27], s43 offen offset:3072  lds
    s_bfe_u32 s44, s72, 0x80010
    s_lshl_b32 s44, s44, 14
    s_add_u32 m0, s42, 98304
    s_nop 0
    buffer_load_dwordx4 v245, s[28:31], s44 offen offset:0 sc1 lds
    buffer_load_dwordx4 v245, s[28:31], s44 offen offset:1024 sc1 lds
    buffer_load_dwordx4 v245, s[28:31], s44 offen offset:2048 sc1 lds
    buffer_load_dwordx4 v245, s[28:31], s44 offen offset:3072 sc1 lds
    s_waitcnt vmcnt(16)
    s_cmp_eq_u64 s[22:23], 0
    s_cbranch_scc1 GDg1_19_ok
    s_bfe_u32 s44, s72, 0x80018
    s_lshl_b32 s44, s44, 1
    s_mov_b32 s15, 200000
GDg1_19:
    s_lshr_b64 s[16:17], s[22:23], s44
    s_and_b32 s16, s16, 3
    s_cbranch_scc0 GDg1_19_ok
    buffer_load_dwordx4 v[24:27], v21, s[28:31], s53 offen sc1
    s_waitcnt vmcnt(0)
    v_xor_b32 v24, s3, v24
    v_xor_b32 v25, s3, v25
    v_xor_b32 v26, s3, v26
    v_xor_b32 v27, s3, v27
    v_or3_b32 v24, v24, v25, v26
    v_or_b32 v24, v24, v27
    v_cmp_ne_u32 vcc, 0, v24
    s_sub_u32 s15, s15, 1
    s_cselect_b64 s[22:23], 0, vcc
    s_branch GDg1_19
GDg1_19_ok:
    s_barrier
    s_bfe_u32 s43, s64, 0x80018
    s_mul_i32 s43, s43, 114688
    s_add_u32 m0, s42, 49152
    s_nop 0
    buffer_load_dwordx4 v246, s[24:27], s43 offen offset:0  lds
    buffer_load_dwordx4 v247, s[24:27], s43 offen offset:1024  lds
    buffer_load_dwordx4 v248, s[24:27], s43 offen offset:2048  lds
    buffer_load_dwordx4 v249, s[24:27], s43 offen offset:3072  lds
    s_bfe_u32 s44, s72, 0x80018
    s_lshl_b32 s44, s44, 14
    s_add_u32 m0, s42, 114688
    s_nop 0
    buffer_load_dwordx4 v245, s[28:31], s44 offen offset:0 sc1 lds
    buffer_load_dwordx4 v245, s[28:31], s44 offen offset:1024 sc1 lds
    buffer_load_dwordx4 v245, s[28:31], s44 offen offset:2048 sc1 lds
    buffer_load_dwordx4 v245, s[28:31], s44 offen offset:3072 sc1 lds
    s_waitcnt vmcnt(16)
    s_cmp_eq_u64 s[22:23], 0
    s_cbranch_scc1 GDg1_20_ok
    s_bfe_u32 s44, s73, 0x80000
    s_lshl_b32 s44, s44, 1
    s_mov_b32 s15, 200000
GDg1_20:
    s_lshr_b64 s[16:17], s[22:23], s44
    s_and_b32 s16, s16, 3
    s_cbranch_scc0 GDg1_20_ok
    buffer_load_dwordx4 v[24:27], v21, s[28:31], s53 offen sc1
    s_waitcnt vmcnt(0)
    v_xor_b32 v24, s3, v24
    v_xor_b32 v25, s3, v25
    v_xor_b32 v26, s3, v26
    v_xor_b32 v27, s3, v27
    v_or3_b32 v24, v24, v25, v26
    v_or_b32 v24, v24, v27
    v_cmp_ne_u32 vcc, 0, v24
    s_sub_u32 s15, s15, 1
    s_cselect_b64 s[22:23], 0, vcc
    s_branch GDg1_20
GDg1_20_ok:
    s_barrier
    s_bfe_u32 s43, s65, 0x80000
    s_mul_i32 s43, s43, 114688
    s_add_u32 m0, s42, 0
    s_nop 0
    buffer_load_dwordx4 v246, s[24:27], s43 offen offset:0  lds
    buffer_load_dwordx4 v247, s[24:27], s43 offen offset:1024  lds
    buffer_load_dwordx4 v248, s[24:27], s43 offen offset:2048  lds
    buffer_load_dwordx4 v249, s[24:27], s43 offen offset:3072  lds
    s_bfe_u32 s44, s73, 0x80000
    s_lshl_b32 s44, s44, 14
    s_add_u32 m0, s42, 65536
    s_nop 0
    buffer_load_dwordx4 v245, s[28:31], s44 offen offset:0 sc1 lds
    buffer_load_dwordx4 v245, s[28:31], s44 offen offset:1024 sc1 lds
    buffer_load_dwordx4 v245, s[28:31], s44 offen offset:2048 sc1 lds
    buffer_load_dwordx4 v245, s[28:31], s44 offen offset:3072 sc1 lds
    s_waitcnt vmcnt(16)
    s_cmp_eq_u64 s[22:23], 0
    s_cbranch_scc1 GDg1_21_ok
    s_bfe_u32 s44, s73, 0x80008
    s_lshl_b32 s44, s44, 1
    s_mov_b32 s15, 200000
GDg1_21:
    s_lshr_b64 s[16:17], s[22:23], s44
    s_and_b32 s16, s16, 3
    s_cbranch_scc0 GDg1_21_ok
    buffer_load_dwordx4 v[24:27], v21, s[28:31], s53 offen sc1
    s_waitcnt vmcnt(0)
    v_xor_b32 v24, s3, v24
    v_xor_b32 v25, s3, v25
    v_xor_b32 v26, s3, v26
    v_xor_b32 v27, s3, v27
    v_or3_b32 v24, v24, v25, v26
    v_or_b32 v24, v24, v27
    v_cmp_ne_u32 vcc, 0, v24
    s_sub_u32 s15, s15, 1
    s_cselect_b64 s[22:23], 0, vcc
    s_branch GDg1_21
GDg1_21_ok:
    s_barrier
    s_bfe_u32 s43, s65, 0x80008
    s_mul_i32 s43, s43, 114688
    s_add_u32 m0, s42, 16384
    s_nop 0
    buffer_load_dwordx4 v246, s[24:27], s43 offen offset:0  lds
    buffer_load_dwordx4 v247, s[24:27], s43 offen offset:1024  lds
    buffer_load_dwordx4 v248, s[24:27], s43 offen offset:2048  lds
    buffer_load_dwordx4 v249, s[24:27], s43 offen offset:3072  lds
    s_bfe_u32 s44, s73, 0x80008
    s_lshl_b32 s44, s44, 14
    s_add_u32 m0, s42, 81920
    s_nop 0
    buffer_load_dwordx4 v245, s[28:31], s44 offen offset:0 sc1 lds
    buffer_load_dwordx4 v245, s[28:31], s44 offen offset:1024 sc1 lds
    buffer_load_dwordx4 v245, s[28:31], s44 offen offset:2048 sc1 lds
    buffer_load_dwordx4 v245, s[28:31], s44 offen offset:3072 sc1 lds
    s_waitcnt vmcnt(16)
    s_cmp_eq_u64 s[22:23], 0
    s_cbranch_scc1 GDg1_22_ok
    s_bfe_u32 s44, s73, 0x80010
    s_lshl_b32 s44, s44, 1
    s_mov_b32 s15, 200000
GDg1_22:
    s_lshr_b64 s[16:17], s[22:23], s44
    s_and_b32 s16, s16, 3
    s_cbranch_scc0 GDg1_22_ok
    buffer_load_dwordx4 v[24:27], v21, s[28:31], s53 offen sc1
    s_waitcnt vmcnt(0)
    v_xor_b32 v24, s3, v24
    v_xor_b32 v25, s3, v25
    v_xor_b32 v26, s3, v26
    v_xor_b32 v27, s3, v27
    v_or3_b32 v24, v24, v25, v26
    v_or_b32 v24, v24, v27
    v_cmp_ne_u32 vcc, 0, v24
    s_sub_u32 s15, s15, 1
    s_cselect_b64 s[22:23], 0, vcc
    s_branch GDg1_22
GDg1_22_ok:
    s_barrier
    s_bfe_u32 s43, s65, 0x80010
    s_mul_i32 s43, s43, 114688
    s_add_u32 m0, s42, 32768
    s_nop 0
    buffer_load_dwordx4 v246, s[24:27], s43 offen offset:0  lds
    buffer_load_dwordx4 v247, s[24:27], s43 offen offset:1024  lds
    buffer_load_dwordx4 v248, s[24:27], s43 offen offset:2048  lds
    buffer_load_dwordx4 v249, s[24:27], s43 offen offset:3072  lds
    s_bfe_u32 s44, s73, 0x80010
    s_lshl_b32 s44, s44, 14
    s_add_u32 m0, s42, 98304
    s_nop 0
    buffer_load_dwordx4 v245, s[28:31], s44 offen offset:0 sc1 lds
    buffer_load_dwordx4 v245, s[28:31], s44 offen offset:1024 sc1 lds
    buffer_load_dwordx4 v245, s[28:31], s44 offen offset:2048 sc1 lds
    buffer_load_dwordx4 v245, s[28:31], s44 offen offset:3072 sc1 lds
    s_waitcnt vmcnt(16)
    s_cmp_eq_u64 s[22:23], 0
    s_cbranch_scc1 GDg1_23_ok
    s_bfe_u32 s44, s73, 0x80018
    s_lshl_b32 s44, s44, 1
    s_mov_b32 s15, 200000
GDg1_23:
    s_lshr_b64 s[16:17], s[22:23], s44
    s_and_b32 s16, s16, 3
    s_cbranch_scc0 GDg1_23_ok
    buffer_load_dwordx4 v[24:27], v21, s[28:31], s53 offen sc1
    s_waitcnt vmcnt(0)
    v_xor_b32 v24, s3, v24
    v_xor_b32 v25, s3, v25
    v_xor_b32 v26, s3, v26
    v_xor_b32 v27, s3, v27
    v_or3_b32 v24, v24, v25, v26
    v_or_b32 v24, v24, v27
    v_cmp_ne_u32 vcc, 0, v24
    s_sub_u32 s15, s15, 1
    s_cselect_b64 s[22:23], 0, vcc
    s_branch GDg1_23
GDg1_23_ok:
    s_barrier
    s_bfe_u32 s43, s65, 0x80018
    s_mul_i32 s43, s43, 114688
    s_add_u32 m0, s42, 49152
    s_nop 0
    buffer_load_dwordx4 v246, s[24:27], s43 offen offset:0  lds
    buffer_load_dwordx4 v247, s[24:27], s43 offen offset:1024  lds
    buffer_load_dwordx4 v248, s[24:27], s43 offen offset:2048  lds
    buffer_load_dwordx4 v249, s[24:27], s43 offen offset:3072  lds
    s_bfe_u32 s44, s73, 0x80018
    s_lshl_b32 s44, s44, 14
    s_add_u32 m0, s42, 114688
    s_nop 0
    buffer_load_dwordx4 v245, s[28:31], s44 offen offset:0 sc1 lds
    buffer_load_dwordx4 v245, s[28:31], s44 offen offset:1024 sc1 lds
    buffer_load_dwordx4 v245, s[28:31], s44 offen offset:2048 sc1 lds
    buffer_load_dwordx4 v245, s[28:31], s44 offen offset:3072 sc1 lds
    s_waitcnt vmcnt(16)
    s_cmp_eq_u64 s[22:23], 0
    s_cbranch_scc1 GDg1_24_ok
    s_bfe_u32 s44, s74, 0x80000
    s_lshl_b32 s44, s44, 1
    s_mov_b32 s15, 200000
GDg1_24:
    s_lshr_b64 s[16:17], s[22:23], s44
    s_and_b32 s16, s16, 3
    s_cbranch_scc0 GDg1_24_ok
    buffer_load_dwordx4 v[24:27], v21, s[28:31], s53 offen sc1
    s_waitcnt vmcnt(0)
    v_xor_b32 v24, s3, v24
    v_xor_b32 v25, s3, v25
    v_xor_b32 v26, s3, v26
    v_xor_b32 v27, s3, v27
    v_or3_b32 v24, v24, v25, v26
    v_or_b32 v24, v24, v27
    v_cmp_ne_u32 vcc, 0, v24
    s_sub_u32 s15, s15, 1
    s_cselect_b64 s[22:23], 0, vcc
    s_branch GDg1_24
GDg1_24_ok:
    s_barrier
    s_bfe_u32 s43, s66, 0x80000
    s_mul_i32 s43, s43, 114688
    s_add_u32 m0, s42, 0
    s_nop 0
    buffer_load_dwordx4 v246, s[24:27], s43 offen offset:0  lds
    buffer_load_dwordx4 v247, s[24:27], s43 offen offset:1024  lds
    buffer_load_dwordx4 v248, s[24:27], s43 offen offset:2048  lds
    buffer_load_dwordx4 v249, s[24:27], s43 offen offset:3072  lds
    s_bfe_u32 s44, s74, 0x80000
    s_lshl_b32 s44, s44, 14
    s_add_u32 m0, s42, 65536
    s_nop 0
    buffer_load_dwordx4 v245, s[28:31], s44 offen offset:0 sc1 lds
    buffer_load_dwordx4 v245, s[28:31], s44 offen offset:1024 sc1 lds
    buffer_load_dwordx4 v245, s[28:31], s44 offen offset:2048 sc1 lds
    buffer_load_dwordx4 v245, s[28:31], s44 offen offset:3072 sc1 lds
    s_waitcnt vmcnt(16)
    s_cmp_eq_u64 s[22:23], 0
    s_cbranch_scc1 GDg1_25_ok
    s_bfe_u32 s44, s74, 0x80008
    s_lshl_b32 s44, s44, 1
    s_mov_b32 s15, 200000
GDg1_25:
    s_lshr_b64 s[16:17], s[22:23], s44
    s_and_b32 s16, s16, 3
    s_cbranch_scc0 GDg1_25_ok
    buffer_load_dwordx4 v[24:27], v21, s[28:31], s53 offen sc1
    s_waitcnt vmcnt(0)
    v_xor_b32 v24, s3, v24
    v_xor_b32 v25, s3, v25
    v_xor_b32 v26, s3, v26
    v_xor_b32 v27, s3, v27
    v_or3_b32 v24, v24, v25, v26
    v_or_b32 v24, v24, v27
    v_cmp_ne_u32 vcc, 0, v24
    s_sub_u32 s15, s15, 1
    s_cselect_b64 s[22:23], 0, vcc
    s_branch GDg1_25
GDg1_25_ok:
    s_barrier
    s_bfe_u32 s43, s66, 0x80008
    s_mul_i32 s43, s43, 114688
    s_add_u32 m0, s42, 16384
    s_nop 0
    buffer_load_dwordx4 v246, s[24:27], s43 offen offset:0  lds
    buffer_load_dwordx4 v247, s[24:27], s43 offen offset:1024  lds
    buffer_load_dwordx4 v248, s[24:27], s43 offen offset:2048  lds
    buffer_load_dwordx4 v249, s[24:27], s43 offen offset:3072  lds
    s_bfe_u32 s44, s74, 0x80008
    s_lshl_b32 s44, s44, 14
    s_add_u32 m0, s42, 81920
    s_nop 0
    buffer_load_dwordx4 v245, s[28:31], s44 offen offset:0 sc1 lds
    buffer_load_dwordx4 v245, s[28:31], s44 offen offset:1024 sc1 lds
    buffer_load_dwordx4 v245, s[28:31], s44 offen offset:2048 sc1 lds
    buffer_load_dwordx4 v245, s[28:31], s44 offen offset:3072 sc1 lds
    s_waitcnt vmcnt(16)
    s_cmp_eq_u64 s[22:23], 0
    s_cbranch_scc1 GDg1_26_ok
    s_bfe_u32 s44, s74, 0x80010
    s_lshl_b32 s44, s44, 1
    s_mov_b32 s15, 200000
GDg1_26:
    s_lshr_b64 s[16:17], s[22:23], s44
    s_and_b32 s16, s16, 3
    s_cbranch_scc0 GDg1_26_ok
    buffer_load_dwordx4 v[24:27], v21, s[28:31], s53 offen sc1
    s_waitcnt vmcnt(0)
    v_xor_b32 v24, s3, v24
    v_xor_b32 v25, s3, v25
    v_xor_b32 v26, s3, v26
    v_xor_b32 v27, s3, v27
    v_or3_b32 v24, v24, v25, v26
    v_or_b32 v24, v24, v27
    v_cmp_ne_u32 vcc, 0, v24
    s_sub_u32 s15, s15, 1
    s_cselect_b64 s[22:23], 0, vcc
    s_branch GDg1_26
GDg1_26_ok:
    s_barrier
    s_bfe_u32 s43, s66, 0x80010
    s_mul_i32 s43, s43, 114688
    s_add_u32 m0, s42, 32768
    s_nop 0
    buffer_load_dwordx4 v246, s[24:27], s43 offen offset:0  lds
    buffer_load_dwordx4 v247, s[24:27], s43 offen offset:1024  lds
    buffer_load_dwordx4 v248, s[24:27], s43 offen offset:2048  lds
    buffer_load_dwordx4 v249, s[24:27], s43 offen offset:3072  lds
    s_bfe_u32 s44, s74, 0x80010
    s_lshl_b32 s44, s44, 14
    s_add_u32 m0, s42, 98304
    s_nop 0
    buffer_load_dwordx4 v245, s[28:31], s44 offen offset:0 sc1 lds
    buffer_load_dwordx4 v245, s[28:31], s44 offen offset:1024 sc1 lds
    buffer_load_dwordx4 v245, s[28:31], s44 offen offset:2048 sc1 lds
    buffer_load_dwordx4 v245, s[28:31], s44 offen offset:3072 sc1 lds
    s_waitcnt vmcnt(16)
    s_cmp_eq_u64 s[22:23], 0
    s_cbranch_scc1 GDg1_27_ok
    s_bfe_u32 s44, s74, 0x80018
    s_lshl_b32 s44, s44, 1
    s_mov_b32 s15, 200000
GDg1_27:
    s_lshr_b64 s[16:17], s[22:23], s44
    s_and_b32 s16, s16, 3
    s_cbranch_scc0 GDg1_27_ok
    buffer_load_dwordx4 v[24:27], v21, s[28:31], s53 offen sc1
    s_waitcnt vmcnt(0)
    v_xor_b32 v24, s3, v24
    v_xor_b32 v25, s3, v25
    v_xor_b32 v26, s3, v26
    v_xor_b32 v27, s3, v27
    v_or3_b32 v24, v24, v25, v26
    v_or_b32 v24, v24, v27
    v_cmp_ne_u32 vcc, 0, v24
    s_sub_u32 s15, s15, 1
    s_cselect_b64 s[22:23], 0, vcc
    s_branch GDg1_27
GDg1_27_ok:
    s_barrier
    s_bfe_u32 s43, s66, 0x80018
    s_mul_i32 s43, s43, 114688
    s_add_u32 m0, s42, 49152
    s_nop 0
    buffer_load_dwordx4 v246, s[24:27], s43 offen offset:0  lds
    buffer_load_dwordx4 v247, s[24:27], s43 offen offset:1024  lds
    buffer_load_dwordx4 v248, s[24:27], s43 offen offset:2048  lds
    buffer_load_dwordx4 v249, s[24:27], s43 offen offset:3072  lds
    s_bfe_u32 s44, s74, 0x80018
    s_lshl_b32 s44, s44, 14
    s_add_u32 m0, s42, 114688
    s_nop 0
    buffer_load_dwordx4 v245, s[28:31], s44 offen offset:0 sc1 lds
    buffer_load_dwordx4 v245, s[28:31], s44 offen offset:1024 sc1 lds
    buffer_load_dwordx4 v245, s[28:31], s44 offen offset:2048 sc1 lds
    buffer_load_dwordx4 v245, s[28:31], s44 offen offset:3072 sc1 lds
    s_waitcnt vmcnt(16)
    s_cmp_eq_u64 s[22:23], 0
    s_cbranch_scc1 GDg1_28_ok
    s_bfe_u32 s44, s75, 0x80000
    s_lshl_b32 s44, s44, 1
    s_mov_b32 s15, 200000
GDg1_28:
    s_lshr_b64 s[16:17], s[22:23], s44
    s_and_b32 s16, s16, 3
    s_cbranch_scc0 GDg1_28_ok
    buffer_load_dwordx4 v[24:27], v21, s[28:31], s53 offen sc1
    s_waitcnt vmcnt(0)
    v_xor_b32 v24, s3, v24
    v_xor_b32 v25, s3, v25
    v_xor_b32 v26, s3, v26
    v_xor_b32 v27, s3, v27
    v_or3_b32 v24, v24, v25, v26
    v_or_b32 v24, v24, v27
    v_cmp_ne_u32 vcc, 0, v24
    s_sub_u32 s15, s15, 1
    s_cselect_b64 s[22:23], 0, vcc
    s_branch GDg1_28
GDg1_28_ok:
    s_barrier
    s_bfe_u32 s43, s67, 0x80000
    s_mul_i32 s43, s43, 114688
    s_add_u32 m0, s42, 0
    s_nop 0
    buffer_load_dwordx4 v246, s[24:27], s43 offen offset:0  lds
    buffer_load_dwordx4 v247, s[24:27], s43 offen offset:1024  lds
    buffer_load_dwordx4 v248, s[24:27], s43 offen offset:2048  lds
    buffer_load_dwordx4 v249, s[24:27], s43 offen offset:3072  lds
    s_bfe_u32 s44, s75, 0x80000
    s_lshl_b32 s44, s44, 14
    s_add_u32 m0, s42, 65536
    s_nop 0
    buffer_load_dwordx4 v245, s[28:31], s44 offen offset:0 sc1 lds
    buffer_load_dwordx4 v245, s[28:31], s44 offen offset:1024 sc1 lds
    buffer_load_dwordx4 v245, s[28:31], s44 offen offset:2048 sc1 lds
    buffer_load_dwordx4 v245, s[28:31], s44 offen offset:3072 sc1 lds
    s_waitcnt vmcnt(16)
    s_cmp_eq_u64 s[22:23], 0
    s_cbranch_scc1 GDg1_29_ok
    s_bfe_u32 s44, s75, 0x80008
    s_lshl_b32 s44, s44, 1
    s_mov_b32 s15, 200000
GDg1_29:
    s_lshr_b64 s[16:17], s[22:23], s44
    s_and_b32 s16, s16, 3
    s_cbranch_scc0 GDg1_29_ok
    buffer_load_dwordx4 v[24:27], v21, s[28:31], s53 offen sc1
    s_waitcnt vmcnt(0)
    v_xor_b32 v24, s3, v24
    v_xor_b32 v25, s3, v25
    v_xor_b32 v26, s3, v26
    v_xor_b32 v27, s3, v27
    v_or3_b32 v24, v24, v25, v26
    v_or_b32 v24, v24, v27
    v_cmp_ne_u32 vcc, 0, v24
    s_sub_u32 s15, s15, 1
    s_cselect_b64 s[22:23], 0, vcc
    s_branch GDg1_29
GDg1_29_ok:
    s_barrier
    s_bfe_u32 s43, s67, 0x80008
    s_mul_i32 s43, s43, 114688
    s_add_u32 m0, s42, 16384
    s_nop 0
    buffer_load_dwordx4 v246, s[24:27], s43 offen offset:0  lds
    buffer_load_dwordx4 v247, s[24:27], s43 offen offset:1024  lds
    buffer_load_dwordx4 v248, s[24:27], s43 offen offset:2048  lds
    buffer_load_dwordx4 v249, s[24:27], s43 offen offset:3072  lds
    s_bfe_u32 s44, s75, 0x80008
    s_lshl_b32 s44, s44, 14
    s_add_u32 m0, s42, 81920
    s_nop 0
    buffer_load_dwordx4 v245, s[28:31], s44 offen offset:0 sc1 lds
    buffer_load_dwordx4 v245, s[28:31], s44 offen offset:1024 sc1 lds
    buffer_load_dwordx4 v245, s[28:31], s44 offen offset:2048 sc1 lds
    buffer_load_dwordx4 v245, s[28:31], s44 offen offset:3072 sc1 lds
    s_waitcnt vmcnt(16)
    s_cmp_eq_u64 s[22:23], 0
    s_cbranch_scc1 GDg1_30_ok
    s_bfe_u32 s44, s75, 0x80010
    s_lshl_b32 s44, s44, 1
    s_mov_b32 s15, 200000
GDg1_30:
    s_lshr_b64 s[16:17], s[22:23], s44
    s_and_b32 s16, s16, 3
    s_cbranch_scc0 GDg1_30_ok
    buffer_load_dwordx4 v[24:27], v21, s[28:31], s53 offen sc1
    s_waitcnt vmcnt(0)
    v_xor_b32 v24, s3, v24
    v_xor_b32 v25, s3, v25
    v_xor_b32 v26, s3, v26
    v_xor_b32 v27, s3, v27
    v_or3_b32 v24, v24, v25, v26
    v_or_b32 v24, v24, v27
    v_cmp_ne_u32 vcc, 0, v24
    s_sub_u32 s15, s15, 1
    s_cselect_b64 s[22:23], 0, vcc
    s_branch GDg1_30
GDg1_30_ok:
    s_barrier
    s_bfe_u32 s43, s67, 0x80010
    s_mul_i32 s43, s43, 114688
    s_add_u32 m0, s42, 32768
    s_nop 0
    buffer_load_dwordx4 v246, s[24:27], s43 offen offset:0  lds
    buffer_load_dwordx4 v247, s[24:27], s43 offen offset:1024  lds
    buffer_load_dwordx4 v248, s[24:27], s43 offen offset:2048  lds
    buffer_load_dwordx4 v249, s[24:27], s43 offen offset:3072  lds
    s_bfe_u32 s44, s75, 0x80010
    s_lshl_b32 s44, s44, 14
    s_add_u32 m0, s42, 98304
    s_nop 0
    buffer_load_dwordx4 v245, s[28:31], s44 offen offset:0 sc1 lds
    buffer_load_dwordx4 v245, s[28:31], s44 offen offset:1024 sc1 lds
    buffer_load_dwordx4 v245, s[28:31], s44 offen offset:2048 sc1 lds
    buffer_load_dwordx4 v245, s[28:31], s44 offen offset:3072 sc1 lds
    s_waitcnt vmcnt(16)
    s_cmp_eq_u64 s[22:23], 0
    s_cbranch_scc1 GDg1_31_ok
    s_bfe_u32 s44, s75, 0x80018
    s_lshl_b32 s44, s44, 1
    s_mov_b32 s15, 200000
GDg1_31:
    s_lshr_b64 s[16:17], s[22:23], s44
    s_and_b32 s16, s16, 3
    s_cbranch_scc0 GDg1_31_ok
    buffer_load_dwordx4 v[24:27], v21, s[28:31], s53 offen sc1
    s_waitcnt vmcnt(0)
    v_xor_b32 v24, s3, v24
    v_xor_b32 v25, s3, v25
    v_xor_b32 v26, s3, v26
    v_xor_b32 v27, s3, v27
    v_or3_b32 v24, v24, v25, v26
    v_or_b32 v24, v24, v27
    v_cmp_ne_u32 vcc, 0, v24
    s_sub_u32 s15, s15, 1
    s_cselect_b64 s[22:23], 0, vcc
    s_branch GDg1_31
GDg1_31_ok:
    s_barrier
    s_bfe_u32 s43, s67, 0x80018
    s_mul_i32 s43, s43, 114688
    s_add_u32 m0, s42, 49152
    s_nop 0
    buffer_load_dwordx4 v246, s[24:27], s43 offen offset:0  lds
    buffer_load_dwordx4 v247, s[24:27], s43 offen offset:1024  lds
    buffer_load_dwordx4 v248, s[24:27], s43 offen offset:2048  lds
    buffer_load_dwordx4 v249, s[24:27], s43 offen offset:3072  lds
    s_bfe_u32 s44, s75, 0x80018
    s_lshl_b32 s44, s44, 14
    s_add_u32 m0, s42, 114688
    s_nop 0
    buffer_load_dwordx4 v245, s[28:31], s44 offen offset:0 sc1 lds
    buffer_load_dwordx4 v245, s[28:31], s44 offen offset:1024 sc1 lds
    buffer_load_dwordx4 v245, s[28:31], s44 offen offset:2048 sc1 lds
    buffer_load_dwordx4 v245, s[28:31], s44 offen offset:3072 sc1 lds
    s_waitcnt vmcnt(16)
    s_barrier
    s_or_b32 s15, s2, s42
    s_cbranch_scc1 G1L_ne
    s_mov_b32 s15, 0x3000040
    s_mov_b64 exec, 1
    v_mov_b32 v24, s3
    v_mov_b32 v25, 0
    buffer_store_dword v24, v25, s[28:31], s15 offen sc1
    s_mov_b64 exec, -1
G1L_ne:
    s_bfe_u32 s43, s46, 0x80000
    s_lshl_b32 s43, s43, 18
    s_add_u32 m0, s42, 0
    s_nop 0
    buffer_load_dwordx4 v240, s[32:35], s43 offen offset:0  lds
    buffer_load_dwordx4 v241, s[32:35], s43 offen offset:1024  lds
    buffer_load_dwordx4 v242, s[32:35], s43 offen offset:2048  lds
    buffer_load_dwordx4 v243, s[32:35], s43 offen offset:3072  lds
    s_waitcnt vmcnt(12)
    s_barrier
    s_bfe_u32 s43, s46, 0x80008
    s_lshl_b32 s43, s43, 18
    s_add_u32 m0, s42, 16384
    s_nop 0
    buffer_load_dwordx4 v240, s[32:35], s43 offen offset:0  lds
    buffer_load_dwordx4 v241, s[32:35], s43 offen offset:1024  lds
    buffer_load_dwordx4 v242, s[32:35], s43 offen offset:2048  lds
    buffer_load_dwordx4 v243, s[32:35], s43 offen offset:3072  lds
    s_waitcnt vmcnt(8)
    s_barrier
    s_bfe_u32 s43, s46, 0x80010
    s_lshl_b32 s43, s43, 18
    s_add_u32 m0, s42, 32768
    s_nop 0
    buffer_load_dwordx4 v240, s[32:35], s43 offen offset:0  lds
    buffer_load_dwordx4 v241, s[32:35], s43 offen offset:1024  lds
    buffer_load_dwordx4 v242, s[32:35], s43 offen offset:2048  lds
    buffer_load_dwordx4 v243, s[32:35], s43 offen offset:3072  lds
    s_branch G2_L1
G2_L:
    s_lshl_b32 s53, s57, 1
    s_add_u32 s53, s53, s14
    s_lshl_b32 s53, s53, 11
    s_add_u32 s53, s53, 0x3080000
    v_min_u32 v23, 55, v1
    v_lshrrev_b32 v22, 2, v23
    v_mul_u32_u24 v22, 112, v22
    v_lshl_add_u32 v23, v23, 2, v22
    s_cmp_eq_u32 s12, 4
    s_cselect_b64 s[22:23], -1, 0
    s_cmp_lg_u32 s12, 4
    s_cbranch_scc1 LGg2_0_a
    s_cmp_eq_u64 s[22:23], 0
    s_cbranch_scc1 GDg2_0_ok
    s_bfe_u32 s44, s46, 0x80000
    s_and_b32 s44, s44, 0xfe
    s_lshl_b32 s44, s44, 1
    s_mov_b32 s15, 200000
GDg2_0:
    s_lshr_b64 s[16:17], s[22:23], s44
    s_and_b32 s16, s16, 15
    s_cbranch_scc0 GDg2_0_ok
    buffer_load_dword v24, v23, s[28:31], s53 offen sc1
    s_waitcnt vmcnt(0)
    v_xor_b32 v24, s3, v24
    v_cmp_ne_u32 vcc, 0, v24
    s_sub_u32 s15, s15, 1
    s_cselect_b64 s[22:23], 0, vcc
    s_branch GDg2_0
GDg2_0_ok:
    v_mov_b32 v24, 1
    ds_write_b32 v12, v24 offset:36
    s_branch LGg2_0_b
LGg2_0_a:
    s_mov_b32 s16, 3200000
LGg2_0_s:
    ds_read_b32 v24, v12 offset:36
    s_sub_u32 s16, s16, 1
    s_cbranch_scc1 LGg2_0_s_out
    s_waitcnt lgkmcnt(0)
    v_cmp_gt_u32 vcc, 1, v24
    s_cbranch_vccnz LGg2_0_s
LGg2_0_s_out:
LGg2_0_b:
    s_bfe_u32 s44, s46, 0x80000
    s_lshl_b32 s44, s44, 14
    s_add_u32 m0, s42, 65536
    s_nop 0
    buffer_load_dwordx4 v244, s[28:31], s44 offen offset:0 sc1 lds
    buffer_load_dwordx4 v244, s[28:31], s44 offen offset:1024 sc1 lds
    buffer_load_dwordx4 v244, s[28:31], s44 offen offset:2048 sc1 lds
    buffer_load_dwordx4 v244, s[28:31], s44 offen offset:3072 sc1 lds
    s_bfe_u32 s44, s46, 0x80008
    s_lshl_b32 s44, s44, 14
    s_add_u32 m0, s42, 81920
    s_nop 0
    buffer_load_dwordx4 v244, s[28:31], s44 offen offset:0 sc1 lds
    buffer_load_dwordx4 v244, s[28:31], s44 offen offset:1024 sc1 lds
    buffer_load_dwordx4 v244, s[28:31], s44 offen offset:2048 sc1 lds
    buffer_load_dwordx4 v244, s[28:31], s44 offen offset:3072 sc1 lds
    s_waitcnt vmcnt(4)
    s_barrier
    s_cmp_lg_u32 s12, 4
    s_cbranch_scc1 LGg2_2c_a
    s_cmp_eq_u64 s[22:23], 0
    s_cbranch_scc1 GDg2_2c_ok
    s_bfe_u32 s44, s46, 0x80010
    s_and_b32 s44, s44, 0xfe
    s_lshl_b32 s44, s44, 1
    s_mov_b32 s15, 200000
GDg2_2c:
    s_lshr_b64 s[16:17], s[22:23], s44
    s_and_b32 s16, s16, 15
    s_cbranch_scc0 GDg2_2c_ok
    buffer_load_dword v24, v23, s[28:31], s53 offen sc1
    s_waitcnt vmcnt(0)
    v_xor_b32 v24, s3, v24
    v_cmp_ne_u32 vcc, 0, v24
    s_sub_u32 s15, s15, 1
    s_cselect_b64 s[22:23], 0, vcc
    s_branch GDg2_2c
GDg2_2c_ok:
    v_mov_b32 v24, 2
    ds_write_b32 v12, v24 offset:36
    s_branch LGg2_2c_b
LGg2_2c_a:
    s_mov_b32 s16, 3200000
LGg2_2c_s:
    ds_read_b32 v24, v12 offset:36
    s_sub_u32 s16, s16, 1
    s_cbranch_scc1 LGg2_2c_s_out
    s_waitcnt lgkmcnt(0)
    v_cmp_gt_u32 vcc, 2, v24
    s_cbranch_vccnz LGg2_2c_s
LGg2_2c_s_out:
LGg2_2c_b:
    s_bfe_u32 s44, s46, 0x80010
    s_lshl_b32 s44, s44, 14
    s_add_u32 m0, s42, 98304
    s_nop 0
    buffer_load_dwordx4 v244, s[28:31], s44 offen offset:0 sc1 lds
    buffer_load_dwordx4 v244, s[28:31], s44 offen offset:1024 sc1 lds
    buffer_load_dwordx4 v244, s[28:31], s44 offen offset:2048 sc1 lds
    buffer_load_dwordx4 v244, s[28:31], s44 offen offset:3072 sc1 lds
    s_bfe_u32 s43, s46, 0x80018
    s_lshl_b32 s43, s43, 18
    s_add_u32 m0, s42, 49152
    s_nop 0
    buffer_load_dwordx4 v240, s[32:35], s43 offen offset:0  lds
    buffer_load_dwordx4 v241, s[32:35], s43 offen offset:1024  lds
    buffer_load_dwordx4 v242, s[32:35], s43 offen offset:2048  lds
    buffer_load_dwordx4 v243, s[32:35], s43 offen offset:3072  lds
    s_bfe_u32 s44, s46, 0x80018
    s_lshl_b32 s44, s44, 14
    s_add_u32 m0, s42, 114688
    s_nop 0
    buffer_load_dwordx4 v244, s[28:31], s44 offen offset:0 sc1 lds
    buffer_load_dwordx4 v244, s[28:31], s44 offen offset:1024 sc1 lds
    buffer_load_dwordx4 v244, s[28:31], s44 offen offset:2048 sc1 lds
    buffer_load_dwordx4 v244, s[28:31], s44 offen offset:3072 sc1 lds
    s_waitcnt vmcnt(12)
    s_barrier
    s_bfe_u32 s43, s47, 0x80000
    s_lshl_b32 s43, s43, 18
    s_add_u32 m0, s42, 0
    s_nop 0
    buffer_load_dwordx4 v240, s[32:35], s43 offen offset:0  lds
    buffer_load_dwordx4 v241, s[32:35], s43 offen offset:1024  lds
    buffer_load_dwordx4 v242, s[32:35], s43 offen offset:2048  lds
    buffer_load_dwordx4 v243, s[32:35], s43 offen offset:3072  lds
    s_cmp_lg_u32 s12, 4
    s_cbranch_scc1 LGg2_4c_a
    s_cmp_eq_u64 s[22:23], 0
    s_cbranch_scc1 GDg2_4c_ok
    s_bfe_u32 s44, s47, 0x80000
    s_and_b32 s44, s44, 0xfe
    s_lshl_b32 s44, s44, 1
    s_mov_b32 s15, 200000
GDg2_4c:
    s_lshr_b64 s[16:17], s[22:23], s44
    s_and_b32 s16, s16, 15
    s_cbranch_scc0 GDg2_4c_ok
    buffer_load_dword v24, v23, s[28:31], s53 offen sc1
    s_waitcnt vmcnt(0)
    v_xor_b32 v24, s3, v24
    v_cmp_ne_u32 vcc, 0, v24
    s_sub_u32 s15, s15, 1
    s_cselect_b64 s[22:23], 0, vcc
    s_branch GDg2_4c
GDg2_4c_ok:
    v_mov_b32 v24, 3
    ds_write_b32 v12, v24 offset:36
    s_branch LGg2_4c_b
LGg2_4c_a:
    s_mov_b32 s16, 3200000
LGg2_4c_s:
    ds_read_b32 v24, v12 offset:36
    s_sub_u32 s16, s16, 1
    s_cbranch_scc1 LGg2_4c_s_out
    s_waitcnt lgkmcnt(0)
    v_cmp_gt_u32 vcc, 3, v24
    s_cbranch_vccnz LGg2_4c_s
LGg2_4c_s_out:
LGg2_4c_b:
    s_bfe_u32 s44, s47, 0x80000
    s_lshl_b32 s44, s44, 14
    s_add_u32 m0, s42, 65536
    s_nop 0
    buffer_load_dwordx4 v244, s[28:31], s44 offen offset:0 sc1 lds
    buffer_load_dwordx4 v244, s[28:31], s44 offen offset:1024 sc1 lds
    buffer_load_dwordx4 v244, s[28:31], s44 offen offset:2048 sc1 lds
    buffer_load_dwordx4 v244, s[28:31], s44 offen offset:3072 sc1 lds
    s_branch G2_L3
G2_L1:
    s_lshl_b32 s53, s57, 1
    s_add_u32 s53, s53, s14
    s_lshl_b32 s53, s53, 11
    s_add_u32 s53, s53, 0x3080000
    v_min_u32 v23, 55, v1
    v_lshrrev_b32 v22, 2, v23
    v_mul_u32_u24 v22, 112, v22
    v_lshl_add_u32 v23, v23, 2, v22
    s_cmp_eq_u32 s12, 4
    s_cselect_b64 s[22:23], -1, 0
G2_L2:
    s_waitcnt vmcnt(8)
    s_barrier
    s_bfe_u32 s43, s46, 0x80018
    s_lshl_b32 s43, s43, 18
    s_add_u32 m0, s42, 49152
    s_nop 0
    buffer_load_dwordx4 v240, s[32:35], s43 offen offset:0  lds
    buffer_load_dwordx4 v241, s[32:35], s43 offen offset:1024  lds
    buffer_load_dwordx4 v242, s[32:35], s43 offen offset:2048  lds
    buffer_load_dwordx4 v243, s[32:35], s43 offen offset:3072  lds
    s_waitcnt vmcnt(8)
    s_barrier
    s_bfe_u32 s43, s47, 0x80000
    s_lshl_b32 s43, s43, 18
    s_add_u32 m0, s42, 0
    s_nop 0
    buffer_load_dwordx4 v240, s[32:35], s43 offen offset:0  lds
    buffer_load_dwordx4 v241, s[32:35], s43 offen offset:1024  lds
    buffer_load_dwordx4 v242, s[32:35], s43 offen offset:2048  lds
    buffer_load_dwordx4 v243, s[32:35], s43 offen offset:3072  lds
    s_cmp_lg_u32 s12, 4
    s_cbranch_scc1 LGg2_2_a
    s_cmp_eq_u64 s[22:23], 0
    s_cbranch_scc1 GDg2_2_ok
    s_bfe_u32 s44, s46, 0x80010
    s_and_b32 s44, s44, 0xfe
    s_lshl_b32 s44, s44, 1
    s_mov_b32 s15, 200000
GDg2_2:
    s_lshr_b64 s[16:17], s[22:23], s44
    s_and_b32 s16, s16, 15
    s_cbranch_scc0 GDg2_2_ok
    buffer_load_dword v24, v23, s[28:31], s53 offen sc1
    s_waitcnt vmcnt(0)
    v_xor_b32 v24, s3, v24
    v_cmp_ne_u32 vcc, 0, v24
    s_sub_u32 s15, s15, 1
    s_cselect_b64 s[22:23], 0, vcc
    s_branch GDg2_2
GDg2_2_ok:
    v_mov_b32 v24, 2
    ds_write_b32 v12, v24 offset:36
    s_branch LGg2_2_b
LGg2_2_a:
    s_mov_b32 s16, 3200000
LGg2_2_s:
    ds_read_b32 v24, v12 offset:36
    s_sub_u32 s16, s16, 1
    s_cbranch_scc1 LGg2_2_s_out
    s_waitcnt lgkmcnt(0)
    v_cmp_gt_u32 vcc, 2, v24
    s_cbranch_vccnz LGg2_2_s
LGg2_2_s_out:
LGg2_2_b:
    s_bfe_u32 s44, s46, 0x80010
    s_lshl_b32 s44, s44, 14
    s_add_u32 m0, s42, 98304
    s_nop 0
    buffer_load_dwordx4 v244, s[28:31], s44 offen offset:0 sc1 lds
    buffer_load_dwordx4 v244, s[28:31], s44 offen offset:1024 sc1 lds
    buffer_load_dwordx4 v244, s[28:31], s44 offen offset:2048 sc1 lds
    buffer_load_dwordx4 v244, s[28:31], s44 offen offset:3072 sc1 lds
    s_bfe_u32 s44, s46, 0x80018
    s_lshl_b32 s44, s44, 14
    s_add_u32 m0, s42, 114688
    s_nop 0
    buffer_load_dwordx4 v244, s[28:31], s44 offen offset:0 sc1 lds
    buffer_load_dwordx4 v244, s[28:31], s44 offen offset:1024 sc1 lds
    buffer_load_dwordx4 v244, s[28:31], s44 offen offset:2048 sc1 lds
    buffer_load_dwordx4 v244, s[28:31], s44 offen offset:3072 sc1 lds
    s_cmp_lg_u32 s12, 4
    s_cbranch_scc1 LGg2_4_a
    s_cmp_eq_u64 s[22:23], 0
    s_cbranch_scc1 GDg2_4_ok
    s_bfe_u32 s44, s47, 0x80000
    s_and_b32 s44, s44, 0xfe
    s_lshl_b32 s44, s44, 1
    s_mov_b32 s15, 200000
GDg2_4:
    s_lshr_b64 s[16:17], s[22:23], s44
    s_and_b32 s16, s16, 15
    s_cbranch_scc0 GDg2_4_ok
    buffer_load_dword v24, v23, s[28:31], s53 offen sc1
    s_waitcnt vmcnt(0)
    v_xor_b32 v24, s3, v24
    v_cmp_ne_u32 vcc, 0, v24
    s_sub_u32 s15, s15, 1
    s_cselect_b64 s[22:23], 0, vcc
    s_branch GDg2_4
GDg2_4_ok:
    v_mov_b32 v24, 3
    ds_write_b32 v12, v24 offset:36
    s_branch LGg2_4_b
LGg2_4_a:
    s_mov_b32 s16, 3200000
LGg2_4_s:
    ds_read_b32 v24, v12 offset:36
    s_sub_u32 s16, s16, 1
    s_cbranch_scc1 LGg2_4_s_out
    s_waitcnt lgkmcnt(0)
    v_cmp_gt_u32 vcc, 3, v24
    s_cbranch_vccnz LGg2_4_s
LGg2_4_s_out:
LGg2_4_b:
    s_bfe_u32 s44, s47, 0x80000
    s_lshl_b32 s44, s44, 14
    s_add_u32 m0, s42, 65536
    s_nop 0
    buffer_load_dwordx4 v244, s[28:31], s44 offen offset:0 sc1 lds
    buffer_load_dwordx4 v244, s[28:31], s44 offen offset:1024 sc1 lds
    buffer_load_dwordx4 v244, s[28:31], s44 offen offset:2048 sc1 lds
    buffer_load_dwordx4 v244, s[28:31], s44 offen offset:3072 sc1 lds
G2_L3:
    s_waitcnt vmcnt(8)
    s_cmp_eq_u64 s[22:23], 0
    s_cbranch_scc1 GDg2_5_ok
    s_bfe_u32 s44, s47, 0x80008
    s_and_b32 s44, s44, 0xfe
    s_lshl_b32 s44, s44, 1
    s_mov_b32 s15, 200000
GDg2_5:
    s_lshr_b64 s[16:17], s[22:23], s44
    s_and_b32 s16, s16, 15
    s_cbranch_scc0 GDg2_5_ok
    buffer_load_dword v24, v23, s[28:31], s53 offen sc1
    s_waitcnt vmcnt(0)
    v_xor_b32 v24, s3, v24
    v_cmp_ne_u32 vcc, 0, v24
    s_sub_u32 s15, s15, 1
    s_cselect_b64 s[22:23], 0, vcc
    s_branch GDg2_5
GDg2_5_ok:
    s_barrier
    buffer_load_dword v24, v23, s[28:31], s53 offen sc1
    s_bfe_u32 s43, s47, 0x80008
    s_lshl_b32 s43, s43, 18
    s_add_u32 m0, s42, 16384
    s_nop 0
    buffer_load_dwordx4 v240, s[32:35], s43 offen offset:0  lds
    buffer_load_dwordx4 v241, s[32:35], s43 offen offset:1024  lds
    buffer_load_dwordx4 v242, s[32:35], s43 offen offset:2048  lds
    buffer_load_dwordx4 v243, s[32:35], s43 offen offset:3072  lds
    s_bfe_u32 s44, s47, 0x80008
    s_lshl_b32 s44, s44, 14
    s_add_u32 m0, s42, 81920
    s_nop 0
    buffer_load_dwordx4 v244, s[28:31], s44 offen offset:0 sc1 lds
    buffer_load_dwordx4 v244, s[28:31], s44 offen offset:1024 sc1 lds
    buffer_load_dwordx4 v244, s[28:31], s44 offen offset:2048 sc1 lds
    buffer_load_dwordx4 v244, s[28:31], s44 offen offset:3072 sc1 lds
    v_and_b32 v33, 31, v1
    v_lshrrev_b32 v34, 5, v1
    s_lshr_b32 s19, s42, 11
    v_and_b32 v40, 7, v33
    v_xor_b32 v40, s19, v40
    v_lshlrev_b32 v40, 4, v40
    v_lshl_add_u32 v40, v33, 7, v40
    v_lshl_add_u32 v40, v34, 12, v40
    v_add_u32 v28, 131072, v40
    v_xor_b32 v32, 16, v28
    v_lshrrev_b32 v40, 3, v1
    v_xor_b32 v26, v40, v1
    v_and_b32 v26, 7, v26
    v_lshlrev_b32 v26, 4, v26
    v_lshl_add_u32 v26, v40, 7, v26
    s_lshl_b32 s19, s54, 7
    v_lshl_add_u32 v27, v33, 2, s19
    v_mov_b32 v40, 0x48000
    v_cmp_gt_u32 vcc, 32, v1
    s_nop 1
    v_cndmask_b32 v27, v40, v27, vcc
    v_lshlrev_b32 v29, 4, v1
    s_and_b32 s18, s2, 31
    s_lshr_b32 s19, s2, 5
    s_lshl_b32 s19, s19, 7
    s_add_u32 s18, s18, s19
    s_lshl_b32 s18, s18, 12
    s_lshl_b32 s19, s42, 5
    s_add_u32 s18, s18, s19
    s_add_u32 s19, s42, 32768
    v_lshrrev_b32 v40, 1, v33
    v_and_b32 v40, 3, v40
    v_lshlrev_b32 v40, 4, v40
    v_lshl_add_u32 v40, v33, 6, v40
    v_lshl_add_u32 v40, v34, 3, v40
    v_add_u32 v30, s19, v40
    v_lshrrev_b32 v40, 3, v1
    v_xor_b32 v40, v40, v1
    v_and_b32 v40, 3, v40
    v_lshlrev_b32 v40, 4, v40
    v_lshrrev_b32 v41, 2, v1
    v_lshl_add_u32 v40, v41, 6, v40
    v_add_u32 v31, s19, v40
    v_mov_b32 v36, 0x35800000
    v_mov_b32 v35, 0
    s_mov_b32 s24, s10
    s_and_b32 s25, s11, 0xffff
    s_mov_b32 s26, 0x1000
    s_mov_b32 s27, 0x20000
    s_waitcnt vmcnt(13)
    s_cmp_eq_u64 s[22:23], 0
    s_cbranch_scc1 GDg2_6_ok
    s_bfe_u32 s44, s47, 0x80010
    s_and_b32 s44, s44, 0xfe
    s_lshl_b32 s44, s44, 1
    s_mov_b32 s15, 200000
GDg2_6:
    s_lshr_b64 s[16:17], s[22:23], s44
    s_and_b32 s16, s16, 15
    s_cbranch_scc0 GDg2_6_ok
    buffer_load_dword v24, v23, s[28:31], s53 offen sc1
    s_waitcnt vmcnt(0)
    v_xor_b32 v24, s3, v24
    v_cmp_ne_u32 vcc, 0, v24
    s_sub_u32 s15, s15, 1
    s_cselect_b64 s[22:23], 0, vcc
    s_branch GDg2_6
GDg2_6_ok:
    s_barrier
    s_bfe_u32 s43, s47, 0x80010
    s_lshl_b32 s43, s43, 18
    s_add_u32 m0, s42, 32768
    s_nop 0
    buffer_load_dwordx4 v240, s[32:35], s43 offen offset:0  lds
    buffer_load_dwordx4 v241, s[32:35], s43 offen offset:1024  lds
    buffer_load_dwordx4 v242, s[32:35], s43 offen offset:2048  lds
    buffer_load_dwordx4 v243, s[32:35], s43 offen offset:3072  lds
    s_bfe_u32 s44, s47, 0x80010
    s_lshl_b32 s44, s44, 14
    s_add_u32 m0, s42, 98304
    s_nop 0
    buffer_load_dwordx4 v244, s[28:31], s44 offen offset:0 sc1 lds
    buffer_load_dwordx4 v244, s[28:31], s44 offen offset:1024 sc1 lds
    buffer_load_dwordx4 v244, s[28:31], s44 offen offset:2048 sc1 lds
    buffer_load_dwordx4 v244, s[28:31], s44 offen offset:3072 sc1 lds
    s_waitcnt vmcnt(17)
    s_waitcnt vmcnt(16)
    v_xor_b32 v24, s3, v24
    v_cmp_ne_u32 vcc, 0, v24
    s_nop 0
    s_and_b64 s[22:23], s[22:23], vcc
    s_cmp_eq_u64 s[22:23], 0
    s_cbranch_scc1 GDg2_7_ok
    s_bfe_u32 s44, s47, 0x80018
    s_and_b32 s44, s44, 0xfe
    s_lshl_b32 s44, s44, 1
    s_mov_b32 s15, 200000
GDg2_7:
    s_lshr_b64 s[16:17], s[22:23], s44
    s_and_b32 s16, s16, 15
    s_cbranch_scc0 GDg2_7_ok
    buffer_load_dword v24, v23, s[28:31], s53 offen sc1
    s_waitcnt vmcnt(0)
    v_xor_b32 v24, s3, v24
    v_cmp_ne_u32 vcc, 0, v24
    s_sub_u32 s15, s15, 1
    s_cselect_b64 s[22:23], 0, vcc
    s_branch GDg2_7
GDg2_7_ok:
    s_barrier
    s_bfe_u32 s43, s47, 0x80018
    s_lshl_b32 s43, s43, 18
    s_add_u32 m0, s42, 49152
    s_nop 0
    buffer_load_dwordx4 v240, s[32:35], s43 offen offset:0  lds
    buffer_load_dwordx4 v241, s[32:35], s43 offen offset:1024  lds
    buffer_load_dwordx4 v242, s[32:35], s43 offen offset:2048  lds
    buffer_load_dwordx4 v243, s[32:35], s43 offen offset:3072  lds
    s_bfe_u32 s44, s47, 0x80018
    s_lshl_b32 s44, s44, 14
    s_add_u32 m0, s42, 114688
    s_nop 0
    buffer_load_dwordx4 v244, s[28:31], s44 offen offset:0 sc1 lds
    buffer_load_dwordx4 v244, s[28:31], s44 offen offset:1024 sc1 lds
    buffer_load_dwordx4 v244, s[28:31], s44 offen offset:2048 sc1 lds
    buffer_load_dwordx4 v244, s[28:31], s44 offen offset:3072 sc1 lds
    s_waitcnt vmcnt(16)
    s_cmp_eq_u64 s[22:23], 0
    s_cbranch_scc1 GDg2_8_ok
    s_bfe_u32 s44, s48, 0x80000
    s_and_b32 s44, s44, 0xfe
    s_lshl_b32 s44, s44, 1
    s_mov_b32 s15, 200000
GDg2_8:
    s_lshr_b64 s[16:17], s[22:23], s44
    s_and_b32 s16, s16, 15
    s_cbranch_scc0 GDg2_8_ok
    buffer_load_dword v24, v23, s[28:31], s53 offen sc1
    s_waitcnt vmcnt(0)
    v_xor_b32 v24, s3, v24
    v_cmp_ne_u32 vcc, 0, v24
    s_sub_u32 s15, s15, 1
    s_cselect_b64 s[22:23], 0, vcc
    s_branch GDg2_8
GDg2_8_ok:
    s_barrier
    buffer_load_dword v24, v23, s[28:31], s53 offen sc1
    s_bfe_u32 s43, s48, 0x80000
    s_lshl_b32 s43, s43, 18
    s_add_u32 m0, s42, 0
    s_nop 0
    buffer_load_dwordx4 v240, s[32:35], s43 offen offset:0  lds
    buffer_load_dwordx4 v241, s[32:35], s43 offen offset:1024  lds
    buffer_load_dwordx4 v242, s[32:35], s43 offen offset:2048  lds
    buffer_load_dwordx4 v243, s[32:35], s43 offen offset:3072  lds
    s_bfe_u32 s44, s48, 0x80000
    s_lshl_b32 s44, s44, 14
    s_add_u32 m0, s42, 65536
    s_nop 0
    buffer_load_dwordx4 v244, s[28:31], s44 offen offset:0 sc1 lds
    buffer_load_dwordx4 v244, s[28:31], s44 offen offset:1024 sc1 lds
    buffer_load_dwordx4 v244, s[28:31], s44 offen offset:2048 sc1 lds
    buffer_load_dwordx4 v244, s[28:31], s44 offen offset:3072 sc1 lds
    s_waitcnt vmcnt(17)
    s_cmp_eq_u64 s[22:23], 0
    s_cbranch_scc1 GDg2_9_ok
    s_bfe_u32 s44, s48, 0x80008
    s_and_b32 s44, s44, 0xfe
    s_lshl_b32 s44, s44, 1
    s_mov_b32 s15, 200000
GDg2_9:
    s_lshr_b64 s[16:17], s[22:23], s44
    s_and_b32 s16, s16, 15
    s_cbranch_scc0 GDg2_9_ok
    buffer_load_dword v24, v23, s[28:31], s53 offen sc1
    s_waitcnt vmcnt(0)
    v_xor_b32 v24, s3, v24
    v_cmp_ne_u32 vcc, 0, v24
    s_sub_u32 s15, s15, 1
    s_cselect_b64 s[22:23], 0, vcc
    s_branch GDg2_9
GDg2_9_ok:
    s_barrier
    s_bfe_u32 s43, s48, 0x80008
    s_lshl_b32 s43, s43, 18
    s_add_u32 m0, s42, 16384
    s_nop 0
    buffer_load_dwordx4 v240, s[32:35], s43 offen offset:0  lds
    buffer_load_dwordx4 v241, s[32:35], s43 offen offset:1024  lds
    buffer_load_dwordx4 v242, s[32:35], s43 offen offset:2048  lds
    buffer_load_dwordx4 v243, s[32:35], s43 offen offset:3072  lds
    s_bfe_u32 s44, s48, 0x80008
    s_lshl_b32 s44, s44, 14
    s_add_u32 m0, s42, 81920
    s_nop 0
    buffer_load_dwordx4 v244, s[28:31], s44 offen offset:0 sc1 lds
    buffer_load_dwordx4 v244, s[28:31], s44 offen offset:1024 sc1 lds
    buffer_load_dwordx4 v244, s[28:31], s44 offen offset:2048 sc1 lds
    buffer_load_dwordx4 v244, s[28:31], s44 offen offset:3072 sc1 lds
    s_waitcnt vmcnt(17)
    s_waitcnt vmcnt(16)
    v_xor_b32 v24, s3, v24
    v_cmp_ne_u32 vcc, 0, v24
    s_nop 0
    s_and_b64 s[22:23], s[22:23], vcc
    s_cmp_eq_u64 s[22:23], 0
    s_cbranch_scc1 GDg2_10_ok
    s_bfe_u32 s44, s48, 0x80010
    s_and_b32 s44, s44, 0xfe
    s_lshl_b32 s44, s44, 1
    s_mov_b32 s15, 200000
GDg2_10:
    s_lshr_b64 s[16:17], s[22:23], s44
    s_and_b32 s16, s16, 15
    s_cbranch_scc0 GDg2_10_ok
    buffer_load_dword v24, v23, s[28:31], s53 offen sc1
    s_waitcnt vmcnt(0)
    v_xor_b32 v24, s3, v24
    v_cmp_ne_u32 vcc, 0, v24
    s_sub_u32 s15, s15, 1
    s_cselect_b64 s[22:23], 0, vcc
    s_branch GDg2_10
GDg2_10_ok:
    s_barrier
    s_bfe_u32 s43, s48, 0x80010
    s_lshl_b32 s43, s43, 18
    s_add_u32 m0, s42, 32768
    s_nop 0
    buffer_load_dwordx4 v240, s[32:35], s43 offen offset:0  lds
    buffer_load_dwordx4 v241, s[32:35], s43 offen offset:1024  lds
    buffer_load_dwordx4 v242, s[32:35], s43 offen offset:2048  lds
    buffer_load_dwordx4 v243, s[32:35], s43 offen offset:3072  lds
    s_bfe_u32 s44, s48, 0x80010
    s_lshl_b32 s44, s44, 14
    s_add_u32 m0, s42, 98304
    s_nop 0
    buffer_load_dwordx4 v244, s[28:31], s44 offen offset:0 sc1 lds
    buffer_load_dwordx4 v244, s[28:31], s44 offen offset:1024 sc1 lds
    buffer_load_dwordx4 v244, s[28:31], s44 offen offset:2048 sc1 lds
    buffer_load_dwordx4 v244, s[28:31], s44 offen offset:3072 sc1 lds
    s_waitcnt vmcnt(16)
    s_cmp_eq_u64 s[22:23], 0
    s_cbranch_scc1 GDg2_11_ok
    s_bfe_u32 s44, s48, 0x80018
    s_and_b32 s44, s44, 0xfe
    s_lshl_b32 s44, s44, 1
    s_mov_b32 s15, 200000
GDg2_11:
    s_lshr_b64 s[16:17], s[22:23], s44
    s_and_b32 s16, s16, 15
    s_cbranch_scc0 GDg2_11_ok
    buffer_load_dword v24, v23, s[28:31], s53 offen sc1
    s_waitcnt vmcnt(0)
    v_xor_b32 v24, s3, v24
    v_cmp_ne_u32 vcc, 0, v24
    s_sub_u32 s15, s15, 1
    s_cselect_b64 s[22:23], 0, vcc
    s_branch GDg2_11
GDg2_11_ok:
    s_barrier
    s_bfe_u32 s43, s48, 0x80018
    s_lshl_b32 s43, s43, 18
    s_add_u32 m0, s42, 49152
    s_nop 0
    buffer_load_dwordx4 v240, s[32:35], s43 offen offset:0  lds
    buffer_load_dwordx4 v241, s[32:35], s43 offen offset:1024  lds
    buffer_load_dwordx4 v242, s[32:35], s43 offen offset:2048  lds
    buffer_load_dwordx4 v243, s[32:35], s43 offen offset:3072  lds
    s_bfe_u32 s44, s48, 0x80018
    s_lshl_b32 s44, s44, 14
    s_add_u32 m0, s42, 114688
    s_nop 0
    buffer_load_dwordx4 v244, s[28:31], s44 offen offset:0 sc1 lds
    buffer_load_dwordx4 v244, s[28:31], s44 offen offset:1024 sc1 lds
    buffer_load_dwordx4 v244, s[28:31], s44 offen offset:2048 sc1 lds
    buffer_load_dwordx4 v244, s[28:31], s44 offen offset:3072 sc1 lds
    s_waitcnt vmcnt(16)
    s_cmp_eq_u64 s[22:23], 0
    s_cbranch_scc1 GDg2_12_ok
    s_bfe_u32 s44, s49, 0x80000
    s_and_b32 s44, s44, 0xfe
    s_lshl_b32 s44, s44, 1
    s_mov_b32 s15, 200000
GDg2_12:
    s_lshr_b64 s[16:17], s[22:23], s44
    s_and_b32 s16, s16, 15
    s_cbranch_scc0 GDg2_12_ok
    buffer_load_dword v24, v23, s[28:31], s53 offen sc1
    s_waitcnt vmcnt(0)
    v_xor_b32 v24, s3, v24
    v_cmp_ne_u32 vcc, 0, v24
    s_sub_u32 s15, s15, 1
    s_cselect_b64 s[22:23], 0, vcc
    s_branch GDg2_12
GDg2_12_ok:
    s_barrier
    s_bfe_u32 s43, s49, 0x80000
    s_lshl_b32 s43, s43, 18
    s_add_u32 m0, s42, 0
    s_nop 0
    buffer_load_dwordx4 v240, s[32:35], s43 offen offset:0  lds
    buffer_load_dwordx4 v241, s[32:35], s43 offen offset:1024  lds
    buffer_load_dwordx4 v242, s[32:35], s43 offen offset:2048  lds
    buffer_load_dwordx4 v243, s[32:35], s43 offen offset:3072  lds
    s_bfe_u32 s44, s49, 0x80000
    s_lshl_b32 s44, s44, 14
    s_add_u32 m0, s42, 65536
    s_nop 0
    buffer_load_dwordx4 v244, s[28:31], s44 offen offset:0 sc1 lds
    buffer_load_dwordx4 v244, s[28:31], s44 offen offset:1024 sc1 lds
    buffer_load_dwordx4 v244, s[28:31], s44 offen offset:2048 sc1 lds
    buffer_load_dwordx4 v244, s[28:31], s44 offen offset:3072 sc1 lds
    s_lshl_b32 s15, s54, 3
    s_add_u32 s15, s15, s55
    s_lshl_b32 s15, s15, 12
    s_add_u32 s15, s15, 0x3010000
    v_and_b32 v22, 31, v1
    v_lshlrev_b32 v22, 7, v22
    buffer_load_dword v22, v22, s[28:31], s15 offen sc1
    s_waitcnt vmcnt(17)
    s_cmp_eq_u64 s[22:23], 0
    s_cbranch_scc1 GDg2_13_ok
    s_bfe_u32 s44, s49, 0x80008
    s_and_b32 s44, s44, 0xfe
    s_lshl_b32 s44, s44, 1
    s_mov_b32 s15, 200000
GDg2_13:
    s_lshr_b64 s[16:17], s[22:23], s44
    s_and_b32 s16, s16, 15
    s_cbranch_scc0 GDg2_13_ok
    buffer_load_dword v24, v23, s[28:31], s53 offen sc1
    s_waitcnt vmcnt(0)
    v_xor_b32 v24, s3, v24
    v_cmp_ne_u32 vcc, 0, v24
    s_sub_u32 s15, s15, 1
    s_cselect_b64 s[22:23], 0, vcc
    s_branch GDg2_13
GDg2_13_ok:
    s_barrier
    s_bfe_u32 s43, s49, 0x80008
    s_lshl_b32 s43, s43, 18
    s_add_u32 m0, s42, 16384
    s_nop 0
    buffer_load_dwordx4 v240, s[32:35], s43 offen offset:0  lds
    buffer_load_dwordx4 v241, s[32:35], s43 offen offset:1024  lds
    buffer_load_dwordx4 v242, s[32:35], s43 offen offset:2048  lds
    buffer_load_dwordx4 v243, s[32:35], s43 offen offset:3072  lds
    s_bfe_u32 s44, s49, 0x80008
    s_lshl_b32 s44, s44, 14
    s_add_u32 m0, s42, 81920
    s_nop 0
    buffer_load_dwordx4 v244, s[28:31], s44 offen offset:0 sc1 lds
    buffer_load_dwordx4 v244, s[28:31], s44 offen offset:1024 sc1 lds
    buffer_load_dwordx4 v244, s[28:31], s44 offen offset:2048 sc1 lds
    buffer_load_dwordx4 v244, s[28:31], s44 offen offset:3072 sc1 lds
    s_waitcnt vmcnt(17)
    s_cmp_eq_u64 s[22:23], 0
    s_cbranch_scc1 GDg2_14_ok
    s_bfe_u32 s44, s49, 0x80010
    s_and_b32 s44, s44, 0xfe
    s_lshl_b32 s44, s44, 1
    s_mov_b32 s15, 200000
GDg2_14:
    s_lshr_b64 s[16:17], s[22:23], s44
    s_and_b32 s16, s16, 15
    s_cbranch_scc0 GDg2_14_ok
    buffer_load_dword v24, v23, s[28:31], s53 offen sc1
    s_waitcnt vmcnt(0)
    v_xor_b32 v24, s3, v24
    v_cmp_ne_u32 vcc, 0, v24
    s_sub_u32 s15, s15, 1
    s_cselect_b64 s[22:23], 0, vcc
    s_branch GDg2_14
GDg2_14_ok:
    s_barrier
    s_bfe_u32 s43, s49, 0x80010
    s_lshl_b32 s43, s43, 18
    s_add_u32 m0, s42, 32768
    s_nop 0
    buffer_load_dwordx4 v240, s[32:35], s43 offen offset:0  lds
    buffer_load_dwordx4 v241, s[32:35], s43 offen offset:1024  lds
    buffer_load_dwordx4 v242, s[32:35], s43 offen offset:2048  lds
    buffer_load_dwordx4 v243, s[32:35], s43 offen offset:3072  lds
    s_bfe_u32 s44, s49, 0x80010
    s_lshl_b32 s44, s44, 14
    s_add_u32 m0, s42, 98304
    s_nop 0
    buffer_load_dwordx4 v244, s[28:31], s44 offen offset:0 sc1 lds
    buffer_load_dwordx4 v244, s[28:31], s44 offen offset:1024 sc1 lds
    buffer_load_dwordx4 v244, s[28:31], s44 offen offset:2048 sc1 lds
    buffer_load_dwordx4 v244, s[28:31], s44 offen offset:3072 sc1 lds
    s_waitcnt vmcnt(17)
    s_cmp_eq_u64 s[22:23], 0
    s_cbranch_scc1 GDg2_15_ok
    s_bfe_u32 s44, s49, 0x80018
    s_and_b32 s44, s44, 0xfe
    s_lshl_b32 s44, s44, 1
    s_mov_b32 s15, 200000
GDg2_15:
    s_lshr_b64 s[16:17], s[22:23], s44
    s_and_b32 s16, s16, 15
    s_cbranch_scc0 GDg2_15_ok
    buffer_load_dword v24, v23, s[28:31], s53 offen sc1
    s_waitcnt vmcnt(0)
    v_xor_b32 v24, s3, v24
    v_cmp_ne_u32 vcc, 0, v24
    s_sub_u32 s15, s15, 1
    s_cselect_b64 s[22:23], 0, vcc
    s_branch GDg2_15
GDg2_15_ok:
    s_barrier
    s_bfe_u32 s43, s49, 0x80018
    s_lshl_b32 s43, s43, 18
    s_add_u32 m0, s42, 49152
    s_nop 0
    buffer_load_dwordx4 v240, s[32:35], s43 offen offset:0  lds
    buffer_load_dwordx4 v241, s[32:35], s43 offen offset:1024  lds
    buffer_load_dwordx4 v242, s[32:35], s43 offen offset:2048  lds
    buffer_load_dwordx4 v243, s[32:35], s43 offen offset:3072  lds
    s_bfe_u32 s44, s49, 0x80018
    s_lshl_b32 s44, s44, 14
    s_add_u32 m0, s42, 114688
    s_nop 0
    buffer_load_dwordx4 v244, s[28:31], s44 offen offset:0 sc1 lds
    buffer_load_dwordx4 v244, s[28:31], s44 offen offset:1024 sc1 lds
    buffer_load_dwordx4 v244, s[28:31], s44 offen offset:2048 sc1 lds
    buffer_load_dwordx4 v244, s[28:31], s44 offen offset:3072 sc1 lds
    s_waitcnt vmcnt(16)
    s_cmp_eq_u64 s[22:23], 0
    s_cbranch_scc1 GDg2_16_ok
    s_bfe_u32 s44, s50, 0x80000
    s_and_b32 s44, s44, 0xfe
    s_lshl_b32 s44, s44, 1
    s_mov_b32 s15, 200000
GDg2_16:
    s_lshr_b64 s[16:17], s[22:23], s44
    s_and_b32 s16, s16, 15
    s_cbranch_scc0 GDg2_16_ok
    buffer_load_dword v24, v23, s[28:31], s53 offen sc1
    s_waitcnt vmcnt(0)
    v_xor_b32 v24, s3, v24
    v_cmp_ne_u32 vcc, 0, v24
    s_sub_u32 s15, s15, 1
    s_cselect_b64 s[22:23], 0, vcc
    s_branch GDg2_16
GDg2_16_ok:
    s_barrier
    s_bfe_u32 s43, s50, 0x80000
    s_lshl_b32 s43, s43, 18
    s_add_u32 m0, s42, 0
    s_nop 0
    buffer_load_dwordx4 v240, s[32:35], s43 offen offset:0  lds
    buffer_load_dwordx4 v241, s[32:35], s43 offen offset:1024  lds
    buffer_load_dwordx4 v242, s[32:35], s43 offen offset:2048  lds
    buffer_load_dwordx4 v243, s[32:35], s43 offen offset:3072  lds
    s_bfe_u32 s44, s50, 0x80000
    s_lshl_b32 s44, s44, 14
    s_add_u32 m0, s42, 65536
    s_nop 0
    buffer_load_dwordx4 v244, s[28:31], s44 offen offset:0 sc1 lds
    buffer_load_dwordx4 v244, s[28:31], s44 offen offset:1024 sc1 lds
    buffer_load_dwordx4 v244, s[28:31], s44 offen offset:2048 sc1 lds
    buffer_load_dwordx4 v244, s[28:31], s44 offen offset:3072 sc1 lds
    s_waitcnt vmcnt(16)
    s_cmp_eq_u64 s[22:23], 0
    s_cbranch_scc1 GDg2_17_ok
    s_bfe_u32 s44, s50, 0x80008
    s_and_b32 s44, s44, 0xfe
    s_lshl_b32 s44, s44, 1
    s_mov_b32 s15, 200000
GDg2_17:
    s_lshr_b64 s[16:17], s[22:23], s44
    s_and_b32 s16, s16, 15
    s_cbranch_scc0 GDg2_17_ok
    buffer_load_dword v24, v23, s[28:31], s53 offen sc1
    s_waitcnt vmcnt(0)
    v_xor_b32 v24, s3, v24
    v_cmp_ne_u32 vcc, 0, v24
    s_sub_u32 s15, s15, 1
    s_cselect_b64 s[22:23], 0, vcc
    s_branch GDg2_17
GDg2_17_ok:
    s_barrier
    s_bfe_u32 s43, s50, 0x80008
    s_lshl_b32 s43, s43, 18
    s_add_u32 m0, s42, 16384
    s_nop 0
    buffer_load_dwordx4 v240, s[32:35], s43 offen offset:0  lds
    buffer_load_dwordx4 v241, s[32:35], s43 offen offset:1024  lds
    buffer_load_dwordx4 v242, s[32:35], s43 offen offset:2048  lds
    buffer_load_dwordx4 v243, s[32:35], s43 offen offset:3072  lds
    s_bfe_u32 s44, s50, 0x80008
    s_lshl_b32 s44, s44, 14
    s_add_u32 m0, s42, 81920
    s_nop 0
    buffer_load_dwordx4 v244, s[28:31], s44 offen offset:0 sc1 lds
    buffer_load_dwordx4 v244, s[28:31], s44 offen offset:1024 sc1 lds
    buffer_load_dwordx4 v244, s[28:31], s44 offen offset:2048 sc1 lds
    buffer_load_dwordx4 v244, s[28:31], s44 offen offset:3072 sc1 lds
    s_waitcnt vmcnt(16)
    s_cmp_eq_u64 s[22:23], 0
    s_cbranch_scc1 GDg2_18_ok
    s_bfe_u32 s44, s50, 0x80010
    s_and_b32 s44, s44, 0xfe
    s_lshl_b32 s44, s44, 1
    s_mov_b32 s15, 200000
GDg2_18:
    s_lshr_b64 s[16:17], s[22:23], s44
    s_and_b32 s16, s16, 15
    s_cbranch_scc0 GDg2_18_ok
    buffer_load_dword v24, v23, s[28:31], s53 offen sc1
    s_waitcnt vmcnt(0)
    v_xor_b32 v24, s3, v24
    v_cmp_ne_u32 vcc, 0, v24
    s_sub_u32 s15, s15, 1
    s_cselect_b64 s[22:23], 0, vcc
    s_branch GDg2_18
GDg2_18_ok:
    s_barrier
    s_bfe_u32 s43, s50, 0x80010
    s_lshl_b32 s43, s43, 18
    s_add_u32 m0, s42, 32768
    s_nop 0
    buffer_load_dwordx4 v240, s[32:35], s43 offen offset:0  lds
    buffer_load_dwordx4 v241, s[32:35], s43 offen offset:1024  lds
    buffer_load_dwordx4 v242, s[32:35], s43 offen offset:2048  lds
    buffer_load_dwordx4 v243, s[32:35], s43 offen offset:3072  lds
    s_bfe_u32 s44, s50, 0x80010
    s_lshl_b32 s44, s44, 14
    s_add_u32 m0, s42, 98304
    s_nop 0
    buffer_load_dwordx4 v244, s[28:31], s44 offen offset:0 sc1 lds
    buffer_load_dwordx4 v244, s[28:31], s44 offen offset:1024 sc1 lds
    buffer_load_dwordx4 v244, s[28:31], s44 offen offset:2048 sc1 lds
    buffer_load_dwordx4 v244, s[28:31], s44 offen offset:3072 sc1 lds
    s_waitcnt vmcnt(16)
    s_cmp_eq_u64 s[22:23], 0
    s_cbranch_scc1 GDg2_19_ok
    s_bfe_u32 s44, s50, 0x80018
    s_and_b32 s44, s44, 0xfe
    s_lshl_b32 s44, s44, 1
    s_mov_b32 s15, 200000
GDg2_19:
    s_lshr_b64 s[16:17], s[22:23], s44
    s_and_b32 s16, s16, 15
    s_cbranch_scc0 GDg2_19_ok
    buffer_load_dword v24, v23, s[28:31], s53 offen sc1
    s_waitcnt vmcnt(0)
    v_xor_b32 v24, s3, v24
    v_cmp_ne_u32 vcc, 0, v24
    s_sub_u32 s15, s15, 1
    s_cselect_b64 s[22:23], 0, vcc
    s_branch GDg2_19
GDg2_19_ok:
    s_barrier
    s_bfe_u32 s43, s50, 0x80018
    s_lshl_b32 s43, s43, 18
    s_add_u32 m0, s42, 49152
    s_nop 0
    buffer_load_dwordx4 v240, s[32:35], s43 offen offset:0  lds
    buffer_load_dwordx4 v241, s[32:35], s43 offen offset:1024  lds
    buffer_load_dwordx4 v242, s[32:35], s43 offen offset:2048  lds
    buffer_load_dwordx4 v243, s[32:35], s43 offen offset:3072  lds
    s_bfe_u32 s44, s50, 0x80018
    s_lshl_b32 s44, s44, 14
    s_add_u32 m0, s42, 114688
    s_nop 0
    buffer_load_dwordx4 v244, s[28:31], s44 offen offset:0 sc1 lds
    buffer_load_dwordx4 v244, s[28:31], s44 offen offset:1024 sc1 lds
    buffer_load_dwordx4 v244, s[28:31], s44 offen offset:2048 sc1 lds
    buffer_load_dwordx4 v244, s[28:31], s44 offen offset:3072 sc1 lds
    s_waitcnt vmcnt(16)
    s_cmp_eq_u64 s[22:23], 0
    s_cbranch_scc1 GDg2_20_ok
    s_bfe_u32 s44, s51, 0x80000
    s_and_b32 s44, s44, 0xfe
    s_lshl_b32 s44, s44, 1
    s_mov_b32 s15, 200000
GDg2_20:
    s_lshr_b64 s[16:17], s[22:23], s44
    s_and_b32 s16, s16, 15
    s_cbranch_scc0 GDg2_20_ok
    buffer_load_dword v24, v23, s[28:31], s53 offen sc1
    s_waitcnt vmcnt(0)
    v_xor_b32 v24, s3, v24
    v_cmp_ne_u32 vcc, 0, v24
    s_sub_u32 s15, s15, 1
    s_cselect_b64 s[22:23], 0, vcc
    s_branch GDg2_20
GDg2_20_ok:
    s_barrier
    s_bfe_u32 s43, s51, 0x80000
    s_lshl_b32 s43, s43, 18
    s_add_u32 m0, s42, 0
    s_nop 0
    buffer_load_dwordx4 v240, s[32:35], s43 offen offset:0  lds
    buffer_load_dwordx4 v241, s[32:35], s43 offen offset:1024  lds
    buffer_load_dwordx4 v242, s[32:35], s43 offen offset:2048  lds
    buffer_load_dwordx4 v243, s[32:35], s43 offen offset:3072  lds
    s_bfe_u32 s44, s51, 0x80000
    s_lshl_b32 s44, s44, 14
    s_add_u32 m0, s42, 65536
    s_nop 0
    buffer_load_dwordx4 v244, s[28:31], s44 offen offset:0 sc1 lds
    buffer_load_dwordx4 v244, s[28:31], s44 offen offset:1024 sc1 lds
    buffer_load_dwordx4 v244, s[28:31], s44 offen offset:2048 sc1 lds
    buffer_load_dwordx4 v244, s[28:31], s44 offen offset:3072 sc1 lds
    s_waitcnt vmcnt(16)
    s_cmp_eq_u64 s[22:23], 0
    s_cbranch_scc1 GDg2_21_ok
    s_bfe_u32 s44, s51, 0x80008
    s_and_b32 s44, s44, 0xfe
    s_lshl_b32 s44, s44, 1
    s_mov_b32 s15, 200000
GDg2_21:
    s_lshr_b64 s[16:17], s[22:23], s44
    s_and_b32 s16, s16, 15
    s_cbranch_scc0 GDg2_21_ok
    buffer_load_dword v24, v23, s[28:31], s53 offen sc1
    s_waitcnt vmcnt(0)
    v_xor_b32 v24, s3, v24
    v_cmp_ne_u32 vcc, 0, v24
    s_sub_u32 s15, s15, 1
    s_cselect_b64 s[22:23], 0, vcc
    s_branch GDg2_21
GDg2_21_ok:
    s_barrier
    s_bfe_u32 s43, s51, 0x80008
    s_lshl_b32 s43, s43, 18
    s_add_u32 m0, s42, 16384
    s_nop 0
    buffer_load_dwordx4 v240, s[32:35], s43 offen offset:0  lds
    buffer_load_dwordx4 v241, s[32:35], s43 offen offset:1024  lds
    buffer_load_dwordx4 v242, s[32:35], s43 offen offset:2048  lds
    buffer_load_dwordx4 v243, s[32:35], s43 offen offset:3072  lds
    s_bfe_u32 s44, s51, 0x80008
    s_lshl_b32 s44, s44, 14
    s_add_u32 m0, s42, 81920
    s_nop 0
    buffer_load_dwordx4 v244, s[28:31], s44 offen offset:0 sc1 lds
    buffer_load_dwordx4 v244, s[28:31], s44 offen offset:1024 sc1 lds
    buffer_load_dwordx4 v244, s[28:31], s44 offen offset:2048 sc1 lds
    buffer_load_dwordx4 v244, s[28:31], s44 offen offset:3072 sc1 lds
    s_waitcnt vmcnt(16)
    s_cmp_eq_u64 s[22:23], 0
    s_cbranch_scc1 GDg2_22_ok
    s_bfe_u32 s44, s51, 0x80010
    s_and_b32 s44, s44, 0xfe
    s_lshl_b32 s44, s44, 1
    s_mov_b32 s15, 200000
GDg2_22:
    s_lshr_b64 s[16:17], s[22:23], s44
    s_and_b32 s16, s16, 15
    s_cbranch_scc0 GDg2_22_ok
    buffer_load_dword v24, v23, s[28:31], s53 offen sc1
    s_waitcnt vmcnt(0)
    v_xor_b32 v24, s3, v24
    v_cmp_ne_u32 vcc, 0, v24
    s_sub_u32 s15, s15, 1
    s_cselect_b64 s[22:23], 0, vcc
    s_branch GDg2_22
GDg2_22_ok:
    s_barrier
    s_bfe_u32 s43, s51, 0x80010
    s_lshl_b32 s43, s43, 18
    s_add_u32 m0, s42, 32768
    s_nop 0
    buffer_load_dwordx4 v240, s[32:35], s43 offen offset:0  lds
    buffer_load_dwordx4 v241, s[32:35], s43 offen offset:1024  lds
    buffer_load_dwordx4 v242, s[32:35], s43 offen offset:2048  lds
    buffer_load_dwordx4 v243, s[32:35], s43 offen offset:3072  lds
    s_bfe_u32 s44, s51, 0x80010
    s_lshl_b32 s44, s44, 14
    s_add_u32 m0, s42, 98304
    s_nop 0
    buffer_load_dwordx4 v244, s[28:31], s44 offen offset:0 sc1 lds
    buffer_load_dwordx4 v244, s[28:31], s44 offen offset:1024 sc1 lds
    buffer_load_dwordx4 v244, s[28:31], s44 offen offset:2048 sc1 lds
    buffer_load_dwordx4 v244, s[28:31], s44 offen offset:3072 sc1 lds
    s_waitcnt vmcnt(16)
    s_cmp_eq_u64 s[22:23], 0
    s_cbranch_scc1 GDg2_23_ok
    s_bfe_u32 s44, s51, 0x80018
    s_and_b32 s44, s44, 0xfe
    s_lshl_b32 s44, s44, 1
    s_mov_b32 s15, 200000
GDg2_23:
    s_lshr_b64 s[16:17], s[22:23], s44
    s_and_b32 s16, s16, 15
    s_cbranch_scc0 GDg2_23_ok
    buffer_load_dword v24, v23, s[28:31], s53 offen sc1
    s_waitcnt vmcnt(0)
    v_xor_b32 v24, s3, v24
    v_cmp_ne_u32 vcc, 0, v24
    s_sub_u32 s15, s15, 1
    s_cselect_b64 s[22:23], 0, vcc
    s_branch GDg2_23
GDg2_23_ok:
    s_barrier
    s_bfe_u32 s43, s51, 0x80018
    s_lshl_b32 s43, s43, 18
    s_add_u32 m0, s42, 49152
    s_nop 0
    buffer_load_dwordx4 v240, s[32:35], s43 offen offset:0  lds
    buffer_load_dwordx4 v241, s[32:35], s43 offen offset:1024  lds
    buffer_load_dwordx4 v242, s[32:35], s43 offen offset:2048  lds
    buffer_load_dwordx4 v243, s[32:35], s43 offen offset:3072  lds
    s_bfe_u32 s44, s51, 0x80018
    s_lshl_b32 s44, s44, 14
    s_add_u32 m0, s42, 114688
    s_nop 0
    buffer_load_dwordx4 v244, s[28:31], s44 offen offset:0 sc1 lds
    buffer_load_dwordx4 v244, s[28:31], s44 offen offset:1024 sc1 lds
    buffer_load_dwordx4 v244, s[28:31], s44 offen offset:2048 sc1 lds
    buffer_load_dwordx4 v244, s[28:31], s44 offen offset:3072 sc1 lds
    s_waitcnt vmcnt(16)
    s_cmp_eq_u64 s[22:23], 0
    s_cbranch_scc1 GDg2_24_ok
    s_bfe_u32 s44, s52, 0x80000
    s_and_b32 s44, s44, 0xfe
    s_lshl_b32 s44, s44, 1
    s_mov_b32 s15, 200000
GDg2_24:
    s_lshr_b64 s[16:17], s[22:23], s44
    s_and_b32 s16, s16, 15
    s_cbranch_scc0 GDg2_24_ok
    buffer_load_dword v24, v23, s[28:31], s53 offen sc1
    s_waitcnt vmcnt(0)
    v_xor_b32 v24, s3, v24
    v_cmp_ne_u32 vcc, 0, v24
    s_sub_u32 s15, s15, 1
    s_cselect_b64 s[22:23], 0, vcc
    s_branch GDg2_24
GDg2_24_ok:
    s_barrier
    s_bfe_u32 s43, s52, 0x80000
    s_lshl_b32 s43, s43, 18
    s_add_u32 m0, s42, 0
    s_nop 0
    buffer_load_dwordx4 v240, s[32:35], s43 offen offset:0  lds
    buffer_load_dwordx4 v241, s[32:35], s43 offen offset:1024  lds
    buffer_load_dwordx4 v242, s[32:35], s43 offen offset:2048  lds
    buffer_load_dwordx4 v243, s[32:35], s43 offen offset:3072  lds
    s_bfe_u32 s44, s52, 0x80000
    s_lshl_b32 s44, s44, 14
    s_add_u32 m0, s42, 65536
    s_nop 0
    buffer_load_dwordx4 v244, s[28:31], s44 offen offset:0 sc1 lds
    buffer_load_dwordx4 v244, s[28:31], s44 offen offset:1024 sc1 lds
    buffer_load_dwordx4 v244, s[28:31], s44 offen offset:2048 sc1 lds
    buffer_load_dwordx4 v244, s[28:31], s44 offen offset:3072 sc1 lds
    s_mov_b32 s19, 0x3008000
    buffer_load_dword v25, v27, s[28:31], s19 offen sc1
    s_waitcnt vmcnt(17)
    s_cmp_eq_u64 s[22:23], 0
    s_cbranch_scc1 GDg2_25_ok
    s_bfe_u32 s44, s52, 0x80008
    s_and_b32 s44, s44, 0xfe
    s_lshl_b32 s44, s44, 1
    s_mov_b32 s15, 200000
GDg2_25:
    s_lshr_b64 s[16:17], s[22:23], s44
    s_and_b32 s16, s16, 15
    s_cbranch_scc0 GDg2_25_ok
    buffer_load_dword v24, v23, s[28:31], s53 offen sc1
    s_waitcnt vmcnt(0)
    v_xor_b32 v24, s3, v24
    v_cmp_ne_u32 vcc, 0, v24
    s_sub_u32 s15, s15, 1
    s_cselect_b64 s[22:23], 0, vcc
    s_branch GDg2_25
GDg2_25_ok:
    s_barrier
    s_bfe_u32 s43, s52, 0x80008
    s_lshl_b32 s43, s43, 18
    s_add_u32 m0, s42, 16384
    s_nop 0
    buffer_load_dwordx4 v240, s[32:35], s43 offen offset:0  lds
    buffer_load_dwordx4 v241, s[32:35], s43 offen offset:1024  lds
    buffer_load_dwordx4 v242, s[32:35], s43 offen offset:2048  lds
    buffer_load_dwordx4 v243, s[32:35], s43 offen offset:3072  lds
    s_bfe_u32 s44, s52, 0x80008
    s_lshl_b32 s44, s44, 14
    s_add_u32 m0, s42, 81920
    s_nop 0
    buffer_load_dwordx4 v244, s[28:31], s44 offen offset:0 sc1 lds
    buffer_load_dwordx4 v244, s[28:31], s44 offen offset:1024 sc1 lds
    buffer_load_dwordx4 v244, s[28:31], s44 offen offset:2048 sc1 lds
    buffer_load_dwordx4 v244, s[28:31], s44 offen offset:3072 sc1 lds
    s_waitcnt vmcnt(17)
    s_cmp_eq_u64 s[22:23], 0
    s_cbranch_scc1 GDg2_26_ok
    s_bfe_u32 s44, s52, 0x80010
    s_and_b32 s44, s44, 0xfe
    s_lshl_b32 s44, s44, 1
    s_mov_b32 s15, 200000
GDg2_26:
    s_lshr_b64 s[16:17], s[22:23], s44
    s_and_b32 s16, s16, 15
    s_cbranch_scc0 GDg2_26_ok
    buffer_load_dword v24, v23, s[28:31], s53 offen sc1
    s_waitcnt vmcnt(0)
    v_xor_b32 v24, s3, v24
    v_cmp_ne_u32 vcc, 0, v24
    s_sub_u32 s15, s15, 1
    s_cselect_b64 s[22:23], 0, vcc
    s_branch GDg2_26
GDg2_26_ok:
    s_barrier
    s_bfe_u32 s43, s52, 0x80010
    s_lshl_b32 s43, s43, 18
    s_add_u32 m0, s42, 32768
    s_nop 0
    buffer_load_dwordx4 v240, s[32:35], s43 offen offset:0  lds
    buffer_load_dwordx4 v241, s[32:35], s43 offen offset:1024  lds
    buffer_load_dwordx4 v242, s[32:35], s43 offen offset:2048  lds
    buffer_load_dwordx4 v243, s[32:35], s43 offen offset:3072  lds
    s_bfe_u32 s44, s52, 0x80010
    s_lshl_b32 s44, s44, 14
    s_add_u32 m0, s42, 98304
    s_nop 0
    buffer_load_dwordx4 v244, s[28:31], s44 offen offset:0 sc1 lds
    buffer_load_dwordx4 v244, s[28:31], s44 offen offset:1024 sc1 lds
    buffer_load_dwordx4 v244, s[28:31], s44 offen offset:2048 sc1 lds
    buffer_load_dwordx4 v244, s[28:31], s44 offen offset:3072 sc1 lds
    s_waitcnt vmcnt(17)
    s_cmp_eq_u64 s[22:23], 0
    s_cbranch_scc1 GDg2_27_ok
    s_bfe_u32 s44, s52, 0x80018
    s_and_b32 s44, s44, 0xfe
    s_lshl_b32 s44, s44, 1
    s_mov_b32 s15, 200000
GDg2_27:
    s_lshr_b64 s[16:17], s[22:23], s44
    s_and_b32 s16, s16, 15
    s_cbranch_scc0 GDg2_27_ok
    buffer_load_dword v24, v23, s[28:31], s53 offen sc1
    s_waitcnt vmcnt(0)
    v_xor_b32 v24, s3, v24
    v_cmp_ne_u32 vcc, 0, v24
    s_sub_u32 s15, s15, 1
    s_cselect_b64 s[22:23], 0, vcc
    s_branch GDg2_27
GDg2_27_ok:
    s_barrier
    s_bfe_u32 s43, s52, 0x80018
    s_lshl_b32 s43, s43, 18
    s_add_u32 m0, s42, 49152
    s_nop 0
    buffer_load_dwordx4 v240, s[32:35], s43 offen offset:0  lds
    buffer_load_dwordx4 v241, s[32:35], s43 offen offset:1024  lds
    buffer_load_dwordx4 v242, s[32:35], s43 offen offset:2048  lds
    buffer_load_dwordx4 v243, s[32:35], s43 offen offset:3072  lds
    s_bfe_u32 s44, s52, 0x80018
    s_lshl_b32 s44, s44, 14
    s_add_u32 m0, s42, 114688
    s_nop 0
    buffer_load_dwordx4 v244, s[28:31], s44 offen offset:0 sc1 lds
    buffer_load_dwordx4 v244, s[28:31], s44 offen offset:1024 sc1 lds
    buffer_load_dwordx4 v244, s[28:31], s44 offen offset:2048 sc1 lds
    buffer_load_dwordx4 v244, s[28:31], s44 offen offset:3072 sc1 lds
    s_waitcnt vmcnt(24)
    v_xor_b32 v25, s3, v25
    v_cmp_ne_u32 vcc, 0, v25
    s_cbranch_vccz G2L_bok
    s_mov_b32 s16, 200000
G2L_bp:
    buffer_load_dword v25, v27, s[28:31], s19 offen sc1
    s_sub_u32 s16, s16, 1
    s_cbranch_scc1 G2L_bp_out
    s_waitcnt vmcnt(0)
    v_xor_b32 v25, s3, v25
    v_cmp_ne_u32 vcc, 0, v25
    s_cbranch_vccnz G2L_bp
G2L_bp_out:
G2L_bok:
    s_mul_i32 s19, s2, 0x4000
    s_add_u32 s19, s19, s42
    s_add_u32 s19, s19, 0x1800000
    s_add_u32 m0, s42, 131072
    s_nop 0
    buffer_load_dwordx4 v26, s[28:31], s19 offen offset:0 sc1 lds
    buffer_load_dwordx4 v26, s[28:31], s19 offen offset:1024 sc1 lds
    buffer_load_dwordx4 v26, s[28:31], s19 offen offset:2048 sc1 lds
    buffer_load_dwordx4 v26, s[28:31], s19 offen offset:3072 sc1 lds
    s_lshr_b32 s19, s18, 9
    s_add_u32 s19, s19, 0x1d00000
    buffer_load_dwordx2 v[88:89], v35, s[28:31], s19 offen sc1
    s_lshr_b32 s19, s18, 10
    buffer_load_dword v90, v35, s[24:27], s19 offen
    s_waitcnt vmcnt(22)
    s_barrier
    s_mov_b32 s32, s8
    s_and_b32 s33, s9, 0xffff
    s_mov_b32 s34, 0x400000
    s_mov_b32 s35, 0x20000
    s_waitcnt vmcnt(14)
    s_barrier
    s_waitcnt vmcnt(6)
    s_barrier
    s_waitcnt vmcnt(0)
    s_mov_b64 exec, 1
    ds_add_u32 v12, v13 offset:44
    s_mov_b64 exec, -1
    s_mov_b32 s16, 3200000
C2R_s:
    ds_read_b32 v24, v12 offset:44
    s_sub_u32 s16, s16, 1
    s_cbranch_scc1 C2R_s_out
    s_waitcnt lgkmcnt(0)
    v_cmp_ne_u32 vcc, 4, v24
    s_cbranch_vccnz C2R_s
C2R_s_out:
    ds_read_b128 v[56:59], v28 offset:0
    ds_read_b128 v[60:63], v28 offset:8192
    ds_read_b128 v[64:67], v32 offset:0
    ds_read_b128 v[68:71], v32 offset:8192
    s_waitcnt lgkmcnt(0)
    v_mfma_f32_32x32x16_bf16 v[96:111], v[56:59], v[160:163], 0
    v_mfma_f32_32x32x16_bf16 v[112:127], v[56:59], v[176:179], 0
    v_mfma_f32_32x32x16_bf16 v[96:111], v[60:63], v[164:167], v[96:111]
    v_mfma_f32_32x32x16_bf16 v[112:127], v[60:63], v[180:183], v[112:127]
    v_mfma_f32_32x32x16_bf16 v[128:143], v[64:67], v[160:163], 0
    v_mfma_f32_32x32x16_bf16 v[144:159], v[64:67], v[176:179], 0
    v_mfma_f32_32x32x16_bf16 v[128:143], v[68:71], v[164:167], v[128:143]
    v_mfma_f32_32x32x16_bf16 v[144:159], v[68:71], v[180:183], v[144:159]
    s_nop 6
    v_mul_f32 v40, v96, v192
    v_mul_f32 v41, v97, v193
    v_mul_f32 v42, v98, v194
    v_mul_f32 v43, v99, v195
    v_mul_f32 v44, v112, v192
    v_mul_f32 v45, v113, v193
    v_mul_f32 v46, v114, v194
    v_mul_f32 v47, v115, v195
    v_fmac_f32 v40, v112, v208
    v_fmac_f32 v41, v113, v209
    v_fmac_f32 v42, v114, v210
    v_fmac_f32 v43, v115, v211
    v_fma_f32 v44, -v96, v208, v44
    v_fma_f32 v45, -v97, v209, v45
    v_fma_f32 v46, -v98, v210, v46
    v_fma_f32 v47, -v99, v211, v47
    v_cvt_pk_bf16_f32 v224, v40, v41
    v_cvt_pk_bf16_f32 v225, v42, v43
    v_cvt_pk_bf16_f32 v226, v44, v45
    v_cvt_pk_bf16_f32 v227, v46, v47
    v_mul_f32 v40, v100, v196
    v_mul_f32 v41, v101, v197
    v_mul_f32 v42, v102, v198
    v_mul_f32 v43, v103, v199
    v_mul_f32 v44, v116, v196
    v_mul_f32 v45, v117, v197
    v_mul_f32 v46, v118, v198
    v_mul_f32 v47, v119, v199
    v_fmac_f32 v40, v116, v212
    v_fmac_f32 v41, v117, v213
    v_fmac_f32 v42, v118, v214
    v_fmac_f32 v43, v119, v215
    v_fma_f32 v44, -v100, v212, v44
    v_fma_f32 v45, -v101, v213, v45
    v_fma_f32 v46, -v102, v214, v46
    v_fma_f32 v47, -v103, v215, v47
    v_cvt_pk_bf16_f32 v228, v40, v41
    v_cvt_pk_bf16_f32 v229, v42, v43
    v_cvt_pk_bf16_f32 v230, v44, v45
    v_cvt_pk_bf16_f32 v231, v46, v47
    v_mul_f32 v40, v104, v200
    v_mul_f32 v41, v105, v201
    v_mul_f32 v42, v106, v202
    v_mul_f32 v43, v107, v203
    v_mul_f32 v44, v120, v200
    v_mul_f32 v45, v121, v201
    v_mul_f32 v46, v122, v202
    v_mul_f32 v47, v123, v203
    v_fmac_f32 v40, v120, v216
    v_fmac_f32 v41, v121, v217
    v_fmac_f32 v42, v122, v218
    v_fmac_f32 v43, v123, v219
    v_fma_f32 v44, -v104, v216, v44
    v_fma_f32 v45, -v105, v217, v45
    v_fma_f32 v46, -v106, v218, v46
    v_fma_f32 v47, -v107, v219, v47
    v_cvt_pk_bf16_f32 v232, v40, v41
    v_cvt_pk_bf16_f32 v233, v42, v43
    v_cvt_pk_bf16_f32 v234, v44, v45
    v_cvt_pk_bf16_f32 v235, v46, v47
    v_mul_f32 v40, v108, v204
    v_mul_f32 v41, v109, v205
    v_mul_f32 v42, v110, v206
    v_mul_f32 v43, v111, v207
    v_mul_f32 v44, v124, v204
    v_mul_f32 v45, v125, v205
    v_mul_f32 v46, v126, v206
    v_mul_f32 v47, v127, v207
    v_fmac_f32 v40, v124, v220
    v_fmac_f32 v41, v125, v221
    v_fmac_f32 v42, v126, v222
    v_fmac_f32 v43, v127, v223
    v_fma_f32 v44, -v108, v220, v44
    v_fma_f32 v45, -v109, v221, v45
    v_fma_f32 v46, -v110, v222, v46
    v_fma_f32 v47, -v111, v223, v47
    v_cvt_pk_bf16_f32 v236, v40, v41
    v_cvt_pk_bf16_f32 v237, v42, v43
    v_cvt_pk_bf16_f32 v238, v44, v45
    v_cvt_pk_bf16_f32 v239, v46, v47
    v_mfma_f32_32x32x16_bf16 v[96:111], v[224:227], v[160:163], 0
    v_mul_f32 v40, v128, v192
    v_mul_f32 v41, v129, v193
    v_mul_f32 v42, v130, v194
    v_mul_f32 v43, v131, v195
    v_mul_f32 v44, v144, v192
    v_mul_f32 v45, v145, v193
    v_mul_f32 v46, v146, v194
    v_mul_f32 v47, v147, v195
    v_fmac_f32 v40, v144, v208
    v_fmac_f32 v41, v145, v209
    v_fmac_f32 v42, v146, v210
    v_fmac_f32 v43, v147, v211
    v_fma_f32 v44, -v128, v208, v44
    v_fma_f32 v45, -v129, v209, v45
    v_fma_f32 v46, -v130, v210, v46
    v_fma_f32 v47, -v131, v211, v47
    v_cvt_pk_bf16_f32 v56, v40, v41
    v_cvt_pk_bf16_f32 v57, v42, v43
    v_cvt_pk_bf16_f32 v58, v44, v45
    v_cvt_pk_bf16_f32 v59, v46, v47
    v_mfma_f32_32x32x16_bf16 v[96:111], v[228:231], v[164:167], v[96:111]
    v_mul_f32 v40, v132, v196
    v_mul_f32 v41, v133, v197
    v_mul_f32 v42, v134, v198
    v_mul_f32 v43, v135, v199
    v_mul_f32 v44, v148, v196
    v_mul_f32 v45, v149, v197
    v_mul_f32 v46, v150, v198
    v_mul_f32 v47, v151, v199
    v_fmac_f32 v40, v148, v212
    v_fmac_f32 v41, v149, v213
    v_fmac_f32 v42, v150, v214
    v_fmac_f32 v43, v151, v215
    v_fma_f32 v44, -v132, v212, v44
    v_fma_f32 v45, -v133, v213, v45
    v_fma_f32 v46, -v134, v214, v46
    v_fma_f32 v47, -v135, v215, v47
    v_cvt_pk_bf16_f32 v60, v40, v41
    v_cvt_pk_bf16_f32 v61, v42, v43
    v_cvt_pk_bf16_f32 v62, v44, v45
    v_cvt_pk_bf16_f32 v63, v46, v47
    v_mfma_f32_32x32x16_bf16 v[96:111], v[232:235], v[168:171], v[96:111]
    v_mul_f32 v40, v136, v200
    v_mul_f32 v41, v137, v201
    v_mul_f32 v42, v138, v202
    v_mul_f32 v43, v139, v203
    v_mul_f32 v44, v152, v200
    v_mul_f32 v45, v153, v201
    v_mul_f32 v46, v154, v202
    v_mul_f32 v47, v155, v203
    v_fmac_f32 v40, v152, v216
    v_fmac_f32 v41, v153, v217
    v_fmac_f32 v42, v154, v218
    v_fmac_f32 v43, v155, v219
    v_fma_f32 v44, -v136, v216, v44
    v_fma_f32 v45, -v137, v217, v45
    v_fma_f32 v46, -v138, v218, v46
    v_fma_f32 v47, -v139, v219, v47
    v_cvt_pk_bf16_f32 v64, v40, v41
    v_cvt_pk_bf16_f32 v65, v42, v43
    v_cvt_pk_bf16_f32 v66, v44, v45
    v_cvt_pk_bf16_f32 v67, v46, v47
    v_mfma_f32_32x32x16_bf16 v[96:111], v[236:239], v[172:175], v[96:111]
    v_mul_f32 v40, v140, v204
    v_mul_f32 v41, v141, v205
    v_mul_f32 v42, v142, v206
    v_mul_f32 v43, v143, v207
    v_mul_f32 v44, v156, v204
    v_mul_f32 v45, v157, v205
    v_mul_f32 v46, v158, v206
    v_mul_f32 v47, v159, v207
    v_fmac_f32 v40, v156, v220
    v_fmac_f32 v41, v157, v221
    v_fmac_f32 v42, v158, v222
    v_fmac_f32 v43, v159, v223
    v_fma_f32 v44, -v140, v220, v44
    v_fma_f32 v45, -v141, v221, v45
    v_fma_f32 v46, -v142, v222, v46
    v_fma_f32 v47, -v143, v223, v47
    v_cvt_pk_bf16_f32 v68, v40, v41
    v_cvt_pk_bf16_f32 v69, v42, v43
    v_cvt_pk_bf16_f32 v70, v44, v45
    v_cvt_pk_bf16_f32 v71, v46, v47
    v_mfma_f32_32x32x16_bf16 v[128:143], v[56:59], v[160:163], 0
    v_cvt_pk_bf16_f32 v40, v96, v97
    v_cvt_pk_bf16_f32 v41, v98, v99
    v_xor_b32 v48, 0, v30
    ds_write_b64 v48, v[40:41] offset:0
    v_mfma_f32_32x32x16_bf16 v[128:143], v[60:63], v[164:167], v[128:143]
    v_cvt_pk_bf16_f32 v42, v100, v101
    v_cvt_pk_bf16_f32 v43, v102, v103
    v_xor_b32 v49, 16, v30
    ds_write_b64 v49, v[42:43] offset:0
    v_mfma_f32_32x32x16_bf16 v[128:143], v[64:67], v[168:171], v[128:143]
    v_cvt_pk_bf16_f32 v44, v104, v105
    v_cvt_pk_bf16_f32 v45, v106, v107
    v_xor_b32 v50, 32, v30
    ds_write_b64 v50, v[44:45] offset:0
    v_mfma_f32_32x32x16_bf16 v[128:143], v[68:71], v[172:175], v[128:143]
    v_cvt_pk_bf16_f32 v46, v108, v109
    v_cvt_pk_bf16_f32 v47, v110, v111
    v_xor_b32 v51, 48, v30
    ds_write_b64 v51, v[46:47] offset:0
    s_nop 7
    v_cvt_pk_bf16_f32 v40, v128, v129
    v_cvt_pk_bf16_f32 v41, v130, v131
    v_xor_b32 v48, 0, v30
    ds_write_b64 v48, v[40:41] offset:2048
    v_cvt_pk_bf16_f32 v42, v132, v133
    v_cvt_pk_bf16_f32 v43, v134, v135
    v_xor_b32 v49, 16, v30
    ds_write_b64 v49, v[42:43] offset:2048
    v_cvt_pk_bf16_f32 v44, v136, v137
    v_cvt_pk_bf16_f32 v45, v138, v139
    v_xor_b32 v50, 32, v30
    ds_write_b64 v50, v[44:45] offset:2048
    v_cvt_pk_bf16_f32 v46, v140, v141
    v_cvt_pk_bf16_f32 v47, v142, v143
    v_xor_b32 v51, 48, v30
    ds_write_b64 v51, v[46:47] offset:2048
    ds_read_b128 v[224:227], v31 offset:0
    ds_read_b128 v[228:231], v31 offset:1024
    ds_read_b128 v[232:235], v31 offset:2048
    ds_read_b128 v[236:239], v31 offset:3072
    v_lshlrev_b32 v92, 16, v90
    v_and_b32 v94, 0xffff0000, v90
    v_fma_f32 v93, -v88, v36, v92
    v_fmac_f32 v92, v88, v36
    v_fma_f32 v95, -v89, v36, v94
    v_fmac_f32 v94, v89, v36
    v_lshlrev_b32 v96, 16, v72
    v_and_b32 v97, 0xffff0000, v72
    v_lshlrev_b32 v98, 16, v73
    v_and_b32 v99, 0xffff0000, v73
    v_lshlrev_b32 v100, 16, v74
    v_and_b32 v101, 0xffff0000, v74
    v_lshlrev_b32 v102, 16, v75
    v_and_b32 v103, 0xffff0000, v75
    v_pk_add_f32 v[96:97], v[96:97], v[92:93]
    v_pk_add_f32 v[98:99], v[98:99], v[92:93]
    v_pk_add_f32 v[100:101], v[100:101], v[92:93]
    v_pk_add_f32 v[102:103], v[102:103], v[92:93]
    s_waitcnt lgkmcnt(3)
    v_lshlrev_b32 v104, 16, v224
    v_and_b32 v105, 0xffff0000, v224
    v_lshlrev_b32 v106, 16, v225
    v_and_b32 v107, 0xffff0000, v225
    v_lshlrev_b32 v108, 16, v226
    v_and_b32 v109, 0xffff0000, v226
    v_lshlrev_b32 v110, 16, v227
    v_and_b32 v111, 0xffff0000, v227
    v_fmac_f32 v96, v104, v36
    v_fmac_f32 v97, v105, v36
    v_fmac_f32 v98, v106, v36
    v_fmac_f32 v99, v107, v36
    v_fmac_f32 v100, v108, v36
    v_fmac_f32 v101, v109, v36
    v_fmac_f32 v102, v110, v36
    v_fmac_f32 v103, v111, v36
    v_lshlrev_b32 v112, 16, v76
    v_and_b32 v113, 0xffff0000, v76
    v_lshlrev_b32 v114, 16, v77
    v_and_b32 v115, 0xffff0000, v77
    v_lshlrev_b32 v116, 16, v78
    v_and_b32 v117, 0xffff0000, v78
    v_lshlrev_b32 v118, 16, v79
    v_and_b32 v119, 0xffff0000, v79
    v_pk_add_f32 v[112:113], v[112:113], v[92:93]
    v_pk_add_f32 v[114:115], v[114:115], v[92:93]
    v_pk_add_f32 v[116:117], v[116:117], v[92:93]
    v_pk_add_f32 v[118:119], v[118:119], v[92:93]
    s_waitcnt lgkmcnt(2)
    v_lshlrev_b32 v120, 16, v228
    v_and_b32 v121, 0xffff0000, v228
    v_lshlrev_b32 v122, 16, v229
    v_and_b32 v123, 0xffff0000, v229
    v_lshlrev_b32 v124, 16, v230
    v_and_b32 v125, 0xffff0000, v230
    v_lshlrev_b32 v126, 16, v231
    v_and_b32 v127, 0xffff0000, v231
    v_fmac_f32 v112, v120, v36
    v_fmac_f32 v113, v121, v36
    v_fmac_f32 v114, v122, v36
    v_fmac_f32 v115, v123, v36
    v_fmac_f32 v116, v124, v36
    v_fmac_f32 v117, v125, v36
    v_fmac_f32 v118, v126, v36
    v_fmac_f32 v119, v127, v36
    v_lshlrev_b32 v128, 16, v80
    v_and_b32 v129, 0xffff0000, v80
    v_lshlrev_b32 v130, 16, v81
    v_and_b32 v131, 0xffff0000, v81
    v_lshlrev_b32 v132, 16, v82
    v_and_b32 v133, 0xffff0000, v82
    v_lshlrev_b32 v134, 16, v83
    v_and_b32 v135, 0xffff0000, v83
    v_pk_add_f32 v[128:129], v[128:129], v[94:95]
    v_pk_add_f32 v[130:131], v[130:131], v[94:95]
    v_pk_add_f32 v[132:133], v[132:133], v[94:95]
    v_pk_add_f32 v[134:135], v[134:135], v[94:95]
    s_waitcnt lgkmcnt(1)
    v_lshlrev_b32 v136, 16, v232
    v_and_b32 v137, 0xffff0000, v232
    v_lshlrev_b32 v138, 16, v233
    v_and_b32 v139, 0xffff0000, v233
    v_lshlrev_b32 v140, 16, v234
    v_and_b32 v141, 0xffff0000, v234
    v_lshlrev_b32 v142, 16, v235
    v_and_b32 v143, 0xffff0000, v235
    v_fmac_f32 v128, v136, v36
    v_fmac_f32 v129, v137, v36
    v_fmac_f32 v130, v138, v36
    v_fmac_f32 v131, v139, v36
    v_fmac_f32 v132, v140, v36
    v_fmac_f32 v133, v141, v36
    v_fmac_f32 v134, v142, v36
    v_fmac_f32 v135, v143, v36
    v_lshlrev_b32 v144, 16, v84
    v_and_b32 v145, 0xffff0000, v84
    v_lshlrev_b32 v146, 16, v85
    v_and_b32 v147, 0xffff0000, v85
    v_lshlrev_b32 v148, 16, v86
    v_and_b32 v149, 0xffff0000, v86
    v_lshlrev_b32 v150, 16, v87
    v_and_b32 v151, 0xffff0000, v87
    v_pk_add_f32 v[144:145], v[144:145], v[94:95]
    v_pk_add_f32 v[146:147], v[146:147], v[94:95]
    v_pk_add_f32 v[148:149], v[148:149], v[94:95]
    v_pk_add_f32 v[150:151], v[150:151], v[94:95]
    s_waitcnt lgkmcnt(0)
    v_lshlrev_b32 v152, 16, v236
    v_and_b32 v153, 0xffff0000, v236
    v_lshlrev_b32 v154, 16, v237
    v_and_b32 v155, 0xffff0000, v237
    v_lshlrev_b32 v156, 16, v238
    v_and_b32 v157, 0xffff0000, v238
    v_lshlrev_b32 v158, 16, v239
    v_and_b32 v159, 0xffff0000, v239
    v_fmac_f32 v144, v152, v36
    v_fmac_f32 v145, v153, v36
    v_fmac_f32 v146, v154, v36
    v_fmac_f32 v147, v155, v36
    v_fmac_f32 v148, v156, v36
    v_fmac_f32 v149, v157, v36
    v_fmac_f32 v150, v158, v36
    v_fmac_f32 v151, v159, v36
    s_cmp_lg_u32 s12, 4
    s_cbranch_scc1 FING_g1
    s_lshl_b32 s15, s54, 3
    s_add_u32 s15, s15, s55
    s_lshl_b32 s15, s15, 12
    s_add_u32 s15, s15, 0x3010000
    v_lshlrev_b32 v27, 7, v33
    s_mov_b32 s16, 3200000
FIN_o:
    ds_read_b32 v24, v12 offset:40
    s_sub_u32 s16, s16, 1
    s_cbranch_scc1 FIN_o_out
    s_waitcnt lgkmcnt(0)
    v_cmp_ne_u32 vcc, 4, v24
    s_cbranch_vccnz FIN_o
FIN_o_out:
    s_mov_b32 s16, 200000
FIN_p:
    buffer_load_dword v24, v27, s[28:31], s15 offen sc1
    s_sub_u32 s16, s16, 1
    s_cbranch_scc1 FIN_p_out
    s_waitcnt vmcnt(0)
    v_xor_b32 v24, s3, v24
    v_cmp_ne_u32 vcc, 0, v24
    s_cbranch_vccnz FIN_p
FIN_p_out:
FING_open:
    v_mov_b32 v24, 1
    ds_write_b32 v12, v24 offset:32
    s_branch FING_g2
FING_g1:
    s_mov_b32 s16, 3200000
FING_gs:
    ds_read_b32 v24, v12 offset:32
    s_sub_u32 s16, s16, 1
    s_cbranch_scc1 FING_gs_out
    s_waitcnt lgkmcnt(0)
    v_cmp_ne_u32 vcc, 1, v24
    s_cbranch_vccnz FING_gs
FING_gs_out:
FING_g2:
    s_add_u32 s19, s18, 0x900000
    s_add_u32 s20, s19, 0x1700000
    buffer_load_dwordx4 v[56:59], v29, s[28:31], s19 offen offset:0 sc1
    buffer_load_dwordx4 v[60:63], v29, s[28:31], s20 offen offset:0 sc1
    buffer_load_dwordx4 v[64:67], v29, s[28:31], s19 offen offset:1024 sc1
    buffer_load_dwordx4 v[68:71], v29, s[28:31], s20 offen offset:1024 sc1
    buffer_load_dwordx4 v[72:75], v29, s[28:31], s19 offen offset:2048 sc1
    buffer_load_dwordx4 v[76:79], v29, s[28:31], s20 offen offset:2048 sc1
    buffer_load_dwordx4 v[80:83], v29, s[28:31], s19 offen offset:3072 sc1
    buffer_load_dwordx4 v[84:87], v29, s[28:31], s20 offen offset:3072 sc1
    s_waitcnt vmcnt(7)
    v_lshlrev_b32 v104, 16, v56
    v_and_b32 v105, 0xffff0000, v56
    v_lshlrev_b32 v106, 16, v57
    v_and_b32 v107, 0xffff0000, v57
    v_lshlrev_b32 v108, 16, v58
    v_and_b32 v109, 0xffff0000, v58
    v_lshlrev_b32 v110, 16, v59
    v_and_b32 v111, 0xffff0000, v59
    v_pk_add_f32 v[96:97], v[96:97], v[104:105]
    v_pk_add_f32 v[98:99], v[98:99], v[106:107]
    v_pk_add_f32 v[100:101], v[100:101], v[108:109]
    v_pk_add_f32 v[102:103], v[102:103], v[110:111]
    s_waitcnt vmcnt(6)
    v_lshlrev_b32 v104, 16, v60
    v_and_b32 v105, 0xffff0000, v60
    v_lshlrev_b32 v106, 16, v61
    v_and_b32 v107, 0xffff0000, v61
    v_lshlrev_b32 v108, 16, v62
    v_and_b32 v109, 0xffff0000, v62
    v_lshlrev_b32 v110, 16, v63
    v_and_b32 v111, 0xffff0000, v63
    v_pk_add_f32 v[96:97], v[96:97], v[104:105]
    v_pk_add_f32 v[98:99], v[98:99], v[106:107]
    v_pk_add_f32 v[100:101], v[100:101], v[108:109]
    v_pk_add_f32 v[102:103], v[102:103], v[110:111]
    v_cvt_pk_bf16_f32 v104, v96, v97
    v_cvt_pk_bf16_f32 v105, v98, v99
    v_cvt_pk_bf16_f32 v106, v100, v101
    v_cvt_pk_bf16_f32 v107, v102, v103
    buffer_store_dwordx4 v[104:107], v29, s[32:35], s18 offen offset:0
    s_waitcnt vmcnt(6)
    v_lshlrev_b32 v120, 16, v64
    v_and_b32 v121, 0xffff0000, v64
    v_lshlrev_b32 v122, 16, v65
    v_and_b32 v123, 0xffff0000, v65
    v_lshlrev_b32 v124, 16, v66
    v_and_b32 v125, 0xffff0000, v66
    v_lshlrev_b32 v126, 16, v67
    v_and_b32 v127, 0xffff0000, v67
    v_pk_add_f32 v[112:113], v[112:113], v[120:121]
    v_pk_add_f32 v[114:115], v[114:115], v[122:123]
    v_pk_add_f32 v[116:117], v[116:117], v[124:125]
    v_pk_add_f32 v[118:119], v[118:119], v[126:127]
    s_waitcnt vmcnt(5)
    v_lshlrev_b32 v120, 16, v68
    v_and_b32 v121, 0xffff0000, v68
    v_lshlrev_b32 v122, 16, v69
    v_and_b32 v123, 0xffff0000, v69
    v_lshlrev_b32 v124, 16, v70
    v_and_b32 v125, 0xffff0000, v70
    v_lshlrev_b32 v126, 16, v71
    v_and_b32 v127, 0xffff0000, v71
    v_pk_add_f32 v[112:113], v[112:113], v[120:121]
    v_pk_add_f32 v[114:115], v[114:115], v[122:123]
    v_pk_add_f32 v[116:117], v[116:117], v[124:125]
    v_pk_add_f32 v[118:119], v[118:119], v[126:127]
    v_cvt_pk_bf16_f32 v120, v112, v113
    v_cvt_pk_bf16_f32 v121, v114, v115
    v_cvt_pk_bf16_f32 v122, v116, v117
    v_cvt_pk_bf16_f32 v123, v118, v119
    buffer_store_dwordx4 v[120:123], v29, s[32:35], s18 offen offset:1024
    s_waitcnt vmcnt(5)
    v_lshlrev_b32 v136, 16, v72
    v_and_b32 v137, 0xffff0000, v72
    v_lshlrev_b32 v138, 16, v73
    v_and_b32 v139, 0xffff0000, v73
    v_lshlrev_b32 v140, 16, v74
    v_and_b32 v141, 0xffff0000, v74
    v_lshlrev_b32 v142, 16, v75
    v_and_b32 v143, 0xffff0000, v75
    v_pk_add_f32 v[128:129], v[128:129], v[136:137]
    v_pk_add_f32 v[130:131], v[130:131], v[138:139]
    v_pk_add_f32 v[132:133], v[132:133], v[140:141]
    v_pk_add_f32 v[134:135], v[134:135], v[142:143]
    s_waitcnt vmcnt(4)
    v_lshlrev_b32 v136, 16, v76
    v_and_b32 v137, 0xffff0000, v76
    v_lshlrev_b32 v138, 16, v77
    v_and_b32 v139, 0xffff0000, v77
    v_lshlrev_b32 v140, 16, v78
    v_and_b32 v141, 0xffff0000, v78
    v_lshlrev_b32 v142, 16, v79
    v_and_b32 v143, 0xffff0000, v79
    v_pk_add_f32 v[128:129], v[128:129], v[136:137]
    v_pk_add_f32 v[130:131], v[130:131], v[138:139]
    v_pk_add_f32 v[132:133], v[132:133], v[140:141]
    v_pk_add_f32 v[134:135], v[134:135], v[142:143]
    v_cvt_pk_bf16_f32 v136, v128, v129
    v_cvt_pk_bf16_f32 v137, v130, v131
    v_cvt_pk_bf16_f32 v138, v132, v133
    v_cvt_pk_bf16_f32 v139, v134, v135
    buffer_store_dwordx4 v[136:139], v29, s[32:35], s18 offen offset:2048
    s_waitcnt vmcnt(4)
    v_lshlrev_b32 v152, 16, v80
    v_and_b32 v153, 0xffff0000, v80
    v_lshlrev_b32 v154, 16, v81
    v_and_b32 v155, 0xffff0000, v81
    v_lshlrev_b32 v156, 16, v82
    v_and_b32 v157, 0xffff0000, v82
    v_lshlrev_b32 v158, 16, v83
    v_and_b32 v159, 0xffff0000, v83
    v_pk_add_f32 v[144:145], v[144:145], v[152:153]
    v_pk_add_f32 v[146:147], v[146:147], v[154:155]
    v_pk_add_f32 v[148:149], v[148:149], v[156:157]
    v_pk_add_f32 v[150:151], v[150:151], v[158:159]
    s_waitcnt vmcnt(3)
    v_lshlrev_b32 v152, 16, v84
    v_and_b32 v153, 0xffff0000, v84
    v_lshlrev_b32 v154, 16, v85
    v_and_b32 v155, 0xffff0000, v85
    v_lshlrev_b32 v156, 16, v86
    v_and_b32 v157, 0xffff0000, v86
    v_lshlrev_b32 v158, 16, v87
    v_and_b32 v159, 0xffff0000, v87
    v_pk_add_f32 v[144:145], v[144:145], v[152:153]
    v_pk_add_f32 v[146:147], v[146:147], v[154:155]
    v_pk_add_f32 v[148:149], v[148:149], v[156:157]
    v_pk_add_f32 v[150:151], v[150:151], v[158:159]
    v_cvt_pk_bf16_f32 v152, v144, v145
    v_cvt_pk_bf16_f32 v153, v146, v147
    v_cvt_pk_bf16_f32 v154, v148, v149
    v_cvt_pk_bf16_f32 v155, v150, v151
    buffer_store_dwordx4 v[152:155], v29, s[32:35], s18 offen offset:3072
    s_endpgm
COL_j:
    s_sub_u32 s19, s2, 224
    s_lshr_b32 s13, s19, 3
    s_and_b32 s14, s19, 7
    s_lshr_b32 s15, s12, 2
    s_and_b32 s16, s12, 3
    v_lshlrev_b32 v8, 4, v1
    s_lshl_b32 s17, s13, 2
    s_add_u32 s17, s17, s16
    s_lshl_b32 s17, s17, 5
    s_lshl_b32 s22, s14, 2
    s_add_u32 s17, s17, s22
    s_add_u32 s17, s17, s15
    v_lshrrev_b32 v16, 2, v1
    v_and_b32 v0, 3, v1
    v_lshlrev_b32 v0, 4, v0
    v_lshl_add_u32 v0, v16, 7, v0
    v_and_b32 v2, 31, v1
    v_lshrrev_b32 v3, 5, v1
    v_lshrrev_b32 v16, 1, v2
    v_xor_b32 v16, s16, v16
    v_and_b32 v16, 7, v16
    v_lshlrev_b32 v16, 4, v16
    v_lshl_add_u32 v16, v2, 7, v16
    v_lshl_add_u32 v16, v3, 12, v16
    s_lshl_b32 s22, s15, 15
    v_add_u32 v6, s22, v16
    v_xor_b32 v7, 64, v6
    v_lshlrev_b32 v16, 4, v2
    v_lshl_add_u32 v16, v3, 9, v16
    s_lshl_b32 s23, s16, 6
    v_xor_b32 v16, s23, v16
    s_lshl_b32 s23, s16, 13
    s_add_u32 s23, s23, s22
    v_add_u32 v9, s23, v16
    v_bfe_u32 v16, v1, 2, 2
    v_lshrrev_b32 v17, 4, v1
    v_lshlrev_b32 v17, 5, v17
    v_and_b32 v18, 3, v1
    v_lshl_add_u32 v17, v18, 3, v17
    v_lshlrev_b32 v19, 6, v16
    v_xor_b32 v17, v17, v19
    v_lshl_add_u32 v17, v16, 13, v17
    s_lshl_b32 s23, s16, 10
    s_add_u32 s23, s23, s22
    v_add_u32 v10, s23, v17
    v_xor_b32 v11, 128, v10
    v_lshrrev_b32 v16, 3, v1
    v_mul_u32_u24 v16, 0x4000, v16
    v_and_b32 v18, 7, v1
    v_lshl_add_u32 v12, v18, 4, v16
    s_mul_i32 s24, s16, 0x100000
    s_lshl_b32 s22, s13, 12
    s_add_u32 s24, s24, s22
    s_lshl_b32 s22, s14, 9
    s_add_u32 s24, s24, s22
    s_lshl_b32 s22, s15, 7
    s_add_u32 s24, s24, s22
    s_add_u32 s24, s24, 0x1800000
    s_mov_b32 s50, 2.0
    s_mov_b32 s51, 2.0
    s_mov_b32 s18, 0
    s_load_dwordx2 s[44:45], s[0:1], 48
    s_min_u32 s64, s19, 27
    s_cmp_ge_u32 s64, 14
    s_cselect_b32 s65, 14, 0
    s_sub_u32 s64, s64, s65
    s_mul_i32 s65, s65, 524288
    s_cmp_ge_u32 s64, 7
    s_addc_u32 s66, s64, 0
    s_lshl_b32 s66, s66, 8
    s_add_u32 s65, s65, s66
    s_lshl_b32 s64, s64, 1
    s_add_u32 s64, s64, s12
    s_add_u32 s64, s64, 4
    v_lshrrev_b32 v28, 1, v1
    v_and_b32 v29, 1, v1
    v_lshlrev_b32 v29, 7, v29
    v_lshl_add_u32 v28, v28, 12, v29
    s_waitcnt lgkmcnt(0)
    s_mov_b32 s60, s44
    s_and_b32 s61, s45, 0xffff
    s_mov_b32 s62, 0xe00000
    s_mov_b32 s63, 0x20000
    v_mov_b32 v13, 155648
    v_mov_b32 v14, 1
    s_lshl_b32 s22, s15, 4
    s_add_u32 s22, s22, 155696
    v_mov_b32 v4, s22
    s_add_u32 s32, s24, 0
    s_add_u32 s33, s24, 131072
    s_add_u32 s34, s24, 262144
    s_add_u32 s35, s24, 393216
    s_add_u32 s36, s24, 524288
    s_add_u32 s37, s24, 655360
    s_add_u32 s38, s24, 786432
    s_add_u32 s39, s24, 917504
    s_cmp_ge_u32 s12, 4
    s_cbranch_scc1 COL_l2
    s_lshr_b32 s22, s17, 6
    s_min_u32 s22, s22, 7
    s_lshl_b32 s22, s22, 9
    s_add_u32 s22, s22, 0x3004000
    v_lshlrev_b32 v16, 3, v1
    s_mov_b32 s23, 200000
COL_wp:
    buffer_load_dwordx2 v[32:33], v16, s[28:31], s22 offen sc1
    s_sub_u32 s23, s23, 1
    s_cbranch_scc1 COL_wp_out
    s_waitcnt vmcnt(0)
    v_xor_b32 v32, s3, v32
    v_xor_b32 v33, s3, v33
    v_or_b32 v32, v32, v33
    v_cmp_ne_u32 vcc, 0, v32
    s_cbranch_vccnz COL_wp
COL_wp_out:
    s_lshr_b32 s22, s17, 1
    s_mul_i32 s22, s22, 0x4000
    s_and_b32 s23, s17, 1
    s_lshl_b32 s23, s23, 6
    s_add_u32 s22, s22, s23
    s_add_u32 s22, s22, 0x900000
    buffer_load_dwordx4 v[128:131], v0, s[28:31], s22 offen offset:0 sc1
    buffer_load_dwordx4 v[132:135], v0, s[28:31], s22 offen offset:2048 sc1
    s_add_u32 s22, s22, 4096
    buffer_load_dwordx4 v[136:139], v0, s[28:31], s22 offen offset:0 sc1
    buffer_load_dwordx4 v[140:143], v0, s[28:31], s22 offen offset:2048 sc1
    s_add_u32 s22, s22, 4096
    buffer_load_dwordx4 v[144:147], v0, s[28:31], s22 offen offset:0 sc1
    buffer_load_dwordx4 v[148:151], v0, s[28:31], s22 offen offset:2048 sc1
    s_add_u32 s22, s22, 4096
    buffer_load_dwordx4 v[152:155], v0, s[28:31], s22 offen offset:0 sc1
    buffer_load_dwordx4 v[156:159], v0, s[28:31], s22 offen offset:2048 sc1
    s_waitcnt vmcnt(0)
    s_barrier
    s_branch COL_in
COL_l2:
    v_lshrrev_b32 v30, 1, v1
    v_mul_u32_u24 v30, 96, v30
    v_add_u32 v30, v30, v8
    s_lshl_b32 s25, s54, 12
    s_add_u32 s25, s25, 0x30c0000
    s_lshl_b32 s20, s19, 2
    s_lshr_b32 s21, s16, 1
    s_add_u32 s20, s20, s21
    s_mul_i32 s20, s20, 0x8000
    s_and_b32 s21, s16, 1
    s_lshl_b32 s21, s21, 14
    s_add_u32 s20, s20, s21
    s_add_u32 s20, s20, 0x2000000
    s_lshl_b32 s21, s42, 2
    s_mov_b32 s23, 3200000
CZ_own:
    ds_read_b32 v24, v13 offset:4
    s_sub_u32 s23, s23, 1
    s_cbranch_scc1 CZ_own_out
    s_waitcnt lgkmcnt(0)
    v_cmp_ne_u32 vcc, 8, v24
    s_cbranch_vccnz CZ_own
CZ_own_out:
    s_mov_b64 s[26:27], -1
    s_and_b32 s22, s12, 1
    s_lshl_b32 s22, s22, 5
    s_lshr_b64 s[26:27], s[26:27], s22
    s_mov_b32 m0, s21
    s_mov_b32 s44, s20
    s_mov_b32 s45, 0
    s_mov_b32 s23, 200000
CZ_l:
    s_lshr_b32 s43, s26, s45
    s_and_b32 s43, s43, 3
    s_cbranch_scc0 CZ_go
    buffer_load_dwordx4 v[24:27], v30, s[28:31], s25 offen sc1
    s_waitcnt vmcnt(0)
    v_xor_b32 v24, s3, v24
    v_xor_b32 v25, s3, v25
    v_xor_b32 v26, s3, v26
    v_xor_b32 v27, s3, v27
    v_or3_b32 v24, v24, v25, v26
    v_or_b32 v24, v24, v27
    v_cmp_ne_u32 vcc, 0, v24
    s_nop 0
    s_lshr_b64 s[26:27], vcc, s22
    s_sub_u32 s23, s23, 1
    s_cselect_b32 s26, 0, s26
    s_branch CZ_l
CZ_go:
    buffer_load_dwordx4 v8, s[28:31], s44 offen sc1 lds
    s_add_u32 m0, m0, 1024
    s_add_u32 s44, s44, 1024
    s_add_u32 s45, s45, 2
    s_cmp_lt_u32 s45, 32
    s_cbranch_scc1 CZ_l
    s_lshr_b32 s22, s17, 6
    s_min_u32 s22, s22, 7
    s_lshl_b32 s22, s22, 9
    s_add_u32 s22, s22, 0x3004000
    v_lshlrev_b32 v16, 3, v1
    s_mov_b32 s23, 200000
COL_wl:
    buffer_load_dwordx2 v[32:33], v16, s[28:31], s22 offen sc1
    s_sub_u32 s23, s23, 1
    s_cbranch_scc1 COL_wl_out
    s_waitcnt vmcnt(0)
    v_xor_b32 v32, s3, v32
    v_xor_b32 v33, s3, v33
    v_or_b32 v32, v32, v33
    v_cmp_ne_u32 vcc, 0, v32
    s_cbranch_vccnz COL_wl
COL_wl_out:
    s_lshr_b32 s22, s17, 1
    s_mul_i32 s22, s22, 0x4000
    s_and_b32 s23, s17, 1
    s_lshl_b32 s23, s23, 6
    s_add_u32 s22, s22, s23
    s_add_u32 s22, s22, 0x900000
    buffer_load_dwordx4 v[128:131], v0, s[28:31], s22 offen offset:0 sc1
    buffer_load_dwordx4 v[132:135], v0, s[28:31], s22 offen offset:2048 sc1
    s_add_u32 s22, s22, 4096
    buffer_load_dwordx4 v[136:139], v0, s[28:31], s22 offen offset:0 sc1
    buffer_load_dwordx4 v[140:143], v0, s[28:31], s22 offen offset:2048 sc1
    s_add_u32 s22, s22, 4096
    buffer_load_dwordx4 v[144:147], v0, s[28:31], s22 offen offset:0 sc1
    buffer_load_dwordx4 v[148:151], v0, s[28:31], s22 offen offset:2048 sc1
    s_add_u32 s22, s22, 4096
    buffer_load_dwordx4 v[152:155], v0, s[28:31], s22 offen offset:0 sc1
    buffer_load_dwordx4 v[156:159], v0, s[28:31], s22 offen offset:2048 sc1
    s_add_u32 m0, s21, 65536
    s_add_u32 s22, s20, 65536
    buffer_load_dwordx4 v8, s[28:31], s22 offen offset:0 sc1 lds
    buffer_load_dwordx4 v8, s[28:31], s22 offen offset:1024 sc1 lds
    buffer_load_dwordx4 v8, s[28:31], s22 offen offset:2048 sc1 lds
    buffer_load_dwordx4 v8, s[28:31], s22 offen offset:3072 sc1 lds
    s_add_u32 m0, s21, 69632
    s_add_u32 s22, s20, 69632
    buffer_load_dwordx4 v8, s[28:31], s22 offen offset:0 sc1 lds
    buffer_load_dwordx4 v8, s[28:31], s22 offen offset:1024 sc1 lds
    buffer_load_dwordx4 v8, s[28:31], s22 offen offset:2048 sc1 lds
    buffer_load_dwordx4 v8, s[28:31], s22 offen offset:3072 sc1 lds
    s_add_u32 m0, s21, 73728
    s_add_u32 s22, s20, 73728
    buffer_load_dwordx4 v8, s[28:31], s22 offen offset:0 sc1 lds
    buffer_load_dwordx4 v8, s[28:31], s22 offen offset:1024 sc1 lds
    buffer_load_dwordx4 v8, s[28:31], s22 offen offset:2048 sc1 lds
    buffer_load_dwordx4 v8, s[28:31], s22 offen offset:3072 sc1 lds
    s_add_u32 m0, s21, 77824
    s_add_u32 s22, s20, 77824
    buffer_load_dwordx4 v8, s[28:31], s22 offen offset:0 sc1 lds
    buffer_load_dwordx4 v8, s[28:31], s22 offen offset:1024 sc1 lds
    buffer_load_dwordx4 v8, s[28:31], s22 offen offset:2048 sc1 lds
    buffer_load_dwordx4 v8, s[28:31], s22 offen offset:3072 sc1 lds
    s_barrier
    s_branch COL_in
COL_round:
    s_mov_b32 s23, 3200000
COL_s1:
    ds_read_b32 v15, v13 offset:16
    s_sub_u32 s23, s23, 1
    s_cbranch_scc1 COL_s1_out
    s_waitcnt lgkmcnt(0)
    v_cmp_ne_u32 vcc, 4, v15
    s_cbranch_vccnz COL_s1
COL_s1_out:
COL_in:
    ds_read_b128 v[32:35], v6 offset:0
    ds_read_b128 v[36:39], v6 offset:8192
    ds_read_b128 v[40:43], v6 offset:16384
    ds_read_b128 v[44:47], v6 offset:24576
    ds_read_b128 v[48:51], v7 offset:0
    ds_read_b128 v[52:55], v7 offset:8192
    ds_read_b128 v[56:59], v7 offset:16384
    ds_read_b128 v[60:63], v7 offset:24576
    s_mov_b64 exec, 1
    ds_add_u32 v4, v14 offset:0
    s_mov_b64 exec, -1
    s_waitcnt lgkmcnt(1)
    v_mfma_f32_32x32x16_bf16 v[64:79], v[32:35], v[160:163], 0
    v_mfma_f32_32x32x16_bf16 v[80:95], v[32:35], v[176:179], 0
    v_mfma_f32_32x32x16_bf16 v[64:79], v[36:39], v[164:167], v[64:79]
    v_mfma_f32_32x32x16_bf16 v[80:95], v[36:39], v[180:183], v[80:95]
    v_mfma_f32_32x32x16_bf16 v[64:79], v[40:43], v[168:171], v[64:79]
    v_mfma_f32_32x32x16_bf16 v[80:95], v[40:43], v[184:187], v[80:95]
    v_mfma_f32_32x32x16_bf16 v[64:79], v[44:47], v[172:175], v[64:79]
    v_mfma_f32_32x32x16_bf16 v[80:95], v[44:47], v[188:191], v[80:95]
    v_mfma_f32_32x32x16_bf16 v[96:111], v[48:51], v[160:163], 0
    v_mfma_f32_32x32x16_bf16 v[112:127], v[48:51], v[176:179], 0
    v_mfma_f32_32x32x16_bf16 v[96:111], v[52:55], v[164:167], v[96:111]
    v_mfma_f32_32x32x16_bf16 v[112:127], v[52:55], v[180:183], v[112:127]
    v_mfma_f32_32x32x16_bf16 v[96:111], v[56:59], v[168:171], v[96:111]
    v_mfma_f32_32x32x16_bf16 v[112:127], v[56:59], v[184:187], v[112:127]
    v_mfma_f32_32x32x16_bf16 v[96:111], v[60:63], v[172:175], v[96:111]
    v_mfma_f32_32x32x16_bf16 v[112:127], v[60:63], v[188:191], v[112:127]
    s_nop 2
    v_mul_f32 v16, v64, v192
    v_mul_f32 v17, v65, v193
    v_mul_f32 v18, v66, v194
    v_mul_f32 v19, v67, v195
    v_mul_f32 v20, v80, v192
    v_mul_f32 v21, v81, v193
    v_mul_f32 v22, v82, v194
    v_mul_f32 v23, v83, v195
    v_fmac_f32 v16, v80, v208
    v_fmac_f32 v17, v81, v209
    v_fmac_f32 v18, v82, v210
    v_fmac_f32 v19, v83, v211
    v_fma_f32 v20, -v64, v208, v20
    v_fma_f32 v21, -v65, v209, v21
    v_fma_f32 v22, -v66, v210, v22
    v_fma_f32 v23, -v67, v211, v23
    s_setprio 1
    v_cvt_pk_bf16_f32 v32, v16, v17
    v_cvt_pk_bf16_f32 v33, v18, v19
    v_cvt_pk_bf16_f32 v34, v20, v21
    v_cvt_pk_bf16_f32 v35, v22, v23
    s_setprio 0
    v_mul_f32 v16, v68, v196
    v_mul_f32 v17, v69, v197
    v_mul_f32 v18, v70, v198
    v_mul_f32 v19, v71, v199
    v_mul_f32 v20, v84, v196
    v_mul_f32 v21, v85, v197
    v_mul_f32 v22, v86, v198
    v_mul_f32 v23, v87, v199
    v_fmac_f32 v16, v84, v212
    v_fmac_f32 v17, v85, v213
    v_fmac_f32 v18, v86, v214
    v_fmac_f32 v19, v87, v215
    v_fma_f32 v20, -v68, v212, v20
    v_fma_f32 v21, -v69, v213, v21
    v_fma_f32 v22, -v70, v214, v22
    v_fma_f32 v23, -v71, v215, v23
    s_setprio 1
    v_cvt_pk_bf16_f32 v36, v16, v17
    v_cvt_pk_bf16_f32 v37, v18, v19
    v_cvt_pk_bf16_f32 v38, v20, v21
    v_cvt_pk_bf16_f32 v39, v22, v23
    s_setprio 0
    v_mul_f32 v16, v72, v200
    v_mul_f32 v17, v73, v201
    v_mul_f32 v18, v74, v202
    v_mul_f32 v19, v75, v203
    v_mul_f32 v20, v88, v200
    v_mul_f32 v21, v89, v201
    v_mul_f32 v22, v90, v202
    v_mul_f32 v23, v91, v203
    v_fmac_f32 v16, v88, v216
    v_fmac_f32 v17, v89, v217
    v_fmac_f32 v18, v90, v218
    v_fmac_f32 v19, v91, v219
    v_fma_f32 v20, -v72, v216, v20
    v_fma_f32 v21, -v73, v217, v21
    v_fma_f32 v22, -v74, v218, v22
    v_fma_f32 v23, -v75, v219, v23
    s_setprio 1
    v_cvt_pk_bf16_f32 v40, v16, v17
    v_cvt_pk_bf16_f32 v41, v18, v19
    v_cvt_pk_bf16_f32 v42, v20, v21
    v_cvt_pk_bf16_f32 v43, v22, v23
    s_setprio 0
    v_mul_f32 v16, v76, v204
    v_mul_f32 v17, v77, v205
    v_mul_f32 v18, v78, v206
    v_mul_f32 v19, v79, v207
    v_mul_f32 v20, v92, v204
    v_mul_f32 v21, v93, v205
    v_mul_f32 v22, v94, v206
    v_mul_f32 v23, v95, v207
    v_fmac_f32 v16, v92, v220
    v_fmac_f32 v17, v93, v221
    v_fmac_f32 v18, v94, v222
    v_fmac_f32 v19, v95, v223
    v_fma_f32 v20, -v76, v220, v20
    v_fma_f32 v21, -v77, v221, v21
    v_fma_f32 v22, -v78, v222, v22
    v_fma_f32 v23, -v79, v223, v23
    s_setprio 1
    v_cvt_pk_bf16_f32 v44, v16, v17
    v_cvt_pk_bf16_f32 v45, v18, v19
    v_cvt_pk_bf16_f32 v46, v20, v21
    v_cvt_pk_bf16_f32 v47, v22, v23
    s_setprio 0
    v_mul_f32 v16, v96, v192
    v_mul_f32 v17, v97, v193
    v_mul_f32 v18, v98, v194
    v_mul_f32 v19, v99, v195
    v_mul_f32 v20, v112, v192
    v_mul_f32 v21, v113, v193
    v_mul_f32 v22, v114, v194
    v_mul_f32 v23, v115, v195
    v_fmac_f32 v16, v112, v208
    v_fmac_f32 v17, v113, v209
    v_fmac_f32 v18, v114, v210
    v_fmac_f32 v19, v115, v211
    v_fma_f32 v20, -v96, v208, v20
    v_fma_f32 v21, -v97, v209, v21
    v_fma_f32 v22, -v98, v210, v22
    v_fma_f32 v23, -v99, v211, v23
    s_setprio 1
    v_cvt_pk_bf16_f32 v48, v16, v17
    v_cvt_pk_bf16_f32 v49, v18, v19
    v_cvt_pk_bf16_f32 v50, v20, v21
    v_cvt_pk_bf16_f32 v51, v22, v23
    s_setprio 0
    v_mul_f32 v16, v100, v196
    v_mul_f32 v17, v101, v197
    v_mul_f32 v18, v102, v198
    v_mul_f32 v19, v103, v199
    v_mul_f32 v20, v116, v196
    v_mul_f32 v21, v117, v197
    v_mul_f32 v22, v118, v198
    v_mul_f32 v23, v119, v199
    v_fmac_f32 v16, v116, v212
    v_fmac_f32 v17, v117, v213
    v_fmac_f32 v18, v118, v214
    v_fmac_f32 v19, v119, v215
    v_fma_f32 v20, -v100, v212, v20
    v_fma_f32 v21, -v101, v213, v21
    v_fma_f32 v22, -v102, v214, v22
    v_fma_f32 v23, -v103, v215, v23
    s_setprio 1
    v_cvt_pk_bf16_f32 v52, v16, v17
    v_cvt_pk_bf16_f32 v53, v18, v19
    v_cvt_pk_bf16_f32 v54, v20, v21
    v_cvt_pk_bf16_f32 v55, v22, v23
    s_setprio 0
    v_mul_f32 v16, v104, v200
    v_mul_f32 v17, v105, v201
    v_mul_f32 v18, v106, v202
    v_mul_f32 v19, v107, v203
    v_mul_f32 v20, v120, v200
    v_mul_f32 v21, v121, v201
    v_mul_f32 v22, v122, v202
    v_mul_f32 v23, v123, v203
    v_fmac_f32 v16, v120, v216
    v_fmac_f32 v17, v121, v217
    v_fmac_f32 v18, v122, v218
    v_fmac_f32 v19, v123, v219
    v_fma_f32 v20, -v104, v216, v20
    v_fma_f32 v21, -v105, v217, v21
    v_fma_f32 v22, -v106, v218, v22
    v_fma_f32 v23, -v107, v219, v23
    s_setprio 1
    v_cvt_pk_bf16_f32 v56, v16, v17
    v_cvt_pk_bf16_f32 v57, v18, v19
    v_cvt_pk_bf16_f32 v58, v20, v21
    v_cvt_pk_bf16_f32 v59, v22, v23
    s_setprio 0
    v_mul_f32 v16, v108, v204
    v_mul_f32 v17, v109, v205
    v_mul_f32 v18, v110, v206
    v_mul_f32 v19, v111, v207
    v_mul_f32 v20, v124, v204
    v_mul_f32 v21, v125, v205
    v_mul_f32 v22, v126, v206
    v_mul_f32 v23, v127, v207
    v_fmac_f32 v16, v124, v220
    v_fmac_f32 v17, v125, v221
    v_fmac_f32 v18, v126, v222
    v_fmac_f32 v19, v127, v223
    v_fma_f32 v20, -v108, v220, v20
    v_fma_f32 v21, -v109, v221, v21
    v_fma_f32 v22, -v110, v222, v22
    v_fma_f32 v23, -v111, v223, v23
    s_setprio 1
    v_cvt_pk_bf16_f32 v60, v16, v17
    v_cvt_pk_bf16_f32 v61, v18, v19
    v_cvt_pk_bf16_f32 v62, v20, v21
    v_cvt_pk_bf16_f32 v63, v22, v23
    v_mfma_f32_32x32x16_bf16 v[64:79], v[160:163], v[32:35], 0
    v_mfma_f32_32x32x16_bf16 v[80:95], v[176:179], v[32:35], 0
    v_mfma_f32_32x32x16_bf16 v[64:79], v[164:167], v[36:39], v[64:79]
    v_mfma_f32_32x32x16_bf16 v[80:95], v[180:183], v[36:39], v[80:95]
    v_mfma_f32_32x32x16_bf16 v[64:79], v[168:171], v[40:43], v[64:79]
    v_mfma_f32_32x32x16_bf16 v[80:95], v[184:187], v[40:43], v[80:95]
    v_mfma_f32_32x32x16_bf16 v[64:79], v[172:175], v[44:47], v[64:79]
    v_mfma_f32_32x32x16_bf16 v[80:95], v[188:191], v[44:47], v[80:95]
    v_mfma_f32_32x32x16_bf16 v[96:111], v[160:163], v[48:51], 0
    v_mfma_f32_32x32x16_bf16 v[112:127], v[176:179], v[48:51], 0
    v_mfma_f32_32x32x16_bf16 v[96:111], v[164:167], v[52:55], v[96:111]
    v_mfma_f32_32x32x16_bf16 v[112:127], v[180:183], v[52:55], v[112:127]
    v_mfma_f32_32x32x16_bf16 v[96:111], v[168:171], v[56:59], v[96:111]
    v_mfma_f32_32x32x16_bf16 v[112:127], v[184:187], v[56:59], v[112:127]
    v_mfma_f32_32x32x16_bf16 v[96:111], v[172:175], v[60:63], v[96:111]
    v_mfma_f32_32x32x16_bf16 v[112:127], v[188:191], v[60:63], v[112:127]
    s_setprio 0
    s_waitcnt vmcnt(16)
    s_cmp_eq_u32 s18, 0
    s_cbranch_scc1 COL_w1
    s_waitcnt vmcnt(2)
COL_w1:
    v_lshlrev_b32 v16, 16, v128
    v_and_b32 v18, 0xffff0000, v128
    v_lshlrev_b32 v20, 16, v129
    v_and_b32 v22, 0xffff0000, v129
    v_lshlrev_b32 v17, 16, v130
    v_and_b32 v19, 0xffff0000, v130
    v_lshlrev_b32 v21, 16, v131
    v_and_b32 v23, 0xffff0000, v131
    v_fma_f32 v24, v96, v224, v64
    v_fma_f32 v25, v97, v225, v65
    v_fma_f32 v26, v112, v224, v80
    v_fma_f32 v27, v113, v225, v81
    v_fmac_f32 v24, v112, v240
    v_fmac_f32 v25, v113, v241
    v_fma_f32 v26, -v96, v240, v26
    v_fma_f32 v27, -v97, v241, v27
    v_fma_f32 v64, v64, 2.0, -v24
    v_fma_f32 v65, v65, 2.0, -v25
    v_fma_f32 v80, v80, 2.0, -v26
    v_fma_f32 v81, v81, 2.0, -v27
    v_mul_f32 v96, v16, v24
    v_mul_f32 v97, v17, v25
    v_mul_f32 v112, v16, v26
    v_mul_f32 v113, v17, v27
    v_fma_f32 v96, -v18, v26, v96
    v_fma_f32 v97, -v19, v27, v97
    v_fmac_f32 v112, v18, v24
    v_fmac_f32 v113, v19, v25
    v_fma_f32 v24, v20, v64, v96
    v_fma_f32 v25, v21, v65, v97
    v_fma_f32 v26, v20, v80, v112
    v_fma_f32 v27, v21, v81, v113
    v_fma_f32 v24, -v22, v80, v24
    v_fma_f32 v25, -v23, v81, v25
    v_fmac_f32 v26, v22, v64
    v_fmac_f32 v27, v23, v65
    v_fma_f32 v96, v96, 2.0, -v24
    v_fma_f32 v97, v97, 2.0, -v25
    v_fma_f32 v112, v112, 2.0, -v26
    v_fma_f32 v113, v113, 2.0, -v27
    s_setprio 1
    v_cvt_pk_bf16_f32 v32, v24, v25
    v_cvt_pk_bf16_f32 v34, -v26, -v27
    s_setprio 0
    v_mul_f32 v64, v96, v224
    v_mul_f32 v65, v97, v225
    v_mul_f32 v80, v112, v224
    v_mul_f32 v81, v113, v225
    v_fma_f32 v64, -v112, v240, v64
    v_fma_f32 v65, -v113, v241, v65
    v_fmac_f32 v80, v96, v240
    v_fmac_f32 v81, v97, v241
    s_setprio 1
    v_cvt_pk_bf16_f32 v48, v64, v65
    v_cvt_pk_bf16_f32 v50, -v80, -v81
    s_setprio 0
    v_lshlrev_b32 v16, 16, v132
    v_and_b32 v18, 0xffff0000, v132
    v_lshlrev_b32 v20, 16, v133
    v_and_b32 v22, 0xffff0000, v133
    v_lshlrev_b32 v17, 16, v134
    v_and_b32 v19, 0xffff0000, v134
    v_lshlrev_b32 v21, 16, v135
    v_and_b32 v23, 0xffff0000, v135
    v_fma_f32 v24, v98, v226, v66
    v_fma_f32 v25, v99, v227, v67
    v_fma_f32 v26, v114, v226, v82
    v_fma_f32 v27, v115, v227, v83
    v_fmac_f32 v24, v114, v242
    v_fmac_f32 v25, v115, v243
    v_fma_f32 v26, -v98, v242, v26
    v_fma_f32 v27, -v99, v243, v27
    v_fma_f32 v66, v66, 2.0, -v24
    v_fma_f32 v67, v67, 2.0, -v25
    v_fma_f32 v82, v82, 2.0, -v26
    v_fma_f32 v83, v83, 2.0, -v27
    v_mul_f32 v98, v16, v24
    v_mul_f32 v99, v17, v25
    v_mul_f32 v114, v16, v26
    v_mul_f32 v115, v17, v27
    v_fma_f32 v98, -v18, v26, v98
    v_fma_f32 v99, -v19, v27, v99
    v_fmac_f32 v114, v18, v24
    v_fmac_f32 v115, v19, v25
    v_fma_f32 v24, v20, v66, v98
    v_fma_f32 v25, v21, v67, v99
    v_fma_f32 v26, v20, v82, v114
    v_fma_f32 v27, v21, v83, v115
    v_fma_f32 v24, -v22, v82, v24
    v_fma_f32 v25, -v23, v83, v25
    v_fmac_f32 v26, v22, v66
    v_fmac_f32 v27, v23, v67
    v_fma_f32 v98, v98, 2.0, -v24
    v_fma_f32 v99, v99, 2.0, -v25
    v_fma_f32 v114, v114, 2.0, -v26
    v_fma_f32 v115, v115, 2.0, -v27
    s_setprio 1
    v_cvt_pk_bf16_f32 v33, v24, v25
    v_cvt_pk_bf16_f32 v35, -v26, -v27
    s_setprio 0
    v_mul_f32 v66, v98, v226
    v_mul_f32 v67, v99, v227
    v_mul_f32 v82, v114, v226
    v_mul_f32 v83, v115, v227
    v_fma_f32 v66, -v114, v242, v66
    v_fma_f32 v67, -v115, v243, v67
    v_fmac_f32 v82, v98, v242
    v_fmac_f32 v83, v99, v243
    s_setprio 1
    v_cvt_pk_bf16_f32 v49, v66, v67
    v_cvt_pk_bf16_f32 v51, -v82, -v83
    s_setprio 0
    v_lshlrev_b32 v16, 16, v136
    v_and_b32 v18, 0xffff0000, v136
    v_lshlrev_b32 v20, 16, v137
    v_and_b32 v22, 0xffff0000, v137
    v_lshlrev_b32 v17, 16, v138
    v_and_b32 v19, 0xffff0000, v138
    v_lshlrev_b32 v21, 16, v139
    v_and_b32 v23, 0xffff0000, v139
    v_fma_f32 v24, v100, v228, v68
    v_fma_f32 v25, v101, v229, v69
    v_fma_f32 v26, v116, v228, v84
    v_fma_f32 v27, v117, v229, v85
    v_fmac_f32 v24, v116, v244
    v_fmac_f32 v25, v117, v245
    v_fma_f32 v26, -v100, v244, v26
    v_fma_f32 v27, -v101, v245, v27
    v_fma_f32 v68, v68, 2.0, -v24
    v_fma_f32 v69, v69, 2.0, -v25
    v_fma_f32 v84, v84, 2.0, -v26
    v_fma_f32 v85, v85, 2.0, -v27
    v_mul_f32 v100, v16, v24
    v_mul_f32 v101, v17, v25
    v_mul_f32 v116, v16, v26
    v_mul_f32 v117, v17, v27
    v_fma_f32 v100, -v18, v26, v100
    v_fma_f32 v101, -v19, v27, v101
    v_fmac_f32 v116, v18, v24
    v_fmac_f32 v117, v19, v25
    v_fma_f32 v24, v20, v68, v100
    v_fma_f32 v25, v21, v69, v101
    v_fma_f32 v26, v20, v84, v116
    v_fma_f32 v27, v21, v85, v117
    v_fma_f32 v24, -v22, v84, v24
    v_fma_f32 v25, -v23, v85, v25
    v_fmac_f32 v26, v22, v68
    v_fmac_f32 v27, v23, v69
    v_fma_f32 v100, v100, 2.0, -v24
    v_fma_f32 v101, v101, 2.0, -v25
    v_fma_f32 v116, v116, 2.0, -v26
    v_fma_f32 v117, v117, 2.0, -v27
    s_setprio 1
    v_cvt_pk_bf16_f32 v36, v24, v25
    v_cvt_pk_bf16_f32 v38, -v26, -v27
    s_setprio 0
    v_mul_f32 v68, v100, v228
    v_mul_f32 v69, v101, v229
    v_mul_f32 v84, v116, v228
    v_mul_f32 v85, v117, v229
    v_fma_f32 v68, -v116, v244, v68
    v_fma_f32 v69, -v117, v245, v69
    v_fmac_f32 v84, v100, v244
    v_fmac_f32 v85, v101, v245
    s_setprio 1
    v_cvt_pk_bf16_f32 v52, v68, v69
    v_cvt_pk_bf16_f32 v54, -v84, -v85
    s_setprio 0
    v_lshlrev_b32 v16, 16, v140
    v_and_b32 v18, 0xffff0000, v140
    v_lshlrev_b32 v20, 16, v141
    v_and_b32 v22, 0xffff0000, v141
    v_lshlrev_b32 v17, 16, v142
    v_and_b32 v19, 0xffff0000, v142
    v_lshlrev_b32 v21, 16, v143
    v_and_b32 v23, 0xffff0000, v143
    v_fma_f32 v24, v102, v230, v70
    v_fma_f32 v25, v103, v231, v71
    v_fma_f32 v26, v118, v230, v86
    v_fma_f32 v27, v119, v231, v87
    v_fmac_f32 v24, v118, v246
    v_fmac_f32 v25, v119, v247
    v_fma_f32 v26, -v102, v246, v26
    v_fma_f32 v27, -v103, v247, v27
    v_fma_f32 v70, v70, 2.0, -v24
    v_fma_f32 v71, v71, 2.0, -v25
    v_fma_f32 v86, v86, 2.0, -v26
    v_fma_f32 v87, v87, 2.0, -v27
    v_mul_f32 v102, v16, v24
    v_mul_f32 v103, v17, v25
    v_mul_f32 v118, v16, v26
    v_mul_f32 v119, v17, v27
    v_fma_f32 v102, -v18, v26, v102
    v_fma_f32 v103, -v19, v27, v103
    v_fmac_f32 v118, v18, v24
    v_fmac_f32 v119, v19, v25
    v_fma_f32 v24, v20, v70, v102
    v_fma_f32 v25, v21, v71, v103
    v_fma_f32 v26, v20, v86, v118
    v_fma_f32 v27, v21, v87, v119
    v_fma_f32 v24, -v22, v86, v24
    v_fma_f32 v25, -v23, v87, v25
    v_fmac_f32 v26, v22, v70
    v_fmac_f32 v27, v23, v71
    v_fma_f32 v102, v102, 2.0, -v24
    v_fma_f32 v103, v103, 2.0, -v25
    v_fma_f32 v118, v118, 2.0, -v26
    v_fma_f32 v119, v119, 2.0, -v27
    s_setprio 1
    v_cvt_pk_bf16_f32 v37, v24, v25
    v_cvt_pk_bf16_f32 v39, -v26, -v27
    s_setprio 0
    v_mul_f32 v70, v102, v230
    v_mul_f32 v71, v103, v231
    v_mul_f32 v86, v118, v230
    v_mul_f32 v87, v119, v231
    v_fma_f32 v70, -v118, v246, v70
    v_fma_f32 v71, -v119, v247, v71
    v_fmac_f32 v86, v102, v246
    v_fmac_f32 v87, v103, v247
    s_setprio 1
    v_cvt_pk_bf16_f32 v53, v70, v71
    v_cvt_pk_bf16_f32 v55, -v86, -v87
    s_setprio 0
    v_lshlrev_b32 v16, 16, v144
    v_and_b32 v18, 0xffff0000, v144
    v_lshlrev_b32 v20, 16, v145
    v_and_b32 v22, 0xffff0000, v145
    v_lshlrev_b32 v17, 16, v146
    v_and_b32 v19, 0xffff0000, v146
    v_lshlrev_b32 v21, 16, v147
    v_and_b32 v23, 0xffff0000, v147
    v_fma_f32 v24, v104, v232, v72
    v_fma_f32 v25, v105, v233, v73
    v_fma_f32 v26, v120, v232, v88
    v_fma_f32 v27, v121, v233, v89
    v_fmac_f32 v24, v120, v248
    v_fmac_f32 v25, v121, v249
    v_fma_f32 v26, -v104, v248, v26
    v_fma_f32 v27, -v105, v249, v27
    v_fma_f32 v72, v72, 2.0, -v24
    v_fma_f32 v73, v73, 2.0, -v25
    v_fma_f32 v88, v88, 2.0, -v26
    v_fma_f32 v89, v89, 2.0, -v27
    v_mul_f32 v104, v16, v24
    v_mul_f32 v105, v17, v25
    v_mul_f32 v120, v16, v26
    v_mul_f32 v121, v17, v27
    v_fma_f32 v104, -v18, v26, v104
    v_fma_f32 v105, -v19, v27, v105
    v_fmac_f32 v120, v18, v24
    v_fmac_f32 v121, v19, v25
    v_fma_f32 v24, v20, v72, v104
    v_fma_f32 v25, v21, v73, v105
    v_fma_f32 v26, v20, v88, v120
    v_fma_f32 v27, v21, v89, v121
    v_fma_f32 v24, -v22, v88, v24
    v_fma_f32 v25, -v23, v89, v25
    v_fmac_f32 v26, v22, v72
    v_fmac_f32 v27, v23, v73
    v_fma_f32 v104, v104, 2.0, -v24
    v_fma_f32 v105, v105, 2.0, -v25
    v_fma_f32 v120, v120, 2.0, -v26
    v_fma_f32 v121, v121, 2.0, -v27
    s_setprio 1
    v_cvt_pk_bf16_f32 v40, v24, v25
    v_cvt_pk_bf16_f32 v42, -v26, -v27
    s_setprio 0
    v_mul_f32 v72, v104, v232
    v_mul_f32 v73, v105, v233
    v_mul_f32 v88, v120, v232
    v_mul_f32 v89, v121, v233
    v_fma_f32 v72, -v120, v248, v72
    v_fma_f32 v73, -v121, v249, v73
    v_fmac_f32 v88, v104, v248
    v_fmac_f32 v89, v105, v249
    s_setprio 1
    v_cvt_pk_bf16_f32 v56, v72, v73
    v_cvt_pk_bf16_f32 v58, -v88, -v89
    s_setprio 0
    v_lshlrev_b32 v16, 16, v148
    v_and_b32 v18, 0xffff0000, v148
    v_lshlrev_b32 v20, 16, v149
    v_and_b32 v22, 0xffff0000, v149
    v_lshlrev_b32 v17, 16, v150
    v_and_b32 v19, 0xffff0000, v150
    v_lshlrev_b32 v21, 16, v151
    v_and_b32 v23, 0xffff0000, v151
    v_fma_f32 v24, v106, v234, v74
    v_fma_f32 v25, v107, v235, v75
    v_fma_f32 v26, v122, v234, v90
    v_fma_f32 v27, v123, v235, v91
    v_fmac_f32 v24, v122, v250
    v_fmac_f32 v25, v123, v251
    v_fma_f32 v26, -v106, v250, v26
    v_fma_f32 v27, -v107, v251, v27
    v_fma_f32 v74, v74, 2.0, -v24
    v_fma_f32 v75, v75, 2.0, -v25
    v_fma_f32 v90, v90, 2.0, -v26
    v_fma_f32 v91, v91, 2.0, -v27
    v_mul_f32 v106, v16, v24
    v_mul_f32 v107, v17, v25
    v_mul_f32 v122, v16, v26
    v_mul_f32 v123, v17, v27
    v_fma_f32 v106, -v18, v26, v106
    v_fma_f32 v107, -v19, v27, v107
    v_fmac_f32 v122, v18, v24
    v_fmac_f32 v123, v19, v25
    v_fma_f32 v24, v20, v74, v106
    v_fma_f32 v25, v21, v75, v107
    v_fma_f32 v26, v20, v90, v122
    v_fma_f32 v27, v21, v91, v123
    v_fma_f32 v24, -v22, v90, v24
    v_fma_f32 v25, -v23, v91, v25
    v_fmac_f32 v26, v22, v74
    v_fmac_f32 v27, v23, v75
    v_fma_f32 v106, v106, 2.0, -v24
    v_fma_f32 v107, v107, 2.0, -v25
    v_fma_f32 v122, v122, 2.0, -v26
    v_fma_f32 v123, v123, 2.0, -v27
    s_setprio 1
    v_cvt_pk_bf16_f32 v41, v24, v25
    v_cvt_pk_bf16_f32 v43, -v26, -v27
    s_setprio 0
    v_mul_f32 v74, v106, v234
    v_mul_f32 v75, v107, v235
    v_mul_f32 v90, v122, v234
    v_mul_f32 v91, v123, v235
    v_fma_f32 v74, -v122, v250, v74
    v_fma_f32 v75, -v123, v251, v75
    v_fmac_f32 v90, v106, v250
    v_fmac_f32 v91, v107, v251
    s_setprio 1
    v_cvt_pk_bf16_f32 v57, v74, v75
    v_cvt_pk_bf16_f32 v59, -v90, -v91
    s_setprio 0
    v_lshlrev_b32 v16, 16, v152
    v_and_b32 v18, 0xffff0000, v152
    v_lshlrev_b32 v20, 16, v153
    v_and_b32 v22, 0xffff0000, v153
    v_lshlrev_b32 v17, 16, v154
    v_and_b32 v19, 0xffff0000, v154
    v_lshlrev_b32 v21, 16, v155
    v_and_b32 v23, 0xffff0000, v155
    v_fma_f32 v24, v108, v236, v76
    v_fma_f32 v25, v109, v237, v77
    v_fma_f32 v26, v124, v236, v92
    v_fma_f32 v27, v125, v237, v93
    v_fmac_f32 v24, v124, v252
    v_fmac_f32 v25, v125, v253
    v_fma_f32 v26, -v108, v252, v26
    v_fma_f32 v27, -v109, v253, v27
    v_fma_f32 v76, v76, 2.0, -v24
    v_fma_f32 v77, v77, 2.0, -v25
    v_fma_f32 v92, v92, 2.0, -v26
    v_fma_f32 v93, v93, 2.0, -v27
    v_mul_f32 v108, v16, v24
    v_mul_f32 v109, v17, v25
    v_mul_f32 v124, v16, v26
    v_mul_f32 v125, v17, v27
    v_fma_f32 v108, -v18, v26, v108
    v_fma_f32 v109, -v19, v27, v109
    v_fmac_f32 v124, v18, v24
    v_fmac_f32 v125, v19, v25
    v_fma_f32 v24, v20, v76, v108
    v_fma_f32 v25, v21, v77, v109
    v_fma_f32 v26, v20, v92, v124
    v_fma_f32 v27, v21, v93, v125
    v_fma_f32 v24, -v22, v92, v24
    v_fma_f32 v25, -v23, v93, v25
    v_fmac_f32 v26, v22, v76
    v_fmac_f32 v27, v23, v77
    v_fma_f32 v108, v108, 2.0, -v24
    v_fma_f32 v109, v109, 2.0, -v25
    v_fma_f32 v124, v124, 2.0, -v26
    v_fma_f32 v125, v125, 2.0, -v27
    s_setprio 1
    v_cvt_pk_bf16_f32 v44, v24, v25
    v_cvt_pk_bf16_f32 v46, -v26, -v27
    s_setprio 0
    v_mul_f32 v76, v108, v236
    v_mul_f32 v77, v109, v237
    v_mul_f32 v92, v124, v236
    v_mul_f32 v93, v125, v237
    v_fma_f32 v76, -v124, v252, v76
    v_fma_f32 v77, -v125, v253, v77
    v_fmac_f32 v92, v108, v252
    v_fmac_f32 v93, v109, v253
    s_setprio 1
    v_cvt_pk_bf16_f32 v60, v76, v77
    v_cvt_pk_bf16_f32 v62, -v92, -v93
    s_setprio 0
    v_lshlrev_b32 v16, 16, v156
    v_and_b32 v18, 0xffff0000, v156
    v_lshlrev_b32 v20, 16, v157
    v_and_b32 v22, 0xffff0000, v157
    v_lshlrev_b32 v17, 16, v158
    v_and_b32 v19, 0xffff0000, v158
    v_lshlrev_b32 v21, 16, v159
    v_and_b32 v23, 0xffff0000, v159
    v_fma_f32 v24, v110, v238, v78
    v_fma_f32 v25, v111, v239, v79
    v_fma_f32 v26, v126, v238, v94
    v_fma_f32 v27, v127, v239, v95
    v_fmac_f32 v24, v126, v254
    v_fmac_f32 v25, v127, v255
    v_fma_f32 v26, -v110, v254, v26
    v_fma_f32 v27, -v111, v255, v27
    v_fma_f32 v78, v78, 2.0, -v24
    v_fma_f32 v79, v79, 2.0, -v25
    v_fma_f32 v94, v94, 2.0, -v26
    v_fma_f32 v95, v95, 2.0, -v27
    v_mul_f32 v110, v16, v24
    v_mul_f32 v111, v17, v25
    v_mul_f32 v126, v16, v26
    v_mul_f32 v127, v17, v27
    v_fma_f32 v110, -v18, v26, v110
    v_fma_f32 v111, -v19, v27, v111
    v_fmac_f32 v126, v18, v24
    v_fmac_f32 v127, v19, v25
    v_fma_f32 v24, v20, v78, v110
    v_fma_f32 v25, v21, v79, v111
    v_fma_f32 v26, v20, v94, v126
    v_fma_f32 v27, v21, v95, v127
    v_fma_f32 v24, -v22, v94, v24
    v_fma_f32 v25, -v23, v95, v25
    v_fmac_f32 v26, v22, v78
    v_fmac_f32 v27, v23, v79
    v_fma_f32 v110, v110, 2.0, -v24
    v_fma_f32 v111, v111, 2.0, -v25
    v_fma_f32 v126, v126, 2.0, -v26
    v_fma_f32 v127, v127, 2.0, -v27
    s_setprio 1
    v_cvt_pk_bf16_f32 v45, v24, v25
    v_cvt_pk_bf16_f32 v47, -v26, -v27
    s_setprio 0
    v_mul_f32 v78, v110, v238
    v_mul_f32 v79, v111, v239
    v_mul_f32 v94, v126, v238
    v_mul_f32 v95, v127, v239
    v_fma_f32 v78, -v126, v254, v78
    v_fma_f32 v79, -v127, v255, v79
    v_fmac_f32 v94, v110, v254
    v_fmac_f32 v95, v111, v255
    s_setprio 1
    v_cvt_pk_bf16_f32 v61, v78, v79
    v_cvt_pk_bf16_f32 v63, -v94, -v95
    s_setprio 0
    s_add_u32 s17, s17, 2
    s_cmp_lg_u32 s18, 0
    s_cbranch_scc1 COL_nw
    s_cmp_eq_u32 s15, 0
    s_cbranch_scc1 COL_nz
    s_waitcnt vmcnt(0)
    s_mov_b64 exec, 1
    ds_add_u32 v13, v14 offset:16
    s_mov_b64 exec, -1
COL_nz:
    s_lshr_b32 s22, s17, 1
    s_mul_i32 s22, s22, 0x4000
    s_and_b32 s23, s17, 1
    s_lshl_b32 s23, s23, 6
    s_add_u32 s22, s22, s23
    s_add_u32 s22, s22, 0x900000
    buffer_load_dwordx4 v[128:131], v0, s[28:31], s22 offen offset:0 sc1
    buffer_load_dwordx4 v[132:135], v0, s[28:31], s22 offen offset:2048 sc1
    s_add_u32 s22, s22, 4096
    buffer_load_dwordx4 v[136:139], v0, s[28:31], s22 offen offset:0 sc1
    buffer_load_dwordx4 v[140:143], v0, s[28:31], s22 offen offset:2048 sc1
    s_add_u32 s22, s22, 4096
    buffer_load_dwordx4 v[144:147], v0, s[28:31], s22 offen offset:0 sc1
    buffer_load_dwordx4 v[148:151], v0, s[28:31], s22 offen offset:2048 sc1
    s_add_u32 s22, s22, 4096
    buffer_load_dwordx4 v[152:155], v0, s[28:31], s22 offen offset:0 sc1
    buffer_load_dwordx4 v[156:159], v0, s[28:31], s22 offen offset:2048 sc1
    s_add_u32 s66, s64, 0
    s_cmp_ge_u32 s66, 28
    s_cselect_b32 s67, 28, 0
    s_sub_u32 s66, s66, s67
    s_cmp_ge_u32 s66, 28
    s_cselect_b32 s67, 28, 0
    s_sub_u32 s66, s66, s67
    s_lshl_b32 s66, s66, 18
    s_add_u32 s66, s66, s65
    buffer_load_dword v29, v28, s[60:63], s66 offen
    s_add_u32 s66, s66, 131072
    buffer_load_dword v29, v28, s[60:63], s66 offen
    s_branch COL_nw2
COL_nw:
    v_subrev_u32 v5, 8, v4
    s_mov_b32 s23, 3200000
COL_s2:
    ds_read_b32 v15, v5 offset:4
    s_sub_u32 s23, s23, 1
    s_cbranch_scc1 COL_s2_out
    s_waitcnt lgkmcnt(0)
    v_cmp_ne_u32 vcc, 4, v15
    s_cbranch_vccnz COL_s2
COL_s2_out:
    ds_read_b64_tr_b16 v[128:129], v10 offset:0
    ds_read_b64_tr_b16 v[130:131], v10 offset:4096
    ds_read_b64_tr_b16 v[132:133], v11 offset:0
    ds_read_b64_tr_b16 v[134:135], v11 offset:4096
    ds_read_b64_tr_b16 v[136:137], v10 offset:256
    ds_read_b64_tr_b16 v[138:139], v10 offset:4352
    ds_read_b64_tr_b16 v[140:141], v11 offset:256
    ds_read_b64_tr_b16 v[142:143], v11 offset:4352
    ds_read_b64_tr_b16 v[144:145], v10 offset:512
    ds_read_b64_tr_b16 v[146:147], v10 offset:4608
    ds_read_b64_tr_b16 v[148:149], v11 offset:512
    ds_read_b64_tr_b16 v[150:151], v11 offset:4608
    ds_read_b64_tr_b16 v[152:153], v10 offset:768
    ds_read_b64_tr_b16 v[154:155], v10 offset:4864
    ds_read_b64_tr_b16 v[156:157], v11 offset:768
    ds_read_b64_tr_b16 v[158:159], v11 offset:4864
COL_nw2:
    s_cmp_eq_u32 s18, 0
    v_mfma_f32_32x32x16_bf16 v[64:79], v[32:35], v[160:163], 0
    v_mfma_f32_32x32x16_bf16 v[80:95], v[32:35], v[176:179], 0
    v_mfma_f32_32x32x16_bf16 v[64:79], v[36:39], v[164:167], v[64:79]
    v_mfma_f32_32x32x16_bf16 v[80:95], v[36:39], v[180:183], v[80:95]
    s_cbranch_scc1 COL_ns0
    s_waitcnt lgkmcnt(14)
    buffer_store_dwordx4 v[128:131], v12, s[28:31], s32 offen sc1
COL_ns0:
    v_mfma_f32_32x32x16_bf16 v[64:79], v[40:43], v[168:171], v[64:79]
    v_mfma_f32_32x32x16_bf16 v[80:95], v[40:43], v[184:187], v[80:95]
    v_mfma_f32_32x32x16_bf16 v[64:79], v[44:47], v[172:175], v[64:79]
    s_cbranch_scc1 COL_ns1
    s_waitcnt lgkmcnt(12)
    buffer_store_dwordx4 v[132:135], v12, s[28:31], s33 offen sc1
COL_ns1:
    v_mfma_f32_32x32x16_bf16 v[80:95], v[44:47], v[188:191], v[80:95]
    v_mfma_f32_32x32x16_bf16 v[96:111], v[48:51], v[160:163], 0
    v_mfma_f32_32x32x16_bf16 v[112:127], v[48:51], v[176:179], 0
    s_cbranch_scc1 COL_ns2
    s_waitcnt lgkmcnt(10)
    buffer_store_dwordx4 v[136:139], v12, s[28:31], s34 offen sc1
COL_ns2:
    v_mfma_f32_32x32x16_bf16 v[96:111], v[52:55], v[164:167], v[96:111]
    v_mfma_f32_32x32x16_bf16 v[112:127], v[52:55], v[180:183], v[112:127]
    v_mfma_f32_32x32x16_bf16 v[96:111], v[56:59], v[168:171], v[96:111]
    s_cbranch_scc1 COL_ns3
    s_waitcnt lgkmcnt(8)
    buffer_store_dwordx4 v[140:143], v12, s[28:31], s35 offen sc1
COL_ns3:
    v_mfma_f32_32x32x16_bf16 v[112:127], v[56:59], v[184:187], v[112:127]
    v_mfma_f32_32x32x16_bf16 v[96:111], v[60:63], v[172:175], v[96:111]
    v_mfma_f32_32x32x16_bf16 v[112:127], v[60:63], v[188:191], v[112:127]
    s_cbranch_scc1 COL_ns4
    s_waitcnt lgkmcnt(6)
    buffer_store_dwordx4 v[144:147], v12, s[28:31], s36 offen sc1
COL_ns4:
    v_mul_f32 v16, v64, v192
    v_mul_f32 v17, v65, v193
    v_mul_f32 v18, v66, v194
    v_mul_f32 v19, v67, v195
    v_mul_f32 v20, v80, v192
    v_mul_f32 v21, v81, v193
    v_mul_f32 v22, v82, v194
    v_mul_f32 v23, v83, v195
    v_fmac_f32 v16, v80, v208
    v_fmac_f32 v17, v81, v209
    v_fmac_f32 v18, v82, v210
    v_fmac_f32 v19, v83, v211
    v_fma_f32 v20, -v64, v208, v20
    v_fma_f32 v21, -v65, v209, v21
    v_fma_f32 v22, -v66, v210, v22
    v_fma_f32 v23, -v67, v211, v23
    s_setprio 1
    v_cvt_pk_bf16_f32 v32, v16, v17
    v_cvt_pk_bf16_f32 v33, v18, v19
    v_cvt_pk_bf16_f32 v34, v20, v21
    v_cvt_pk_bf16_f32 v35, v22, v23
    s_setprio 0
    v_mul_f32 v16, v68, v196
    v_mul_f32 v17, v69, v197
    v_mul_f32 v18, v70, v198
    v_mul_f32 v19, v71, v199
    v_mul_f32 v20, v84, v196
    v_mul_f32 v21, v85, v197
    v_mul_f32 v22, v86, v198
    v_mul_f32 v23, v87, v199
    v_fmac_f32 v16, v84, v212
    v_fmac_f32 v17, v85, v213
    v_fmac_f32 v18, v86, v214
    v_fmac_f32 v19, v87, v215
    v_fma_f32 v20, -v68, v212, v20
    v_fma_f32 v21, -v69, v213, v21
    v_fma_f32 v22, -v70, v214, v22
    v_fma_f32 v23, -v71, v215, v23
    s_setprio 1
    v_cvt_pk_bf16_f32 v36, v16, v17
    v_cvt_pk_bf16_f32 v37, v18, v19
    v_cvt_pk_bf16_f32 v38, v20, v21
    v_cvt_pk_bf16_f32 v39, v22, v23
    s_setprio 0
    v_mul_f32 v16, v72, v200
    v_mul_f32 v17, v73, v201
    v_mul_f32 v18, v74, v202
    v_mul_f32 v19, v75, v203
    v_mul_f32 v20, v88, v200
    v_mul_f32 v21, v89, v201
    v_mul_f32 v22, v90, v202
    v_mul_f32 v23, v91, v203
    v_fmac_f32 v16, v88, v216
    v_fmac_f32 v17, v89, v217
    v_fmac_f32 v18, v90, v218
    v_fmac_f32 v19, v91, v219
    v_fma_f32 v20, -v72, v216, v20
    v_fma_f32 v21, -v73, v217, v21
    v_fma_f32 v22, -v74, v218, v22
    v_fma_f32 v23, -v75, v219, v23
    s_setprio 1
    v_cvt_pk_bf16_f32 v40, v16, v17
    v_cvt_pk_bf16_f32 v41, v18, v19
    v_cvt_pk_bf16_f32 v42, v20, v21
    v_cvt_pk_bf16_f32 v43, v22, v23
    s_setprio 0
    v_mul_f32 v16, v76, v204
    v_mul_f32 v17, v77, v205
    v_mul_f32 v18, v78, v206
    v_mul_f32 v19, v79, v207
    v_mul_f32 v20, v92, v204
    v_mul_f32 v21, v93, v205
    v_mul_f32 v22, v94, v206
    v_mul_f32 v23, v95, v207
    v_fmac_f32 v16, v92, v220
    v_fmac_f32 v17, v93, v221
    v_fmac_f32 v18, v94, v222
    v_fmac_f32 v19, v95, v223
    v_fma_f32 v20, -v76, v220, v20
    v_fma_f32 v21, -v77, v221, v21
    v_fma_f32 v22, -v78, v222, v22
    v_fma_f32 v23, -v79, v223, v23
    s_setprio 1
    v_cvt_pk_bf16_f32 v44, v16, v17
    v_cvt_pk_bf16_f32 v45, v18, v19
    v_cvt_pk_bf16_f32 v46, v20, v21
    v_cvt_pk_bf16_f32 v47, v22, v23
    s_setprio 0
    v_mul_f32 v16, v96, v192
    v_mul_f32 v17, v97, v193
    v_mul_f32 v18, v98, v194
    v_mul_f32 v19, v99, v195
    v_mul_f32 v20, v112, v192
    v_mul_f32 v21, v113, v193
    v_mul_f32 v22, v114, v194
    v_mul_f32 v23, v115, v195
    v_fmac_f32 v16, v112, v208
    v_fmac_f32 v17, v113, v209
    v_fmac_f32 v18, v114, v210
    v_fmac_f32 v19, v115, v211
    v_fma_f32 v20, -v96, v208, v20
    v_fma_f32 v21, -v97, v209, v21
    v_fma_f32 v22, -v98, v210, v22
    v_fma_f32 v23, -v99, v211, v23
    s_setprio 1
    v_cvt_pk_bf16_f32 v48, v16, v17
    v_cvt_pk_bf16_f32 v49, v18, v19
    v_cvt_pk_bf16_f32 v50, v20, v21
    v_cvt_pk_bf16_f32 v51, v22, v23
    s_setprio 0
    v_mul_f32 v16, v100, v196
    v_mul_f32 v17, v101, v197
    v_mul_f32 v18, v102, v198
    v_mul_f32 v19, v103, v199
    v_mul_f32 v20, v116, v196
    v_mul_f32 v21, v117, v197
    v_mul_f32 v22, v118, v198
    v_mul_f32 v23, v119, v199
    v_fmac_f32 v16, v116, v212
    v_fmac_f32 v17, v117, v213
    v_fmac_f32 v18, v118, v214
    v_fmac_f32 v19, v119, v215
    v_fma_f32 v20, -v100, v212, v20
    v_fma_f32 v21, -v101, v213, v21
    v_fma_f32 v22, -v102, v214, v22
    v_fma_f32 v23, -v103, v215, v23
    s_setprio 1
    v_cvt_pk_bf16_f32 v52, v16, v17
    v_cvt_pk_bf16_f32 v53, v18, v19
    v_cvt_pk_bf16_f32 v54, v20, v21
    v_cvt_pk_bf16_f32 v55, v22, v23
    s_setprio 0
    v_mul_f32 v16, v104, v200
    v_mul_f32 v17, v105, v201
    v_mul_f32 v18, v106, v202
    v_mul_f32 v19, v107, v203
    v_mul_f32 v20, v120, v200
    v_mul_f32 v21, v121, v201
    v_mul_f32 v22, v122, v202
    v_mul_f32 v23, v123, v203
    v_fmac_f32 v16, v120, v216
    v_fmac_f32 v17, v121, v217
    v_fmac_f32 v18, v122, v218
    v_fmac_f32 v19, v123, v219
    v_fma_f32 v20, -v104, v216, v20
    v_fma_f32 v21, -v105, v217, v21
    v_fma_f32 v22, -v106, v218, v22
    v_fma_f32 v23, -v107, v219, v23
    s_setprio 1
    v_cvt_pk_bf16_f32 v56, v16, v17
    v_cvt_pk_bf16_f32 v57, v18, v19
    v_cvt_pk_bf16_f32 v58, v20, v21
    v_cvt_pk_bf16_f32 v59, v22, v23
    s_setprio 0
    v_mul_f32 v16, v108, v204
    v_mul_f32 v17, v109, v205
    v_mul_f32 v18, v110, v206
    v_mul_f32 v19, v111, v207
    v_mul_f32 v20, v124, v204
    v_mul_f32 v21, v125, v205
    v_mul_f32 v22, v126, v206
    v_mul_f32 v23, v127, v207
    v_fmac_f32 v16, v124, v220
    v_fmac_f32 v17, v125, v221
    v_fmac_f32 v18, v126, v222
    v_fmac_f32 v19, v127, v223
    v_fma_f32 v20, -v108, v220, v20
    v_fma_f32 v21, -v109, v221, v21
    v_fma_f32 v22, -v110, v222, v22
    v_fma_f32 v23, -v111, v223, v23
    s_setprio 1
    v_cvt_pk_bf16_f32 v60, v16, v17
    v_cvt_pk_bf16_f32 v61, v18, v19
    v_cvt_pk_bf16_f32 v62, v20, v21
    v_cvt_pk_bf16_f32 v63, v22, v23
    v_mfma_f32_32x32x16_bf16 v[64:79], v[160:163], v[32:35], 0
    v_mfma_f32_32x32x16_bf16 v[80:95], v[176:179], v[32:35], 0
    v_mfma_f32_32x32x16_bf16 v[64:79], v[164:167], v[36:39], v[64:79]
    s_cbranch_scc1 COL_ns5
    s_waitcnt lgkmcnt(4)
    buffer_store_dwordx4 v[148:151], v12, s[28:31], s37 offen sc1
COL_ns5:
    v_mfma_f32_32x32x16_bf16 v[80:95], v[180:183], v[36:39], v[80:95]
    v_mfma_f32_32x32x16_bf16 v[64:79], v[168:171], v[40:43], v[64:79]
    v_mfma_f32_32x32x16_bf16 v[80:95], v[184:187], v[40:43], v[80:95]
    s_cbranch_scc1 COL_ns6
    s_waitcnt lgkmcnt(2)
    buffer_store_dwordx4 v[152:155], v12, s[28:31], s38 offen sc1
COL_ns6:
    v_mfma_f32_32x32x16_bf16 v[64:79], v[172:175], v[44:47], v[64:79]
    v_mfma_f32_32x32x16_bf16 v[80:95], v[188:191], v[44:47], v[80:95]
    v_mfma_f32_32x32x16_bf16 v[96:111], v[160:163], v[48:51], 0
    s_cbranch_scc1 COL_ns7
    s_waitcnt lgkmcnt(0)
    buffer_store_dwordx4 v[156:159], v12, s[28:31], s39 offen sc1
COL_ns7:
    v_mfma_f32_32x32x16_bf16 v[112:127], v[176:179], v[48:51], 0
    v_mfma_f32_32x32x16_bf16 v[96:111], v[164:167], v[52:55], v[96:111]
    v_mfma_f32_32x32x16_bf16 v[112:127], v[180:183], v[52:55], v[112:127]
    v_mfma_f32_32x32x16_bf16 v[96:111], v[168:171], v[56:59], v[96:111]
    v_mfma_f32_32x32x16_bf16 v[112:127], v[184:187], v[56:59], v[112:127]
    v_mfma_f32_32x32x16_bf16 v[96:111], v[172:175], v[60:63], v[96:111]
    v_mfma_f32_32x32x16_bf16 v[112:127], v[188:191], v[60:63], v[112:127]
    s_setprio 0
    s_mov_b32 s23, 3200000
COL_s3:
    ds_read_b32 v15, v4 offset:0
    s_sub_u32 s23, s23, 1
    s_cbranch_scc1 COL_s3_out
    s_waitcnt lgkmcnt(0)
    v_cmp_ne_u32 vcc, 4, v15
    s_cbranch_vccnz COL_s3
COL_s3_out:
    s_cmp_lg_u32 s17, 2
    s_cbranch_scc1 COL_nhalf
    v_mul_f32 v64, 0.5, v64
    v_mul_f32 v65, 0.5, v65
    v_mul_f32 v66, 0.5, v66
    v_mul_f32 v67, 0.5, v67
    v_mul_f32 v68, 0.5, v68
    v_mul_f32 v69, 0.5, v69
    v_mul_f32 v70, 0.5, v70
    v_mul_f32 v71, 0.5, v71
    v_mul_f32 v72, 0.5, v72
    v_mul_f32 v73, 0.5, v73
    v_mul_f32 v74, 0.5, v74
    v_mul_f32 v75, 0.5, v75
    v_mul_f32 v76, 0.5, v76
    v_mul_f32 v77, 0.5, v77
    v_mul_f32 v78, 0.5, v78
    v_mul_f32 v79, 0.5, v79
    v_mul_f32 v80, 0.5, v80
    v_mul_f32 v81, 0.5, v81
    v_mul_f32 v82, 0.5, v82
    v_mul_f32 v83, 0.5, v83
    v_mul_f32 v84, 0.5, v84
    v_mul_f32 v85, 0.5, v85
    v_mul_f32 v86, 0.5, v86
    v_mul_f32 v87, 0.5, v87
    v_mul_f32 v88, 0.5, v88
    v_mul_f32 v89, 0.5, v89
    v_mul_f32 v90, 0.5, v90
    v_mul_f32 v91, 0.5, v91
    v_mul_f32 v92, 0.5, v92
    v_mul_f32 v93, 0.5, v93
    v_mul_f32 v94, 0.5, v94
    v_mul_f32 v95, 0.5, v95
    v_mul_f32 v96, 0.5, v96
    v_mul_f32 v97, 0.5, v97
    v_mul_f32 v98, 0.5, v98
    v_mul_f32 v99, 0.5, v99
    v_mul_f32 v100, 0.5, v100
    v_mul_f32 v101, 0.5, v101
    v_mul_f32 v102, 0.5, v102
    v_mul_f32 v103, 0.5, v103
    v_mul_f32 v104, 0.5, v104
    v_mul_f32 v105, 0.5, v105
    v_mul_f32 v106, 0.5, v106
    v_mul_f32 v107, 0.5, v107
    v_mul_f32 v108, 0.5, v108
    v_mul_f32 v109, 0.5, v109
    v_mul_f32 v110, 0.5, v110
    v_mul_f32 v111, 0.5, v111
    v_mul_f32 v112, 0.5, v112
    v_mul_f32 v113, 0.5, v113
    v_mul_f32 v114, 0.5, v114
    v_mul_f32 v115, 0.5, v115
    v_mul_f32 v116, 0.5, v116
    v_mul_f32 v117, 0.5, v117
    v_mul_f32 v118, 0.5, v118
    v_mul_f32 v119, 0.5, v119
    v_mul_f32 v120, 0.5, v120
    v_mul_f32 v121, 0.5, v121
    v_mul_f32 v122, 0.5, v122
    v_mul_f32 v123, 0.5, v123
    v_mul_f32 v124, 0.5, v124
    v_mul_f32 v125, 0.5, v125
    v_mul_f32 v126, 0.5, v126
    v_mul_f32 v127, 0.5, v127
COL_nhalf:
    s_setprio 1
    s_nop 2
    v_cvt_pk_bf16_f32 v32, v64, v96
    v_cvt_pk_bf16_f32 v33, v65, v97
    v_cvt_pk_bf16_f32 v34, v66, v98
    v_cvt_pk_bf16_f32 v35, v67, v99
    ds_write_b128 v9, v[32:35] offset:0
    v_cvt_pk_bf16_f32 v36, v68, v100
    v_cvt_pk_bf16_f32 v37, v69, v101
    v_cvt_pk_bf16_f32 v38, v70, v102
    v_cvt_pk_bf16_f32 v39, v71, v103
    ds_write_b128 v9, v[36:39] offset:1024
    v_cvt_pk_bf16_f32 v40, v72, v104
    v_cvt_pk_bf16_f32 v41, v73, v105
    v_cvt_pk_bf16_f32 v42, v74, v106
    v_cvt_pk_bf16_f32 v43, v75, v107
    ds_write_b128 v9, v[40:43] offset:2048
    v_cvt_pk_bf16_f32 v44, v76, v108
    v_cvt_pk_bf16_f32 v45, v77, v109
    v_cvt_pk_bf16_f32 v46, v78, v110
    v_cvt_pk_bf16_f32 v47, v79, v111
    ds_write_b128 v9, v[44:47] offset:3072
    v_cvt_pk_bf16_f32 v48, v80, v112
    v_cvt_pk_bf16_f32 v49, v81, v113
    v_cvt_pk_bf16_f32 v50, v82, v114
    v_cvt_pk_bf16_f32 v51, v83, v115
    ds_write_b128 v9, v[48:51] offset:4096
    v_cvt_pk_bf16_f32 v52, v84, v116
    v_cvt_pk_bf16_f32 v53, v85, v117
    v_cvt_pk_bf16_f32 v54, v86, v118
    v_cvt_pk_bf16_f32 v55, v87, v119
    ds_write_b128 v9, v[52:55] offset:5120
    v_cvt_pk_bf16_f32 v56, v88, v120
    v_cvt_pk_bf16_f32 v57, v89, v121
    v_cvt_pk_bf16_f32 v58, v90, v122
    v_cvt_pk_bf16_f32 v59, v91, v123
    ds_write_b128 v9, v[56:59] offset:6144
    v_cvt_pk_bf16_f32 v60, v92, v124
    v_cvt_pk_bf16_f32 v61, v93, v125
    v_cvt_pk_bf16_f32 v62, v94, v126
    v_cvt_pk_bf16_f32 v63, v95, v127
    ds_write_b128 v9, v[60:63] offset:7168
    s_setprio 0
    s_mov_b64 exec, 1
    ds_add_u32 v4, v14 offset:4
    s_mov_b64 exec, -1
    s_cmp_lg_u32 s18, 0
    s_cbranch_scc1 COL_last
    s_mov_b32 s18, 1
    v_add_u32 v6, 0x10000, v6
    v_add_u32 v7, 0x10000, v7
    v_add_u32 v9, 0x10000, v9
    v_add_u32 v4, 8, v4
    s_branch COL_round
COL_last:
    v_add_u32 v10, 0x10000, v10
    v_add_u32 v11, 0x10000, v11
    s_mov_b32 s23, 3200000
COL_s4:
    ds_read_b32 v15, v4 offset:4
    s_sub_u32 s23, s23, 1
    s_cbranch_scc1 COL_s4_out
    s_waitcnt lgkmcnt(0)
    v_cmp_ne_u32 vcc, 4, v15
    s_cbranch_vccnz COL_s4
COL_s4_out:
    ds_read_b64_tr_b16 v[64:65], v10 offset:0
    ds_read_b64_tr_b16 v[66:67], v10 offset:4096
    ds_read_b64_tr_b16 v[68:69], v11 offset:0
    ds_read_b64_tr_b16 v[70:71], v11 offset:4096
    ds_read_b64_tr_b16 v[72:73], v10 offset:256
    ds_read_b64_tr_b16 v[74:75], v10 offset:4352
    ds_read_b64_tr_b16 v[76:77], v11 offset:256
    ds_read_b64_tr_b16 v[78:79], v11 offset:4352
    ds_read_b64_tr_b16 v[80:81], v10 offset:512
    ds_read_b64_tr_b16 v[82:83], v10 offset:4608
    ds_read_b64_tr_b16 v[84:85], v11 offset:512
    ds_read_b64_tr_b16 v[86:87], v11 offset:4608
    ds_read_b64_tr_b16 v[88:89], v10 offset:768
    ds_read_b64_tr_b16 v[90:91], v10 offset:4864
    ds_read_b64_tr_b16 v[92:93], v11 offset:768
    ds_read_b64_tr_b16 v[94:95], v11 offset:4864
    s_waitcnt lgkmcnt(14)
    buffer_store_dwordx4 v[64:67], v12, s[28:31], s32 offen offset:256 sc1
    s_waitcnt lgkmcnt(12)
    buffer_store_dwordx4 v[68:71], v12, s[28:31], s33 offen offset:256 sc1
    s_waitcnt lgkmcnt(10)
    buffer_store_dwordx4 v[72:75], v12, s[28:31], s34 offen offset:256 sc1
    s_waitcnt lgkmcnt(8)
    buffer_store_dwordx4 v[76:79], v12, s[28:31], s35 offen offset:256 sc1
    s_waitcnt lgkmcnt(6)
    buffer_store_dwordx4 v[80:83], v12, s[28:31], s36 offen offset:256 sc1
    s_waitcnt lgkmcnt(4)
    buffer_store_dwordx4 v[84:87], v12, s[28:31], s37 offen offset:256 sc1
    s_waitcnt lgkmcnt(2)
    buffer_store_dwordx4 v[88:91], v12, s[28:31], s38 offen offset:256 sc1
    s_waitcnt lgkmcnt(0)
    buffer_store_dwordx4 v[92:95], v12, s[28:31], s39 offen offset:256 sc1
COL_done:
    s_cmp_ge_u32 s12, 4
    s_cbranch_scc1 COL_Lx
    s_mov_b64 exec, 1
    ds_add_u32 v13, v14 offset:20
    s_mov_b64 exec, -1
    s_or_b32 s22, s19, s12
    s_cmp_eq_u32 s22, 0
    s_cbranch_scc1 COL_ny
    s_waitcnt vmcnt(0)
    s_mov_b64 exec, 1
    ds_add_rtn_u32 v24, v13, v14 offset:28
    s_waitcnt lgkmcnt(0)
    v_cmp_ne_u32 vcc, 7, v24
    s_mov_b64 exec, -1
    s_cbranch_vccnz COL_fr_na
    s_lshl_b32 s22, s2, 2
    s_add_u32 s22, s22, 0x3007c80
    v_lshlrev_b32 v25, 7, v1
    s_mov_b64 exec, 0xff
    v_mov_b32 v24, s3
    buffer_store_dword v24, v25, s[28:31], s22 offen sc1
    s_mov_b64 exec, -1
COL_fr_na:
    s_load_dwordx2 s[6:7], s[0:1], 48
    s_lshr_b32 s14, s54, 2
    s_bfe_u32 s13, s54, 0x10001
    s_lshl_b32 s13, s13, 3
    s_add_u32 s13, s13, s55
    s_mul_i32 s14, s14, 7340032
    s_lshl_b32 s13, s13, 8
    s_add_u32 s13, s13, s14
    s_lshl_b32 s14, s57, 2
    s_add_u32 s14, s14, s12
    s_mul_i32 s14, s14, 229376
    s_add_u32 s13, s13, s14
    v_lshrrev_b32 v24, 1, v1
    v_and_b32 v25, 1, v1
    v_lshlrev_b32 v25, 7, v25
    v_min_u32 v26, 23, v24
    v_lshl_add_u32 v24, v24, 12, v25
    v_lshl_add_u32 v26, v26, 12, v25
    s_waitcnt lgkmcnt(0)
    s_mov_b32 s32, s6
    s_and_b32 s33, s7, 0xffff
    s_mov_b32 s34, 0xe00000
    s_mov_b32 s35, 0x20000
    buffer_load_dword v15, v24, s[32:35], s13 offen
    s_add_u32 s13, s13, 131072
    buffer_load_dword v15, v26, s[32:35], s13 offen
    s_mov_b32 s24, 0
    s_branch G2_R2
COL_ny:
    s_mov_b32 s17, 512
    v_lshlrev_b32 v6, 5, v1
    s_mov_b32 s25, 0x800000
    s_add_u32 s26, s25, 4096
    buffer_load_dwordx4 v[32:35], v6, s[28:31], s25 offen offset:0 sc1
    buffer_load_dwordx4 v[36:39], v6, s[28:31], s25 offen offset:2048 sc1
    buffer_load_dwordx4 v[40:43], v6, s[28:31], s26 offen offset:0 sc1
    buffer_load_dwordx4 v[44:47], v6, s[28:31], s26 offen offset:2048 sc1
    buffer_load_dwordx4 v[48:51], v6, s[28:31], s25 offen offset:16 sc1
    buffer_load_dwordx4 v[52:55], v6, s[28:31], s25 offen offset:2064 sc1
    buffer_load_dwordx4 v[56:59], v6, s[28:31], s26 offen offset:16 sc1
    buffer_load_dwordx4 v[60:63], v6, s[28:31], s26 offen offset:2064 sc1
    s_waitcnt vmcnt(8)
    s_mov_b64 exec, 1
    ds_add_rtn_u32 v24, v13, v14 offset:28
    s_waitcnt lgkmcnt(0)
    v_cmp_ne_u32 vcc, 7, v24
    s_mov_b64 exec, -1
    s_cbranch_vccnz COL_fn_na
    s_lshl_b32 s22, s2, 2
    s_add_u32 s22, s22, 0x3007c80
    v_lshlrev_b32 v25, 7, v1
    s_mov_b64 exec, 0xff
    v_mov_b32 v24, s3
    buffer_store_dword v24, v25, s[28:31], s22 offen sc1
    s_mov_b64 exec, -1
COL_fn_na:
    s_waitcnt vmcnt(0)
    v_mov_b32 v128, v32
    v_mov_b32 v129, v33
    s_lshr_b32 s22, s17, 6
    s_min_u32 s22, s22, 7
    s_lshl_b32 s22, s22, 9
    s_add_u32 s22, s22, 0x3004000
    v_lshlrev_b32 v16, 3, v1
    s_mov_b32 s23, 200000
COL_wn:
    buffer_load_dwordx2 v[32:33], v16, s[28:31], s22 offen sc1
    s_sub_u32 s23, s23, 1
    s_cbranch_scc1 COL_wn_out
    s_waitcnt vmcnt(0)
    v_xor_b32 v32, s3, v32
    v_xor_b32 v33, s3, v33
    v_or_b32 v32, v32, v33
    v_cmp_ne_u32 vcc, 0, v32
    s_cbranch_vccnz COL_wn
COL_wn_out:
    v_mov_b32 v32, v128
    v_mov_b32 v33, v129
    s_lshr_b32 s22, s17, 1
    s_mul_i32 s22, s22, 0x4000
    s_and_b32 s23, s17, 1
    s_lshl_b32 s23, s23, 6
    s_add_u32 s22, s22, s23
    s_add_u32 s22, s22, 0x900000
    buffer_load_dwordx4 v[128:131], v0, s[28:31], s22 offen offset:0 sc1
    buffer_load_dwordx4 v[132:135], v0, s[28:31], s22 offen offset:2048 sc1
    s_add_u32 s22, s22, 4096
    buffer_load_dwordx4 v[136:139], v0, s[28:31], s22 offen offset:0 sc1
    buffer_load_dwordx4 v[140:143], v0, s[28:31], s22 offen offset:2048 sc1
    s_add_u32 s22, s22, 4096
    buffer_load_dwordx4 v[144:147], v0, s[28:31], s22 offen offset:0 sc1
    buffer_load_dwordx4 v[148:151], v0, s[28:31], s22 offen offset:2048 sc1
    s_add_u32 s22, s22, 4096
    buffer_load_dwordx4 v[152:155], v0, s[28:31], s22 offen offset:0 sc1
    buffer_load_dwordx4 v[156:159], v0, s[28:31], s22 offen offset:2048 sc1
    s_mov_b32 s23, 3200000
COL_s5:
    ds_read_b32 v15, v13 offset:76
    s_sub_u32 s23, s23, 1
    s_cbranch_scc1 COL_s5_out
    s_waitcnt lgkmcnt(0)
    v_cmp_ne_u32 vcc, 4, v15
    s_cbranch_vccnz COL_s5
COL_s5_out:
    v_mfma_f32_32x32x16_bf16 v[64:79], v[32:35], v[160:163], 0
    v_mfma_f32_32x32x16_bf16 v[80:95], v[32:35], v[176:179], 0
    v_mfma_f32_32x32x16_bf16 v[64:79], v[36:39], v[164:167], v[64:79]
    v_mfma_f32_32x32x16_bf16 v[80:95], v[36:39], v[180:183], v[80:95]
    v_mfma_f32_32x32x16_bf16 v[64:79], v[40:43], v[168:171], v[64:79]
    v_mfma_f32_32x32x16_bf16 v[80:95], v[40:43], v[184:187], v[80:95]
    v_mfma_f32_32x32x16_bf16 v[64:79], v[44:47], v[172:175], v[64:79]
    v_mfma_f32_32x32x16_bf16 v[80:95], v[44:47], v[188:191], v[80:95]
    v_mfma_f32_32x32x16_bf16 v[96:111], v[48:51], v[160:163], 0
    v_mfma_f32_32x32x16_bf16 v[112:127], v[48:51], v[176:179], 0
    v_mfma_f32_32x32x16_bf16 v[96:111], v[52:55], v[164:167], v[96:111]
    v_mfma_f32_32x32x16_bf16 v[112:127], v[52:55], v[180:183], v[112:127]
    v_mfma_f32_32x32x16_bf16 v[96:111], v[56:59], v[168:171], v[96:111]
    v_mfma_f32_32x32x16_bf16 v[112:127], v[56:59], v[184:187], v[112:127]
    v_mfma_f32_32x32x16_bf16 v[96:111], v[60:63], v[172:175], v[96:111]
    v_mfma_f32_32x32x16_bf16 v[112:127], v[60:63], v[188:191], v[112:127]
    s_nop 2
    v_mul_f32 v16, v64, v192
    v_mul_f32 v17, v65, v193
    v_mul_f32 v18, v66, v194
    v_mul_f32 v19, v67, v195
    v_mul_f32 v20, v80, v192
    v_mul_f32 v21, v81, v193
    v_mul_f32 v22, v82, v194
    v_mul_f32 v23, v83, v195
    v_fmac_f32 v16, v80, v208
    v_fmac_f32 v17, v81, v209
    v_fmac_f32 v18, v82, v210
    v_fmac_f32 v19, v83, v211
    v_fma_f32 v20, -v64, v208, v20
    v_fma_f32 v21, -v65, v209, v21
    v_fma_f32 v22, -v66, v210, v22
    v_fma_f32 v23, -v67, v211, v23
    s_setprio 1
    v_cvt_pk_bf16_f32 v32, v16, v17
    v_cvt_pk_bf16_f32 v33, v18, v19
    v_cvt_pk_bf16_f32 v34, v20, v21
    v_cvt_pk_bf16_f32 v35, v22, v23
    s_setprio 0
    v_mul_f32 v16, v68, v196
    v_mul_f32 v17, v69, v197
    v_mul_f32 v18, v70, v198
    v_mul_f32 v19, v71, v199
    v_mul_f32 v20, v84, v196
    v_mul_f32 v21, v85, v197
    v_mul_f32 v22, v86, v198
    v_mul_f32 v23, v87, v199
    v_fmac_f32 v16, v84, v212
    v_fmac_f32 v17, v85, v213
    v_fmac_f32 v18, v86, v214
    v_fmac_f32 v19, v87, v215
    v_fma_f32 v20, -v68, v212, v20
    v_fma_f32 v21, -v69, v213, v21
    v_fma_f32 v22, -v70, v214, v22
    v_fma_f32 v23, -v71, v215, v23
    s_setprio 1
    v_cvt_pk_bf16_f32 v36, v16, v17
    v_cvt_pk_bf16_f32 v37, v18, v19
    v_cvt_pk_bf16_f32 v38, v20, v21
    v_cvt_pk_bf16_f32 v39, v22, v23
    s_setprio 0
    v_mul_f32 v16, v72, v200
    v_mul_f32 v17, v73, v201
    v_mul_f32 v18, v74, v202
    v_mul_f32 v19, v75, v203
    v_mul_f32 v20, v88, v200
    v_mul_f32 v21, v89, v201
    v_mul_f32 v22, v90, v202
    v_mul_f32 v23, v91, v203
    v_fmac_f32 v16, v88, v216
    v_fmac_f32 v17, v89, v217
    v_fmac_f32 v18, v90, v218
    v_fmac_f32 v19, v91, v219
    v_fma_f32 v20, -v72, v216, v20
    v_fma_f32 v21, -v73, v217, v21
    v_fma_f32 v22, -v74, v218, v22
    v_fma_f32 v23, -v75, v219, v23
    s_setprio 1
    v_cvt_pk_bf16_f32 v40, v16, v17
    v_cvt_pk_bf16_f32 v41, v18, v19
    v_cvt_pk_bf16_f32 v42, v20, v21
    v_cvt_pk_bf16_f32 v43, v22, v23
    s_setprio 0
    v_mul_f32 v16, v76, v204
    v_mul_f32 v17, v77, v205
    v_mul_f32 v18, v78, v206
    v_mul_f32 v19, v79, v207
    v_mul_f32 v20, v92, v204
    v_mul_f32 v21, v93, v205
    v_mul_f32 v22, v94, v206
    v_mul_f32 v23, v95, v207
    v_fmac_f32 v16, v92, v220
    v_fmac_f32 v17, v93, v221
    v_fmac_f32 v18, v94, v222
    v_fmac_f32 v19, v95, v223
    v_fma_f32 v20, -v76, v220, v20
    v_fma_f32 v21, -v77, v221, v21
    v_fma_f32 v22, -v78, v222, v22
    v_fma_f32 v23, -v79, v223, v23
    s_setprio 1
    v_cvt_pk_bf16_f32 v44, v16, v17
    v_cvt_pk_bf16_f32 v45, v18, v19
    v_cvt_pk_bf16_f32 v46, v20, v21
    v_cvt_pk_bf16_f32 v47, v22, v23
    s_setprio 0
    v_mul_f32 v16, v96, v192
    v_mul_f32 v17, v97, v193
    v_mul_f32 v18, v98, v194
    v_mul_f32 v19, v99, v195
    v_mul_f32 v20, v112, v192
    v_mul_f32 v21, v113, v193
    v_mul_f32 v22, v114, v194
    v_mul_f32 v23, v115, v195
    v_fmac_f32 v16, v112, v208
    v_fmac_f32 v17, v113, v209
    v_fmac_f32 v18, v114, v210
    v_fmac_f32 v19, v115, v211
    v_fma_f32 v20, -v96, v208, v20
    v_fma_f32 v21, -v97, v209, v21
    v_fma_f32 v22, -v98, v210, v22
    v_fma_f32 v23, -v99, v211, v23
    s_setprio 1
    v_cvt_pk_bf16_f32 v48, v16, v17
    v_cvt_pk_bf16_f32 v49, v18, v19
    v_cvt_pk_bf16_f32 v50, v20, v21
    v_cvt_pk_bf16_f32 v51, v22, v23
    s_setprio 0
    v_mul_f32 v16, v100, v196
    v_mul_f32 v17, v101, v197
    v_mul_f32 v18, v102, v198
    v_mul_f32 v19, v103, v199
    v_mul_f32 v20, v116, v196
    v_mul_f32 v21, v117, v197
    v_mul_f32 v22, v118, v198
    v_mul_f32 v23, v119, v199
    v_fmac_f32 v16, v116, v212
    v_fmac_f32 v17, v117, v213
    v_fmac_f32 v18, v118, v214
    v_fmac_f32 v19, v119, v215
    v_fma_f32 v20, -v100, v212, v20
    v_fma_f32 v21, -v101, v213, v21
    v_fma_f32 v22, -v102, v214, v22
    v_fma_f32 v23, -v103, v215, v23
    s_setprio 1
    v_cvt_pk_bf16_f32 v52, v16, v17
    v_cvt_pk_bf16_f32 v53, v18, v19
    v_cvt_pk_bf16_f32 v54, v20, v21
    v_cvt_pk_bf16_f32 v55, v22, v23
    s_setprio 0
    v_mul_f32 v16, v104, v200
    v_mul_f32 v17, v105, v201
    v_mul_f32 v18, v106, v202
    v_mul_f32 v19, v107, v203
    v_mul_f32 v20, v120, v200
    v_mul_f32 v21, v121, v201
    v_mul_f32 v22, v122, v202
    v_mul_f32 v23, v123, v203
    v_fmac_f32 v16, v120, v216
    v_fmac_f32 v17, v121, v217
    v_fmac_f32 v18, v122, v218
    v_fmac_f32 v19, v123, v219
    v_fma_f32 v20, -v104, v216, v20
    v_fma_f32 v21, -v105, v217, v21
    v_fma_f32 v22, -v106, v218, v22
    v_fma_f32 v23, -v107, v219, v23
    s_setprio 1
    v_cvt_pk_bf16_f32 v56, v16, v17
    v_cvt_pk_bf16_f32 v57, v18, v19
    v_cvt_pk_bf16_f32 v58, v20, v21
    v_cvt_pk_bf16_f32 v59, v22, v23
    s_setprio 0
    v_mul_f32 v16, v108, v204
    v_mul_f32 v17, v109, v205
    v_mul_f32 v18, v110, v206
    v_mul_f32 v19, v111, v207
    v_mul_f32 v20, v124, v204
    v_mul_f32 v21, v125, v205
    v_mul_f32 v22, v126, v206
    v_mul_f32 v23, v127, v207
    v_fmac_f32 v16, v124, v220
    v_fmac_f32 v17, v125, v221
    v_fmac_f32 v18, v126, v222
    v_fmac_f32 v19, v127, v223
    v_fma_f32 v20, -v108, v220, v20
    v_fma_f32 v21, -v109, v221, v21
    v_fma_f32 v22, -v110, v222, v22
    v_fma_f32 v23, -v111, v223, v23
    s_setprio 1
    v_cvt_pk_bf16_f32 v60, v16, v17
    v_cvt_pk_bf16_f32 v61, v18, v19
    v_cvt_pk_bf16_f32 v62, v20, v21
    v_cvt_pk_bf16_f32 v63, v22, v23
    v_mfma_f32_32x32x16_bf16 v[64:79], v[160:163], v[32:35], 0
    v_mfma_f32_32x32x16_bf16 v[80:95], v[176:179], v[32:35], 0
    v_mfma_f32_32x32x16_bf16 v[64:79], v[164:167], v[36:39], v[64:79]
    v_mfma_f32_32x32x16_bf16 v[80:95], v[180:183], v[36:39], v[80:95]
    v_mfma_f32_32x32x16_bf16 v[64:79], v[168:171], v[40:43], v[64:79]
    v_mfma_f32_32x32x16_bf16 v[80:95], v[184:187], v[40:43], v[80:95]
    v_mfma_f32_32x32x16_bf16 v[64:79], v[172:175], v[44:47], v[64:79]
    v_mfma_f32_32x32x16_bf16 v[80:95], v[188:191], v[44:47], v[80:95]
    v_mfma_f32_32x32x16_bf16 v[96:111], v[160:163], v[48:51], 0
    v_mfma_f32_32x32x16_bf16 v[112:127], v[176:179], v[48:51], 0
    v_mfma_f32_32x32x16_bf16 v[96:111], v[164:167], v[52:55], v[96:111]
    v_mfma_f32_32x32x16_bf16 v[112:127], v[180:183], v[52:55], v[112:127]
    v_mfma_f32_32x32x16_bf16 v[96:111], v[168:171], v[56:59], v[96:111]
    v_mfma_f32_32x32x16_bf16 v[112:127], v[184:187], v[56:59], v[112:127]
    v_mfma_f32_32x32x16_bf16 v[96:111], v[172:175], v[60:63], v[96:111]
    v_mfma_f32_32x32x16_bf16 v[112:127], v[188:191], v[60:63], v[112:127]
    s_setprio 0
    s_waitcnt vmcnt(0)
    v_lshlrev_b32 v16, 16, v128
    v_and_b32 v18, 0xffff0000, v128
    v_lshlrev_b32 v20, 16, v129
    v_and_b32 v22, 0xffff0000, v129
    v_lshlrev_b32 v17, 16, v130
    v_and_b32 v19, 0xffff0000, v130
    v_lshlrev_b32 v21, 16, v131
    v_and_b32 v23, 0xffff0000, v131
    s_nop 0
    v_fma_f32 v24, v96, v224, v64
    v_fma_f32 v25, v97, v225, v65
    v_fma_f32 v26, v112, v224, v80
    v_fma_f32 v27, v113, v225, v81
    v_fmac_f32 v24, v112, v240
    v_fmac_f32 v25, v113, v241
    v_fma_f32 v26, -v96, v240, v26
    v_fma_f32 v27, -v97, v241, v27
    v_fma_f32 v64, v64, 2.0, -v24
    v_fma_f32 v65, v65, 2.0, -v25
    v_fma_f32 v80, v80, 2.0, -v26
    v_fma_f32 v81, v81, 2.0, -v27
    v_mul_f32 v96, v16, v24
    v_mul_f32 v97, v17, v25
    v_mul_f32 v112, v16, v26
    v_mul_f32 v113, v17, v27
    v_fma_f32 v96, -v18, v26, v96
    v_fma_f32 v97, -v19, v27, v97
    v_fmac_f32 v112, v18, v24
    v_fmac_f32 v113, v19, v25
    v_fma_f32 v24, v20, v64, v96
    v_fma_f32 v25, v21, v65, v97
    v_fma_f32 v26, v20, v80, v112
    v_fma_f32 v27, v21, v81, v113
    v_fma_f32 v24, -v22, v80, v24
    v_fma_f32 v25, -v23, v81, v25
    v_fmac_f32 v26, v22, v64
    v_fmac_f32 v27, v23, v65
    v_fma_f32 v96, v96, 2.0, -v24
    v_fma_f32 v97, v97, 2.0, -v25
    v_fma_f32 v112, v112, 2.0, -v26
    v_fma_f32 v113, v113, 2.0, -v27
    s_setprio 1
    v_cvt_pk_bf16_f32 v32, v24, v25
    v_cvt_pk_bf16_f32 v34, -v26, -v27
    s_setprio 0
    v_mul_f32 v64, v96, v224
    v_mul_f32 v65, v97, v225
    v_mul_f32 v80, v112, v224
    v_mul_f32 v81, v113, v225
    v_fma_f32 v64, -v112, v240, v64
    v_fma_f32 v65, -v113, v241, v65
    v_fmac_f32 v80, v96, v240
    v_fmac_f32 v81, v97, v241
    s_setprio 1
    v_cvt_pk_bf16_f32 v48, v64, v65
    v_cvt_pk_bf16_f32 v50, -v80, -v81
    s_setprio 0
    v_lshlrev_b32 v16, 16, v132
    v_and_b32 v18, 0xffff0000, v132
    v_lshlrev_b32 v20, 16, v133
    v_and_b32 v22, 0xffff0000, v133
    v_lshlrev_b32 v17, 16, v134
    v_and_b32 v19, 0xffff0000, v134
    v_lshlrev_b32 v21, 16, v135
    v_and_b32 v23, 0xffff0000, v135
    v_fma_f32 v24, v98, v226, v66
    v_fma_f32 v25, v99, v227, v67
    v_fma_f32 v26, v114, v226, v82
    v_fma_f32 v27, v115, v227, v83
    v_fmac_f32 v24, v114, v242
    v_fmac_f32 v25, v115, v243
    v_fma_f32 v26, -v98, v242, v26
    v_fma_f32 v27, -v99, v243, v27
    v_fma_f32 v66, v66, 2.0, -v24
    v_fma_f32 v67, v67, 2.0, -v25
    v_fma_f32 v82, v82, 2.0, -v26
    v_fma_f32 v83, v83, 2.0, -v27
    v_mul_f32 v98, v16, v24
    v_mul_f32 v99, v17, v25
    v_mul_f32 v114, v16, v26
    v_mul_f32 v115, v17, v27
    v_fma_f32 v98, -v18, v26, v98
    v_fma_f32 v99, -v19, v27, v99
    v_fmac_f32 v114, v18, v24
    v_fmac_f32 v115, v19, v25
    v_fma_f32 v24, v20, v66, v98
    v_fma_f32 v25, v21, v67, v99
    v_fma_f32 v26, v20, v82, v114
    v_fma_f32 v27, v21, v83, v115
    v_fma_f32 v24, -v22, v82, v24
    v_fma_f32 v25, -v23, v83, v25
    v_fmac_f32 v26, v22, v66
    v_fmac_f32 v27, v23, v67
    v_fma_f32 v98, v98, 2.0, -v24
    v_fma_f32 v99, v99, 2.0, -v25
    v_fma_f32 v114, v114, 2.0, -v26
    v_fma_f32 v115, v115, 2.0, -v27
    s_setprio 1
    v_cvt_pk_bf16_f32 v33, v24, v25
    v_cvt_pk_bf16_f32 v35, -v26, -v27
    s_setprio 0
    v_mul_f32 v66, v98, v226
    v_mul_f32 v67, v99, v227
    v_mul_f32 v82, v114, v226
    v_mul_f32 v83, v115, v227
    v_fma_f32 v66, -v114, v242, v66
    v_fma_f32 v67, -v115, v243, v67
    v_fmac_f32 v82, v98, v242
    v_fmac_f32 v83, v99, v243
    s_setprio 1
    v_cvt_pk_bf16_f32 v49, v66, v67
    v_cvt_pk_bf16_f32 v51, -v82, -v83
    s_setprio 0
    v_lshlrev_b32 v16, 16, v136
    v_and_b32 v18, 0xffff0000, v136
    v_lshlrev_b32 v20, 16, v137
    v_and_b32 v22, 0xffff0000, v137
    v_lshlrev_b32 v17, 16, v138
    v_and_b32 v19, 0xffff0000, v138
    v_lshlrev_b32 v21, 16, v139
    v_and_b32 v23, 0xffff0000, v139
    v_fma_f32 v24, v100, v228, v68
    v_fma_f32 v25, v101, v229, v69
    v_fma_f32 v26, v116, v228, v84
    v_fma_f32 v27, v117, v229, v85
    v_fmac_f32 v24, v116, v244
    v_fmac_f32 v25, v117, v245
    v_fma_f32 v26, -v100, v244, v26
    v_fma_f32 v27, -v101, v245, v27
    v_fma_f32 v68, v68, 2.0, -v24
    v_fma_f32 v69, v69, 2.0, -v25
    v_fma_f32 v84, v84, 2.0, -v26
    v_fma_f32 v85, v85, 2.0, -v27
    v_mul_f32 v100, v16, v24
    v_mul_f32 v101, v17, v25
    v_mul_f32 v116, v16, v26
    v_mul_f32 v117, v17, v27
    v_fma_f32 v100, -v18, v26, v100
    v_fma_f32 v101, -v19, v27, v101
    v_fmac_f32 v116, v18, v24
    v_fmac_f32 v117, v19, v25
    v_fma_f32 v24, v20, v68, v100
    v_fma_f32 v25, v21, v69, v101
    v_fma_f32 v26, v20, v84, v116
    v_fma_f32 v27, v21, v85, v117
    v_fma_f32 v24, -v22, v84, v24
    v_fma_f32 v25, -v23, v85, v25
    v_fmac_f32 v26, v22, v68
    v_fmac_f32 v27, v23, v69
    v_fma_f32 v100, v100, 2.0, -v24
    v_fma_f32 v101, v101, 2.0, -v25
    v_fma_f32 v116, v116, 2.0, -v26
    v_fma_f32 v117, v117, 2.0, -v27
    s_setprio 1
    v_cvt_pk_bf16_f32 v36, v24, v25
    v_cvt_pk_bf16_f32 v38, -v26, -v27
    s_setprio 0
    v_mul_f32 v68, v100, v228
    v_mul_f32 v69, v101, v229
    v_mul_f32 v84, v116, v228
    v_mul_f32 v85, v117, v229
    v_fma_f32 v68, -v116, v244, v68
    v_fma_f32 v69, -v117, v245, v69
    v_fmac_f32 v84, v100, v244
    v_fmac_f32 v85, v101, v245
    s_setprio 1
    v_cvt_pk_bf16_f32 v52, v68, v69
    v_cvt_pk_bf16_f32 v54, -v84, -v85
    s_setprio 0
    v_lshlrev_b32 v16, 16, v140
    v_and_b32 v18, 0xffff0000, v140
    v_lshlrev_b32 v20, 16, v141
    v_and_b32 v22, 0xffff0000, v141
    v_lshlrev_b32 v17, 16, v142
    v_and_b32 v19, 0xffff0000, v142
    v_lshlrev_b32 v21, 16, v143
    v_and_b32 v23, 0xffff0000, v143
    v_fma_f32 v24, v102, v230, v70
    v_fma_f32 v25, v103, v231, v71
    v_fma_f32 v26, v118, v230, v86
    v_fma_f32 v27, v119, v231, v87
    v_fmac_f32 v24, v118, v246
    v_fmac_f32 v25, v119, v247
    v_fma_f32 v26, -v102, v246, v26
    v_fma_f32 v27, -v103, v247, v27
    v_fma_f32 v70, v70, 2.0, -v24
    v_fma_f32 v71, v71, 2.0, -v25
    v_fma_f32 v86, v86, 2.0, -v26
    v_fma_f32 v87, v87, 2.0, -v27
    v_mul_f32 v102, v16, v24
    v_mul_f32 v103, v17, v25
    v_mul_f32 v118, v16, v26
    v_mul_f32 v119, v17, v27
    v_fma_f32 v102, -v18, v26, v102
    v_fma_f32 v103, -v19, v27, v103
    v_fmac_f32 v118, v18, v24
    v_fmac_f32 v119, v19, v25
    v_fma_f32 v24, v20, v70, v102
    v_fma_f32 v25, v21, v71, v103
    v_fma_f32 v26, v20, v86, v118
    v_fma_f32 v27, v21, v87, v119
    v_fma_f32 v24, -v22, v86, v24
    v_fma_f32 v25, -v23, v87, v25
    v_fmac_f32 v26, v22, v70
    v_fmac_f32 v27, v23, v71
    v_fma_f32 v102, v102, 2.0, -v24
    v_fma_f32 v103, v103, 2.0, -v25
    v_fma_f32 v118, v118, 2.0, -v26
    v_fma_f32 v119, v119, 2.0, -v27
    s_setprio 1
    v_cvt_pk_bf16_f32 v37, v24, v25
    v_cvt_pk_bf16_f32 v39, -v26, -v27
    s_setprio 0
    v_mul_f32 v70, v102, v230
    v_mul_f32 v71, v103, v231
    v_mul_f32 v86, v118, v230
    v_mul_f32 v87, v119, v231
    v_fma_f32 v70, -v118, v246, v70
    v_fma_f32 v71, -v119, v247, v71
    v_fmac_f32 v86, v102, v246
    v_fmac_f32 v87, v103, v247
    s_setprio 1
    v_cvt_pk_bf16_f32 v53, v70, v71
    v_cvt_pk_bf16_f32 v55, -v86, -v87
    s_setprio 0
    v_lshlrev_b32 v16, 16, v144
    v_and_b32 v18, 0xffff0000, v144
    v_lshlrev_b32 v20, 16, v145
    v_and_b32 v22, 0xffff0000, v145
    v_lshlrev_b32 v17, 16, v146
    v_and_b32 v19, 0xffff0000, v146
    v_lshlrev_b32 v21, 16, v147
    v_and_b32 v23, 0xffff0000, v147
    v_fma_f32 v24, v104, v232, v72
    v_fma_f32 v25, v105, v233, v73
    v_fma_f32 v26, v120, v232, v88
    v_fma_f32 v27, v121, v233, v89
    v_fmac_f32 v24, v120, v248
    v_fmac_f32 v25, v121, v249
    v_fma_f32 v26, -v104, v248, v26
    v_fma_f32 v27, -v105, v249, v27
    v_fma_f32 v72, v72, 2.0, -v24
    v_fma_f32 v73, v73, 2.0, -v25
    v_fma_f32 v88, v88, 2.0, -v26
    v_fma_f32 v89, v89, 2.0, -v27
    v_mul_f32 v104, v16, v24
    v_mul_f32 v105, v17, v25
    v_mul_f32 v120, v16, v26
    v_mul_f32 v121, v17, v27
    v_fma_f32 v104, -v18, v26, v104
    v_fma_f32 v105, -v19, v27, v105
    v_fmac_f32 v120, v18, v24
    v_fmac_f32 v121, v19, v25
    v_fma_f32 v24, v20, v72, v104
    v_fma_f32 v25, v21, v73, v105
    v_fma_f32 v26, v20, v88, v120
    v_fma_f32 v27, v21, v89, v121
    v_fma_f32 v24, -v22, v88, v24
    v_fma_f32 v25, -v23, v89, v25
    v_fmac_f32 v26, v22, v72
    v_fmac_f32 v27, v23, v73
    v_fma_f32 v104, v104, 2.0, -v24
    v_fma_f32 v105, v105, 2.0, -v25
    v_fma_f32 v120, v120, 2.0, -v26
    v_fma_f32 v121, v121, 2.0, -v27
    s_setprio 1
    v_cvt_pk_bf16_f32 v40, v24, v25
    v_cvt_pk_bf16_f32 v42, -v26, -v27
    s_setprio 0
    v_mul_f32 v72, v104, v232
    v_mul_f32 v73, v105, v233
    v_mul_f32 v88, v120, v232
    v_mul_f32 v89, v121, v233
    v_fma_f32 v72, -v120, v248, v72
    v_fma_f32 v73, -v121, v249, v73
    v_fmac_f32 v88, v104, v248
    v_fmac_f32 v89, v105, v249
    s_setprio 1
    v_cvt_pk_bf16_f32 v56, v72, v73
    v_cvt_pk_bf16_f32 v58, -v88, -v89
    s_setprio 0
    v_lshlrev_b32 v16, 16, v148
    v_and_b32 v18, 0xffff0000, v148
    v_lshlrev_b32 v20, 16, v149
    v_and_b32 v22, 0xffff0000, v149
    v_lshlrev_b32 v17, 16, v150
    v_and_b32 v19, 0xffff0000, v150
    v_lshlrev_b32 v21, 16, v151
    v_and_b32 v23, 0xffff0000, v151
    v_fma_f32 v24, v106, v234, v74
    v_fma_f32 v25, v107, v235, v75
    v_fma_f32 v26, v122, v234, v90
    v_fma_f32 v27, v123, v235, v91
    v_fmac_f32 v24, v122, v250
    v_fmac_f32 v25, v123, v251
    v_fma_f32 v26, -v106, v250, v26
    v_fma_f32 v27, -v107, v251, v27
    v_fma_f32 v74, v74, 2.0, -v24
    v_fma_f32 v75, v75, 2.0, -v25
    v_fma_f32 v90, v90, 2.0, -v26
    v_fma_f32 v91, v91, 2.0, -v27
    v_mul_f32 v106, v16, v24
    v_mul_f32 v107, v17, v25
    v_mul_f32 v122, v16, v26
    v_mul_f32 v123, v17, v27
    v_fma_f32 v106, -v18, v26, v106
    v_fma_f32 v107, -v19, v27, v107
    v_fmac_f32 v122, v18, v24
    v_fmac_f32 v123, v19, v25
    v_fma_f32 v24, v20, v74, v106
    v_fma_f32 v25, v21, v75, v107
    v_fma_f32 v26, v20, v90, v122
    v_fma_f32 v27, v21, v91, v123
    v_fma_f32 v24, -v22, v90, v24
    v_fma_f32 v25, -v23, v91, v25
    v_fmac_f32 v26, v22, v74
    v_fmac_f32 v27, v23, v75
    v_fma_f32 v106, v106, 2.0, -v24
    v_fma_f32 v107, v107, 2.0, -v25
    v_fma_f32 v122, v122, 2.0, -v26
    v_fma_f32 v123, v123, 2.0, -v27
    s_setprio 1
    v_cvt_pk_bf16_f32 v41, v24, v25
    v_cvt_pk_bf16_f32 v43, -v26, -v27
    s_setprio 0
    v_mul_f32 v74, v106, v234
    v_mul_f32 v75, v107, v235
    v_mul_f32 v90, v122, v234
    v_mul_f32 v91, v123, v235
    v_fma_f32 v74, -v122, v250, v74
    v_fma_f32 v75, -v123, v251, v75
    v_fmac_f32 v90, v106, v250
    v_fmac_f32 v91, v107, v251
    s_setprio 1
    v_cvt_pk_bf16_f32 v57, v74, v75
    v_cvt_pk_bf16_f32 v59, -v90, -v91
    s_setprio 0
    v_lshlrev_b32 v16, 16, v152
    v_and_b32 v18, 0xffff0000, v152
    v_lshlrev_b32 v20, 16, v153
    v_and_b32 v22, 0xffff0000, v153
    v_lshlrev_b32 v17, 16, v154
    v_and_b32 v19, 0xffff0000, v154
    v_lshlrev_b32 v21, 16, v155
    v_and_b32 v23, 0xffff0000, v155
    v_fma_f32 v24, v108, v236, v76
    v_fma_f32 v25, v109, v237, v77
    v_fma_f32 v26, v124, v236, v92
    v_fma_f32 v27, v125, v237, v93
    v_fmac_f32 v24, v124, v252
    v_fmac_f32 v25, v125, v253
    v_fma_f32 v26, -v108, v252, v26
    v_fma_f32 v27, -v109, v253, v27
    v_fma_f32 v76, v76, 2.0, -v24
    v_fma_f32 v77, v77, 2.0, -v25
    v_fma_f32 v92, v92, 2.0, -v26
    v_fma_f32 v93, v93, 2.0, -v27
    v_mul_f32 v108, v16, v24
    v_mul_f32 v109, v17, v25
    v_mul_f32 v124, v16, v26
    v_mul_f32 v125, v17, v27
    v_fma_f32 v108, -v18, v26, v108
    v_fma_f32 v109, -v19, v27, v109
    v_fmac_f32 v124, v18, v24
    v_fmac_f32 v125, v19, v25
    v_fma_f32 v24, v20, v76, v108
    v_fma_f32 v25, v21, v77, v109
    v_fma_f32 v26, v20, v92, v124
    v_fma_f32 v27, v21, v93, v125
    v_fma_f32 v24, -v22, v92, v24
    v_fma_f32 v25, -v23, v93, v25
    v_fmac_f32 v26, v22, v76
    v_fmac_f32 v27, v23, v77
    v_fma_f32 v108, v108, 2.0, -v24
    v_fma_f32 v109, v109, 2.0, -v25
    v_fma_f32 v124, v124, 2.0, -v26
    v_fma_f32 v125, v125, 2.0, -v27
    s_setprio 1
    v_cvt_pk_bf16_f32 v44, v24, v25
    v_cvt_pk_bf16_f32 v46, -v26, -v27
    s_setprio 0
    v_mul_f32 v76, v108, v236
    v_mul_f32 v77, v109, v237
    v_mul_f32 v92, v124, v236
    v_mul_f32 v93, v125, v237
    v_fma_f32 v76, -v124, v252, v76
    v_fma_f32 v77, -v125, v253, v77
    v_fmac_f32 v92, v108, v252
    v_fmac_f32 v93, v109, v253
    s_setprio 1
    v_cvt_pk_bf16_f32 v60, v76, v77
    v_cvt_pk_bf16_f32 v62, -v92, -v93
    s_setprio 0
    v_lshlrev_b32 v16, 16, v156
    v_and_b32 v18, 0xffff0000, v156
    v_lshlrev_b32 v20, 16, v157
    v_and_b32 v22, 0xffff0000, v157
    v_lshlrev_b32 v17, 16, v158
    v_and_b32 v19, 0xffff0000, v158
    v_lshlrev_b32 v21, 16, v159
    v_and_b32 v23, 0xffff0000, v159
    v_fma_f32 v24, v110, v238, v78
    v_fma_f32 v25, v111, v239, v79
    v_fma_f32 v26, v126, v238, v94
    v_fma_f32 v27, v127, v239, v95
    v_fmac_f32 v24, v126, v254
    v_fmac_f32 v25, v127, v255
    v_fma_f32 v26, -v110, v254, v26
    v_fma_f32 v27, -v111, v255, v27
    v_fma_f32 v78, v78, 2.0, -v24
    v_fma_f32 v79, v79, 2.0, -v25
    v_fma_f32 v94, v94, 2.0, -v26
    v_fma_f32 v95, v95, 2.0, -v27
    v_mul_f32 v110, v16, v24
    v_mul_f32 v111, v17, v25
    v_mul_f32 v126, v16, v26
    v_mul_f32 v127, v17, v27
    v_fma_f32 v110, -v18, v26, v110
    v_fma_f32 v111, -v19, v27, v111
    v_fmac_f32 v126, v18, v24
    v_fmac_f32 v127, v19, v25
    v_fma_f32 v24, v20, v78, v110
    v_fma_f32 v25, v21, v79, v111
    v_fma_f32 v26, v20, v94, v126
    v_fma_f32 v27, v21, v95, v127
    v_fma_f32 v24, -v22, v94, v24
    v_fma_f32 v25, -v23, v95, v25
    v_fmac_f32 v26, v22, v78
    v_fmac_f32 v27, v23, v79
    v_fma_f32 v110, v110, 2.0, -v24
    v_fma_f32 v111, v111, 2.0, -v25
    v_fma_f32 v126, v126, 2.0, -v26
    v_fma_f32 v127, v127, 2.0, -v27
    s_setprio 1
    v_cvt_pk_bf16_f32 v45, v24, v25
    v_cvt_pk_bf16_f32 v47, -v26, -v27
    s_setprio 0
    v_mul_f32 v78, v110, v238
    v_mul_f32 v79, v111, v239
    v_mul_f32 v94, v126, v238
    v_mul_f32 v95, v127, v239
    v_fma_f32 v78, -v126, v254, v78
    v_fma_f32 v79, -v127, v255, v79
    v_fmac_f32 v94, v110, v254
    v_fmac_f32 v95, v111, v255
    s_setprio 1
    v_cvt_pk_bf16_f32 v61, v78, v79
    v_cvt_pk_bf16_f32 v63, -v94, -v95
    s_setprio 0
    v_mfma_f32_32x32x16_bf16 v[64:79], v[32:35], v[160:163], 0
    v_mfma_f32_32x32x16_bf16 v[80:95], v[32:35], v[176:179], 0
    v_mfma_f32_32x32x16_bf16 v[64:79], v[36:39], v[164:167], v[64:79]
    v_mfma_f32_32x32x16_bf16 v[80:95], v[36:39], v[180:183], v[80:95]
    v_mfma_f32_32x32x16_bf16 v[64:79], v[40:43], v[168:171], v[64:79]
    v_mfma_f32_32x32x16_bf16 v[80:95], v[40:43], v[184:187], v[80:95]
    v_mfma_f32_32x32x16_bf16 v[64:79], v[44:47], v[172:175], v[64:79]
    v_mfma_f32_32x32x16_bf16 v[80:95], v[44:47], v[188:191], v[80:95]
    v_mfma_f32_32x32x16_bf16 v[96:111], v[48:51], v[160:163], 0
    v_mfma_f32_32x32x16_bf16 v[112:127], v[48:51], v[176:179], 0
    v_mfma_f32_32x32x16_bf16 v[96:111], v[52:55], v[164:167], v[96:111]
    v_mfma_f32_32x32x16_bf16 v[112:127], v[52:55], v[180:183], v[112:127]
    v_mfma_f32_32x32x16_bf16 v[96:111], v[56:59], v[168:171], v[96:111]
    v_mfma_f32_32x32x16_bf16 v[112:127], v[56:59], v[184:187], v[112:127]
    v_mfma_f32_32x32x16_bf16 v[96:111], v[60:63], v[172:175], v[96:111]
    v_mfma_f32_32x32x16_bf16 v[112:127], v[60:63], v[188:191], v[112:127]
    s_nop 2
    v_mul_f32 v16, v64, v192
    v_mul_f32 v17, v65, v193
    v_mul_f32 v18, v66, v194
    v_mul_f32 v19, v67, v195
    v_mul_f32 v20, v80, v192
    v_mul_f32 v21, v81, v193
    v_mul_f32 v22, v82, v194
    v_mul_f32 v23, v83, v195
    v_fmac_f32 v16, v80, v208
    v_fmac_f32 v17, v81, v209
    v_fmac_f32 v18, v82, v210
    v_fmac_f32 v19, v83, v211
    v_fma_f32 v20, -v64, v208, v20
    v_fma_f32 v21, -v65, v209, v21
    v_fma_f32 v22, -v66, v210, v22
    v_fma_f32 v23, -v67, v211, v23
    s_setprio 1
    v_cvt_pk_bf16_f32 v32, v16, v17
    v_cvt_pk_bf16_f32 v33, v18, v19
    v_cvt_pk_bf16_f32 v34, v20, v21
    v_cvt_pk_bf16_f32 v35, v22, v23
    s_setprio 0
    v_mul_f32 v16, v68, v196
    v_mul_f32 v17, v69, v197
    v_mul_f32 v18, v70, v198
    v_mul_f32 v19, v71, v199
    v_mul_f32 v20, v84, v196
    v_mul_f32 v21, v85, v197
    v_mul_f32 v22, v86, v198
    v_mul_f32 v23, v87, v199
    v_fmac_f32 v16, v84, v212
    v_fmac_f32 v17, v85, v213
    v_fmac_f32 v18, v86, v214
    v_fmac_f32 v19, v87, v215
    v_fma_f32 v20, -v68, v212, v20
    v_fma_f32 v21, -v69, v213, v21
    v_fma_f32 v22, -v70, v214, v22
    v_fma_f32 v23, -v71, v215, v23
    s_setprio 1
    v_cvt_pk_bf16_f32 v36, v16, v17
    v_cvt_pk_bf16_f32 v37, v18, v19
    v_cvt_pk_bf16_f32 v38, v20, v21
    v_cvt_pk_bf16_f32 v39, v22, v23
    s_setprio 0
    v_mul_f32 v16, v72, v200
    v_mul_f32 v17, v73, v201
    v_mul_f32 v18, v74, v202
    v_mul_f32 v19, v75, v203
    v_mul_f32 v20, v88, v200
    v_mul_f32 v21, v89, v201
    v_mul_f32 v22, v90, v202
    v_mul_f32 v23, v91, v203
    v_fmac_f32 v16, v88, v216
    v_fmac_f32 v17, v89, v217
    v_fmac_f32 v18, v90, v218
    v_fmac_f32 v19, v91, v219
    v_fma_f32 v20, -v72, v216, v20
    v_fma_f32 v21, -v73, v217, v21
    v_fma_f32 v22, -v74, v218, v22
    v_fma_f32 v23, -v75, v219, v23
    s_setprio 1
    v_cvt_pk_bf16_f32 v40, v16, v17
    v_cvt_pk_bf16_f32 v41, v18, v19
    v_cvt_pk_bf16_f32 v42, v20, v21
    v_cvt_pk_bf16_f32 v43, v22, v23
    s_setprio 0
    v_mul_f32 v16, v76, v204
    v_mul_f32 v17, v77, v205
    v_mul_f32 v18, v78, v206
    v_mul_f32 v19, v79, v207
    v_mul_f32 v20, v92, v204
    v_mul_f32 v21, v93, v205
    v_mul_f32 v22, v94, v206
    v_mul_f32 v23, v95, v207
    v_fmac_f32 v16, v92, v220
    v_fmac_f32 v17, v93, v221
    v_fmac_f32 v18, v94, v222
    v_fmac_f32 v19, v95, v223
    v_fma_f32 v20, -v76, v220, v20
    v_fma_f32 v21, -v77, v221, v21
    v_fma_f32 v22, -v78, v222, v22
    v_fma_f32 v23, -v79, v223, v23
    s_setprio 1
    v_cvt_pk_bf16_f32 v44, v16, v17
    v_cvt_pk_bf16_f32 v45, v18, v19
    v_cvt_pk_bf16_f32 v46, v20, v21
    v_cvt_pk_bf16_f32 v47, v22, v23
    s_setprio 0
    v_mul_f32 v16, v96, v192
    v_mul_f32 v17, v97, v193
    v_mul_f32 v18, v98, v194
    v_mul_f32 v19, v99, v195
    v_mul_f32 v20, v112, v192
    v_mul_f32 v21, v113, v193
    v_mul_f32 v22, v114, v194
    v_mul_f32 v23, v115, v195
    v_fmac_f32 v16, v112, v208
    v_fmac_f32 v17, v113, v209
    v_fmac_f32 v18, v114, v210
    v_fmac_f32 v19, v115, v211
    v_fma_f32 v20, -v96, v208, v20
    v_fma_f32 v21, -v97, v209, v21
    v_fma_f32 v22, -v98, v210, v22
    v_fma_f32 v23, -v99, v211, v23
    s_setprio 1
    v_cvt_pk_bf16_f32 v48, v16, v17
    v_cvt_pk_bf16_f32 v49, v18, v19
    v_cvt_pk_bf16_f32 v50, v20, v21
    v_cvt_pk_bf16_f32 v51, v22, v23
    s_setprio 0
    v_mul_f32 v16, v100, v196
    v_mul_f32 v17, v101, v197
    v_mul_f32 v18, v102, v198
    v_mul_f32 v19, v103, v199
    v_mul_f32 v20, v116, v196
    v_mul_f32 v21, v117, v197
    v_mul_f32 v22, v118, v198
    v_mul_f32 v23, v119, v199
    v_fmac_f32 v16, v116, v212
    v_fmac_f32 v17, v117, v213
    v_fmac_f32 v18, v118, v214
    v_fmac_f32 v19, v119, v215
    v_fma_f32 v20, -v100, v212, v20
    v_fma_f32 v21, -v101, v213, v21
    v_fma_f32 v22, -v102, v214, v22
    v_fma_f32 v23, -v103, v215, v23
    s_setprio 1
    v_cvt_pk_bf16_f32 v52, v16, v17
    v_cvt_pk_bf16_f32 v53, v18, v19
    v_cvt_pk_bf16_f32 v54, v20, v21
    v_cvt_pk_bf16_f32 v55, v22, v23
    s_setprio 0
    v_mul_f32 v16, v104, v200
    v_mul_f32 v17, v105, v201
    v_mul_f32 v18, v106, v202
    v_mul_f32 v19, v107, v203
    v_mul_f32 v20, v120, v200
    v_mul_f32 v21, v121, v201
    v_mul_f32 v22, v122, v202
    v_mul_f32 v23, v123, v203
    v_fmac_f32 v16, v120, v216
    v_fmac_f32 v17, v121, v217
    v_fmac_f32 v18, v122, v218
    v_fmac_f32 v19, v123, v219
    v_fma_f32 v20, -v104, v216, v20
    v_fma_f32 v21, -v105, v217, v21
    v_fma_f32 v22, -v106, v218, v22
    v_fma_f32 v23, -v107, v219, v23
    s_setprio 1
    v_cvt_pk_bf16_f32 v56, v16, v17
    v_cvt_pk_bf16_f32 v57, v18, v19
    v_cvt_pk_bf16_f32 v58, v20, v21
    v_cvt_pk_bf16_f32 v59, v22, v23
    s_setprio 0
    v_mul_f32 v16, v108, v204
    v_mul_f32 v17, v109, v205
    v_mul_f32 v18, v110, v206
    v_mul_f32 v19, v111, v207
    v_mul_f32 v20, v124, v204
    v_mul_f32 v21, v125, v205
    v_mul_f32 v22, v126, v206
    v_mul_f32 v23, v127, v207
    v_fmac_f32 v16, v124, v220
    v_fmac_f32 v17, v125, v221
    v_fmac_f32 v18, v126, v222
    v_fmac_f32 v19, v127, v223
    v_fma_f32 v20, -v108, v220, v20
    v_fma_f32 v21, -v109, v221, v21
    v_fma_f32 v22, -v110, v222, v22
    v_fma_f32 v23, -v111, v223, v23
    s_setprio 1
    v_cvt_pk_bf16_f32 v60, v16, v17
    v_cvt_pk_bf16_f32 v61, v18, v19
    v_cvt_pk_bf16_f32 v62, v20, v21
    v_cvt_pk_bf16_f32 v63, v22, v23
    v_mfma_f32_32x32x16_bf16 v[64:79], v[160:163], v[32:35], 0
    v_mfma_f32_32x32x16_bf16 v[80:95], v[176:179], v[32:35], 0
    v_mfma_f32_32x32x16_bf16 v[64:79], v[164:167], v[36:39], v[64:79]
    v_mfma_f32_32x32x16_bf16 v[80:95], v[180:183], v[36:39], v[80:95]
    v_mfma_f32_32x32x16_bf16 v[64:79], v[168:171], v[40:43], v[64:79]
    v_mfma_f32_32x32x16_bf16 v[80:95], v[184:187], v[40:43], v[80:95]
    v_mfma_f32_32x32x16_bf16 v[64:79], v[172:175], v[44:47], v[64:79]
    v_mfma_f32_32x32x16_bf16 v[80:95], v[188:191], v[44:47], v[80:95]
    v_mfma_f32_32x32x16_bf16 v[96:111], v[160:163], v[48:51], 0
    v_mfma_f32_32x32x16_bf16 v[112:127], v[176:179], v[48:51], 0
    v_mfma_f32_32x32x16_bf16 v[96:111], v[164:167], v[52:55], v[96:111]
    v_mfma_f32_32x32x16_bf16 v[112:127], v[180:183], v[52:55], v[112:127]
    v_mfma_f32_32x32x16_bf16 v[96:111], v[168:171], v[56:59], v[96:111]
    v_mfma_f32_32x32x16_bf16 v[112:127], v[184:187], v[56:59], v[112:127]
    v_mfma_f32_32x32x16_bf16 v[96:111], v[172:175], v[60:63], v[96:111]
    v_mfma_f32_32x32x16_bf16 v[112:127], v[188:191], v[60:63], v[112:127]
    s_setprio 0
    v_lshlrev_b32 v6, 3, v2
    v_lshl_add_u32 v6, v3, 10, v6
    s_mov_b32 s25, 0x1d00000
    s_add_u32 s26, s25, 4096
    v_mul_f32 v32, 0.5, v64
    s_nop 4
    v_mul_f32 v33, 0.5, v96
    buffer_store_dwordx2 v[32:33], v6, s[28:31], s25 offen offset:0 sc1
    v_mul_f32 v34, 0.5, v65
    v_mul_f32 v35, 0.5, v97
    buffer_store_dwordx2 v[34:35], v6, s[28:31], s25 offen offset:256 sc1
    v_mul_f32 v36, 0.5, v66
    v_mul_f32 v37, 0.5, v98
    buffer_store_dwordx2 v[36:37], v6, s[28:31], s25 offen offset:512 sc1
    v_mul_f32 v38, 0.5, v67
    v_mul_f32 v39, 0.5, v99
    buffer_store_dwordx2 v[38:39], v6, s[28:31], s25 offen offset:768 sc1
    v_mul_f32 v40, 0.5, v68
    v_mul_f32 v41, 0.5, v100
    buffer_store_dwordx2 v[40:41], v6, s[28:31], s25 offen offset:2048 sc1
    v_mul_f32 v42, 0.5, v69
    v_mul_f32 v43, 0.5, v101
    buffer_store_dwordx2 v[42:43], v6, s[28:31], s25 offen offset:2304 sc1
    v_mul_f32 v44, 0.5, v70
    v_mul_f32 v45, 0.5, v102
    buffer_store_dwordx2 v[44:45], v6, s[28:31], s25 offen offset:2560 sc1
    v_mul_f32 v46, 0.5, v71
    v_mul_f32 v47, 0.5, v103
    buffer_store_dwordx2 v[46:47], v6, s[28:31], s25 offen offset:2816 sc1
    v_mul_f32 v48, 0.5, v72
    v_mul_f32 v49, 0.5, v104
    buffer_store_dwordx2 v[48:49], v6, s[28:31], s26 offen offset:0 sc1
    v_mul_f32 v50, 0.5, v73
    v_mul_f32 v51, 0.5, v105
    buffer_store_dwordx2 v[50:51], v6, s[28:31], s26 offen offset:256 sc1
    v_mul_f32 v52, 0.5, v74
    v_mul_f32 v53, 0.5, v106
    buffer_store_dwordx2 v[52:53], v6, s[28:31], s26 offen offset:512 sc1
    v_mul_f32 v54, 0.5, v75
    v_mul_f32 v55, 0.5, v107
    buffer_store_dwordx2 v[54:55], v6, s[28:31], s26 offen offset:768 sc1
    v_mul_f32 v56, 0.5, v76
    v_mul_f32 v57, 0.5, v108
    buffer_store_dwordx2 v[56:57], v6, s[28:31], s26 offen offset:2048 sc1
    v_mul_f32 v58, 0.5, v77
    v_mul_f32 v59, 0.5, v109
    buffer_store_dwordx2 v[58:59], v6, s[28:31], s26 offen offset:2304 sc1
    v_mul_f32 v60, 0.5, v78
    v_mul_f32 v61, 0.5, v110
    buffer_store_dwordx2 v[60:61], v6, s[28:31], s26 offen offset:2560 sc1
    v_mul_f32 v62, 0.5, v79
    v_mul_f32 v63, 0.5, v111
    buffer_store_dwordx2 v[62:63], v6, s[28:31], s26 offen offset:2816 sc1
    s_mov_b32 s24, 0x3050000
    s_branch G2_R
COL_Lx:
    s_lshr_b32 s14, s54, 2
    s_bfe_u32 s13, s54, 0x10001
    s_lshl_b32 s13, s13, 3
    s_add_u32 s13, s13, s55
    s_mov_b32 s32, s6
    s_and_b32 s33, s7, 0xffff
    s_mov_b32 s34, 0xe00000
    s_mov_b32 s35, 0x20000
    s_mul_i32 s20, s14, 7340032
    s_lshl_b32 s17, s13, 8
    s_add_u32 s20, s20, s17
    s_mul_i32 s21, s57, 917504
    s_mul_i32 s17, s14, 458752
    s_add_u32 s21, s21, s17
    s_add_u32 s21, s21, 0x1000000
    v_lshrrev_b32 v24, 4, v1
    v_lshlrev_b32 v25, 2, v24
    v_xor_b32 v25, v25, v1
    v_and_b32 v25, 15, v25
    v_lshlrev_b32 v25, 4, v25
    s_lshr_b32 s40, s42, 12
    s_mul_i32 s41, s40, 65536
    s_add_u32 s41, s41, s20
    v_mul_u32_u24 v24, 4096, v24
    v_add3_u32 v240, v24, v25, s41
    v_xor_b32 v25, 32, v25
    v_add3_u32 v25, v24, v25, s41
    v_add_u32 v241, 0x3c00, v240
    v_add_u32 v242, 0x7800, v25
    v_add_u32 v243, 0xb400, v25
    s_add_u32 s41, s42, s21
    v_lshlrev_b32 v244, 4, v1
    v_add_u32 v244, s41, v244
    s_cmp_lg_u32 s59, 0
    s_cbranch_scc1 G2b_phi0
    s_mov_b32 s46, 0x3020100
    s_mov_b32 s47, 0x6050804
    s_mov_b32 s48, 0x100c0907
    s_mov_b32 s49, 0xe0d0b0a
    s_mov_b32 s50, 0x1814110f
    s_mov_b32 s51, 0x16151312
    s_mov_b32 s52, 0x1b1a1917
G2b_phi0:
    s_cmp_lg_u32 s59, 1
    s_cbranch_scc1 G2b_phi1
    s_mov_b32 s46, 0x3020100
    s_mov_b32 s47, 0x6040905
    s_mov_b32 s48, 0xd0a0807
    s_mov_b32 s49, 0xe0c0b11
    s_mov_b32 s50, 0x1512100f
    s_mov_b32 s51, 0x16141319
    s_mov_b32 s52, 0x1b1a1817
G2b_phi1:
    s_cmp_lg_u32 s59, 2
    s_cbranch_scc1 G2b_phi2
    s_mov_b32 s46, 0x3020100
    s_mov_b32 s47, 0x5040a06
    s_mov_b32 s48, 0xb090807
    s_mov_b32 s49, 0xd0c120e
    s_mov_b32 s50, 0x1311100f
    s_mov_b32 s51, 0x15141a16
    s_mov_b32 s52, 0x1b191817
G2b_phi2:
    s_cmp_lg_u32 s59, 3
    s_cbranch_scc1 G2b_phi3
    s_mov_b32 s46, 0x3020100
    s_mov_b32 s47, 0x50b0704
    s_mov_b32 s48, 0xa090806
    s_mov_b32 s49, 0xd130f0c
    s_mov_b32 s50, 0x1211100e
    s_mov_b32 s51, 0x151b1714
    s_mov_b32 s52, 0x1a191816
G2b_phi3:
    s_cmp_lg_u32 s59, 4
    s_cbranch_scc1 G2b_phi4
    s_mov_b32 s46, 0x3020100
    s_mov_b32 s47, 0xc080504
    s_mov_b32 s48, 0xa090706
    s_mov_b32 s49, 0x14100d0b
    s_mov_b32 s50, 0x12110f0e
    s_mov_b32 s51, 0x16181513
    s_mov_b32 s52, 0x1b1a1917
G2b_phi4:
    s_cmp_lg_u32 s59, 5
    s_cbranch_scc1 G2b_phi5
    s_mov_b32 s46, 0x3020100
    s_mov_b32 s47, 0x9060405
    s_mov_b32 s48, 0xa08070d
    s_mov_b32 s49, 0x110e0c0b
    s_mov_b32 s50, 0x12100f15
    s_mov_b32 s51, 0x19161413
    s_mov_b32 s52, 0x1b1a1817
G2b_phi5:
    s_cmp_lg_u32 s59, 6
    s_cbranch_scc1 G2b_phi6
    s_mov_b32 s46, 0x3020100
    s_mov_b32 s47, 0x7050406
    s_mov_b32 s48, 0x9080e0a
    s_mov_b32 s49, 0xf0d0c0b
    s_mov_b32 s50, 0x11101612
    s_mov_b32 s51, 0x17151413
    s_mov_b32 s52, 0x1b19181a
G2b_phi6:
    s_cmp_lg_u32 s59, 7
    s_cbranch_scc1 G2b_phi7
    s_mov_b32 s46, 0x3020100
    s_mov_b32 s47, 0x6050407
    s_mov_b32 s48, 0x90f0b08
    s_mov_b32 s49, 0xe0d0c0a
    s_mov_b32 s50, 0x11171310
    s_mov_b32 s51, 0x16151412
    s_mov_b32 s52, 0x1a191b18
G2b_phi7:
    s_bfe_u32 s17, s54, 0x10001
    s_mul_i32 s17, s17, 7
    s_add_u32 s17, s17, s55
    s_mul_i32 s17, s17, 0x02020202
    s_add_u32 s46, s46, s17
    s_add_u32 s20, s46, 0x64646464
    s_and_b32 s20, s20, 0x80808080
    s_lshr_b32 s20, s20, 7
    s_mul_i32 s20, s20, 28
    s_sub_u32 s46, s46, s20
    s_add_u32 s47, s47, s17
    s_add_u32 s20, s47, 0x64646464
    s_and_b32 s20, s20, 0x80808080
    s_lshr_b32 s20, s20, 7
    s_mul_i32 s20, s20, 28
    s_sub_u32 s47, s47, s20
    s_add_u32 s48, s48, s17
    s_add_u32 s20, s48, 0x64646464
    s_and_b32 s20, s20, 0x80808080
    s_lshr_b32 s20, s20, 7
    s_mul_i32 s20, s20, 28
    s_sub_u32 s48, s48, s20
    s_add_u32 s49, s49, s17
    s_add_u32 s20, s49, 0x64646464
    s_and_b32 s20, s20, 0x80808080
    s_lshr_b32 s20, s20, 7
    s_mul_i32 s20, s20, 28
    s_sub_u32 s49, s49, s20
    s_add_u32 s50, s50, s17
    s_add_u32 s20, s50, 0x64646464
    s_and_b32 s20, s20, 0x80808080
    s_lshr_b32 s20, s20, 7
    s_mul_i32 s20, s20, 28
    s_sub_u32 s50, s50, s20
    s_add_u32 s51, s51, s17
    s_add_u32 s20, s51, 0x64646464
    s_and_b32 s20, s20, 0x80808080
    s_lshr_b32 s20, s20, 7
    s_mul_i32 s20, s20, 28
    s_sub_u32 s51, s51, s20
    s_add_u32 s52, s52, s17
    s_add_u32 s20, s52, 0x64646464
    s_and_b32 s20, s20, 0x80808080
    s_lshr_b32 s20, s20, 7
    s_mul_i32 s20, s20, 28
    s_sub_u32 s52, s52, s20
    s_mov_b32 s23, 3200000
COL_s6:
    ds_read_b32 v15, v13 offset:20
    s_sub_u32 s23, s23, 1
    s_cbranch_scc1 COL_s6_out
    s_waitcnt lgkmcnt(0)
    v_cmp_ne_u32 vcc, 4, v15
    s_cbranch_vccnz COL_s6
COL_s6_out:
    s_bfe_u32 s43, s46, 0x80000
    s_lshl_b32 s43, s43, 18
    s_add_u32 m0, s42, 0
    s_nop 0
    buffer_load_dwordx4 v240, s[32:35], s43 offen offset:0  lds
    buffer_load_dwordx4 v241, s[32:35], s43 offen offset:1024  lds
    buffer_load_dwordx4 v242, s[32:35], s43 offen offset:2048  lds
    buffer_load_dwordx4 v243, s[32:35], s43 offen offset:3072  lds
    s_bfe_u32 s43, s46, 0x80008
    s_lshl_b32 s43, s43, 18
    s_add_u32 m0, s42, 16384
    s_nop 0
    buffer_load_dwordx4 v240, s[32:35], s43 offen offset:0  lds
    buffer_load_dwordx4 v241, s[32:35], s43 offen offset:1024  lds
    buffer_load_dwordx4 v242, s[32:35], s43 offen offset:2048  lds
    buffer_load_dwordx4 v243, s[32:35], s43 offen offset:3072  lds
    s_bfe_u32 s43, s46, 0x80010
    s_lshl_b32 s43, s43, 18
    s_add_u32 m0, s42, 32768
    s_nop 0
    buffer_load_dwordx4 v240, s[32:35], s43 offen offset:0  lds
    buffer_load_dwordx4 v241, s[32:35], s43 offen offset:1024  lds
    buffer_load_dwordx4 v242, s[32:35], s43 offen offset:2048  lds
    buffer_load_dwordx4 v243, s[32:35], s43 offen offset:3072  lds
    s_waitcnt vmcnt(12)
    s_mov_b64 exec, 1
    ds_add_rtn_u32 v24, v13, v14 offset:28
    s_waitcnt lgkmcnt(0)
    v_cmp_ne_u32 vcc, 7, v24
    s_mov_b64 exec, -1
    s_cbranch_vccnz COL_fl_na
    s_lshl_b32 s22, s2, 2
    s_add_u32 s22, s22, 0x3007c80
    v_lshlrev_b32 v25, 7, v1
    s_mov_b64 exec, 0xff
    v_mov_b32 v24, s3
    buffer_store_dword v24, v25, s[28:31], s22 offen sc1
    s_mov_b64 exec, -1
COL_fl_na:
    s_add_u32 s18, s42, 131072
    v_lshl_add_u32 v25, v1, 4, s18
    ds_read_b128 v[72:75], v25 offset:0
    ds_read_b128 v[76:79], v25 offset:1024
    ds_read_b128 v[80:83], v25 offset:2048
    ds_read_b128 v[84:87], v25 offset:3072
    s_waitcnt lgkmcnt(0)
    v_mov_b32 v12, 155648
    v_mov_b32 v13, 1
    s_branch G2_L
END:
    s_endpgm
.text
.p2align 8
.type fft_tables,@object
fft_tables:
.long 0x3f803f80,0x3f803f80,0x3f803f80,0x3f803f80,0x3f7b3f80,0x3f553f6d,0x3f0e3f35,0x3e483ec4
.long 0x3f6d3f80,0x3ec43f35,0xbec40000,0xbf6dbf35,0x3f553f80,0xbe483ec4,0xbf7bbf35,0xbf0ebf6d
.long 0x3f353f80,0xbf350000,0xbf35bf80,0x3f350000,0x3f0e3f80,0xbf7bbec4,0x3e48bf35,0x3f553f6d
.long 0x3ec43f80,0xbf6dbf35,0x3f6d0000,0xbec43f35,0x3e483f80,0xbf0ebf6d,0x3f553f35,0xbf7bbec4
.long 0x3f80,0xbf80,0x3f80,0xbf80,0xbe483f80,0x3f0ebf6d,0xbf553f35,0x3f7bbec4
.long 0xbec43f80,0x3f6dbf35,0xbf6d0000,0x3ec43f35,0xbf0e3f80,0x3f7bbec4,0xbe48bf35,0xbf553f6d
.long 0xbf353f80,0x3f350000,0x3f35bf80,0xbf350000,0xbf553f80,0x3e483ec4,0x3f7bbf35,0x3f0ebf6d
.long 0xbf6d3f80,0xbec43f35,0x3ec40000,0x3f6dbf35,0xbf7b3f80,0xbf553f6d,0xbf0e3f35,0xbe483ec4
.long 0xbf803f80,0xbf803f80,0xbf803f80,0xbf803f80,0xbf7b3f80,0xbf553f6d,0xbf0e3f35,0xbe483ec4
.long 0xbf6d3f80,0xbec43f35,0x3ec40000,0x3f6dbf35,0xbf553f80,0x3e483ec4,0x3f7bbf35,0x3f0ebf6d
.long 0xbf353f80,0x3f350000,0x3f35bf80,0xbf350000,0xbf0e3f80,0x3f7bbec4,0xbe48bf35,0xbf553f6d
.long 0xbec43f80,0x3f6dbf35,0xbf6d0000,0x3ec43f35,0xbe483f80,0x3f0ebf6d,0xbf553f35,0x3f7bbec4
.long 0x3f80,0xbf80,0x3f80,0xbf80,0x3e483f80,0xbf0ebf6d,0x3f553f35,0xbf7bbec4
.long 0x3ec43f80,0xbf6dbf35,0x3f6d0000,0xbec43f35,0x3f0e3f80,0xbf7bbec4,0x3e48bf35,0x3f553f6d
.long 0x3f353f80,0xbf350000,0xbf35bf80,0x3f350000,0x3f553f80,0xbe483ec4,0xbf7bbf35,0xbf0ebf6d
.long 0x3f6d3f80,0x3ec43f35,0xbec40000,0xbf6dbf35,0x3f7b3f80,0x3f553f6d,0x3f0e3f35,0x3e483ec4
.long 0x3f803f80,0x3f803f80,0x3f803f80,0x3f803f80,0xbe480000,0xbf0ebec4,0xbf55bf35,0xbf7bbf6d
.long 0xbf6dbf80,0xbec4bf35,0x3ec40000,0x3f6d3f35,0x3f0e0000,0x3f7b3f6d,0x3e483f35,0xbf55bec4
.long 0x3f353f80,0xbf350000,0xbf35bf80,0x3f350000,0xbf550000,0xbe48bf6d,0x3f7b3f35,0xbf0e3ec4
.long 0xbec4bf80,0x3f6d3f35,0xbf6d0000,0x3ec4bf35,0x3f7b0000,0xbf553ec4,0x3f0ebf35,0xbe483f6d
.long 0x3f80,0xbf80,0x3f80,0xbf80,0xbf7b0000,0x3f553ec4,0xbf0ebf35,0x3e483f6d
.long 0x3ec4bf80,0xbf6d3f35,0x3f6d0000,0xbec4bf35,0x3f550000,0x3e48bf6d,0xbf7b3f35,0x3f0e3ec4
.long 0xbf353f80,0x3f350000,0x3f35bf80,0xbf350000,0xbf0e0000,0xbf7b3f6d,0xbe483f35,0x3f55bec4
.long 0x3f6dbf80,0x3ec4bf35,0xbec40000,0xbf6d3f35,0x3e480000,0x3f0ebec4,0x3f55bf35,0x3f7bbf6d
.long 0xbf803f80,0xbf803f80,0xbf803f80,0xbf803f80,0x3e480000,0x3f0ebec4,0x3f55bf35,0x3f7bbf6d
.long 0x3f6dbf80,0x3ec4bf35,0xbec40000,0xbf6d3f35,0xbf0e0000,0xbf7b3f6d,0xbe483f35,0x3f55bec4
.long 0xbf353f80,0x3f350000,0x3f35bf80,0xbf350000,0x3f550000,0x3e48bf6d,0xbf7b3f35,0x3f0e3ec4
.long 0x3ec4bf80,0xbf6d3f35,0x3f6d0000,0xbec4bf35,0xbf7b0000,0x3f553ec4,0xbf0ebf35,0x3e483f6d
.long 0x3f80,0xbf80,0x3f80,0xbf80,0x3f7b0000,0xbf553ec4,0x3f0ebf35,0xbe483f6d
.long 0xbec4bf80,0x3f6d3f35,0xbf6d0000,0x3ec4bf35,0xbf550000,0xbe48bf6d,0x3f7b3f35,0xbf0e3ec4
.long 0x3f353f80,0xbf350000,0xbf35bf80,0x3f350000,0x3f0e0000,0x3f7b3f6d,0x3e483f35,0xbf55bec4
.long 0xbf6dbf80,0xbec4bf35,0x3ec40000,0x3f6d3f35,0xbe480000,0xbf0ebec4,0xbf55bf35,0xbf7bbf6d
.long 0x3f803f80,0x3f803f80,0x3f803f80,0x3f803f80,0xbf7bbf80,0xbf55bf6d,0xbf0ebf35,0xbe48bec4
.long 0x3f6d3f80,0x3ec43f35,0xbec40000,0xbf6dbf35,0xbf55bf80,0x3e48bec4,0x3f7b3f35,0x3f0e3f6d
.long 0x3f353f80,0xbf350000,0xbf35bf80,0x3f350000,0xbf0ebf80,0x3f7b3ec4,0xbe483f35,0xbf55bf6d
.long 0x3ec43f80,0xbf6dbf35,0x3f6d0000,0xbec43f35,0xbe48bf80,0x3f0e3f6d,0xbf55bf35,0x3f7b3ec4
.long 0x3f80,0xbf80,0x3f80,0xbf80,0x3e48bf80,0xbf0e3f6d,0x3f55bf35,0xbf7b3ec4
.long 0xbec43f80,0x3f6dbf35,0xbf6d0000,0x3ec43f35,0x3f0ebf80,0xbf7b3ec4,0x3e483f35,0x3f55bf6d
.long 0xbf353f80,0x3f350000,0x3f35bf80,0xbf350000,0x3f55bf80,0xbe48bec4,0xbf7b3f35,0xbf0e3f6d
.long 0xbf6d3f80,0xbec43f35,0x3ec40000,0x3f6dbf35,0x3f7bbf80,0x3f55bf6d,0x3f0ebf35,0x3e48bec4
.long 0xbf803f80,0xbf803f80,0xbf803f80,0xbf803f80,0x3f7bbf80,0x3f55bf6d,0x3f0ebf35,0x3e48bec4
.long 0xbf6d3f80,0xbec43f35,0x3ec40000,0x3f6dbf35,0x3f55bf80,0xbe48bec4,0xbf7b3f35,0xbf0e3f6d
.long 0xbf353f80,0x3f350000,0x3f35bf80,0xbf350000,0x3f0ebf80,0xbf7b3ec4,0x3e483f35,0x3f55bf6d
.long 0xbec43f80,0x3f6dbf35,0xbf6d0000,0x3ec43f35,0x3e48bf80,0xbf0e3f6d,0x3f55bf35,0xbf7b3ec4
.long 0x3f80,0xbf80,0x3f80,0xbf80,0xbe48bf80,0x3f0e3f6d,0xbf55bf35,0x3f7b3ec4
.long 0x3ec43f80,0xbf6dbf35,0x3f6d0000,0xbec43f35,0xbf0ebf80,0x3f7b3ec4,0xbe483f35,0xbf55bf6d
.long 0x3f353f80,0xbf350000,0xbf35bf80,0x3f350000,0xbf55bf80,0x3e48bec4,0x3f7b3f35,0x3f0e3f6d
.long 0x3f6d3f80,0x3ec43f35,0xbec40000,0xbf6dbf35,0xbf7bbf80,0xbf55bf6d,0xbf0ebf35,0xbe48bec4
.long 0x3f803f80,0x3f803f80,0x3f803f80,0x3f803f80,0x3e480000,0x3f0e3ec4,0x3f553f35,0x3f7b3f6d
.long 0xbf6dbf80,0xbec4bf35,0x3ec40000,0x3f6d3f35,0xbf0e0000,0xbf7bbf6d,0xbe48bf35,0x3f553ec4
.long 0x3f353f80,0xbf350000,0xbf35bf80,0x3f350000,0x3f550000,0x3e483f6d,0xbf7bbf35,0x3f0ebec4
.long 0xbec4bf80,0x3f6d3f35,0xbf6d0000,0x3ec4bf35,0xbf7b0000,0x3f55bec4,0xbf0e3f35,0x3e48bf6d
.long 0x3f80,0xbf80,0x3f80,0xbf80,0x3f7b0000,0xbf55bec4,0x3f0e3f35,0xbe48bf6d
.long 0x3ec4bf80,0xbf6d3f35,0x3f6d0000,0xbec4bf35,0xbf550000,0xbe483f6d,0x3f7bbf35,0xbf0ebec4
.long 0xbf353f80,0x3f350000,0x3f35bf80,0xbf350000,0x3f0e0000,0x3f7bbf6d,0x3e48bf35,0xbf553ec4
.long 0x3f6dbf80,0x3ec4bf35,0xbec40000,0xbf6d3f35,0xbe480000,0xbf0e3ec4,0xbf553f35,0xbf7b3f6d
.long 0xbf803f80,0xbf803f80,0xbf803f80,0xbf803f80,0xbe480000,0xbf0e3ec4,0xbf553f35,0xbf7b3f6d
.long 0x3f6dbf80,0x3ec4bf35,0xbec40000,0xbf6d3f35,0x3f0e0000,0x3f7bbf6d,0x3e48bf35,0xbf553ec4
.long 0xbf353f80,0x3f350000,0x3f35bf80,0xbf350000,0xbf550000,0xbe483f6d,0x3f7bbf35,0xbf0ebec4
.long 0x3ec4bf80,0xbf6d3f35,0x3f6d0000,0xbec4bf35,0x3f7b0000,0xbf55bec4,0x3f0e3f35,0xbe48bf6d
.long 0x3f80,0xbf80,0x3f80,0xbf80,0xbf7b0000,0x3f55bec4,0xbf0e3f35,0x3e48bf6d
.long 0xbec4bf80,0x3f6d3f35,0xbf6d0000,0x3ec4bf35,0x3f550000,0x3e483f6d,0xbf7bbf35,0x3f0ebec4
.long 0x3f353f80,0xbf350000,0xbf35bf80,0x3f350000,0xbf0e0000,0xbf7bbf6d,0xbe48bf35,0x3f553ec4
.long 0xbf6dbf80,0xbec4bf35,0x3ec40000,0x3f6d3f35,0x3e480000,0x3f0e3ec4,0x3f553f35,0x3f7b3f6d
.long 0x80008000,0x80008000,0x80008000,0x80008000,0xbe488000,0xbf0ebec4,0xbf55bf35,0xbf7bbf6d
.long 0xbec48000,0xbf6dbf35,0xbf6dbf80,0xbec4bf35,0xbf0e8000,0xbf7bbf6d,0xbe48bf35,0x3f553ec4
.long 0xbf358000,0xbf35bf80,0x3f358000,0x3f353f80,0xbf558000,0xbe48bf6d,0x3f7b3f35,0xbf0e3ec4
.long 0xbf6d8000,0x3ec4bf35,0x3ec43f80,0xbf6dbf35,0xbf7b8000,0x3f55bec4,0xbf0e3f35,0x3e48bf6d
.long 0xbf808000,0x3f808000,0xbf808000,0x3f808000,0xbf7b8000,0x3f553ec4,0xbf0ebf35,0x3e483f6d
.long 0xbf6d8000,0x3ec43f35,0x3ec4bf80,0xbf6d3f35,0xbf558000,0xbe483f6d,0x3f7bbf35,0xbf0ebec4
.long 0xbf358000,0xbf353f80,0x3f358000,0x3f35bf80,0xbf0e8000,0xbf7b3f6d,0xbe483f35,0x3f55bec4
.long 0xbec48000,0xbf6d3f35,0xbf6d3f80,0xbec43f35,0xbe488000,0xbf0e3ec4,0xbf553f35,0xbf7b3f6d
.long 0x80008000,0x80008000,0x80008000,0x80008000,0x3e488000,0x3f0ebec4,0x3f55bf35,0x3f7bbf6d
.long 0x3ec48000,0x3f6dbf35,0x3f6dbf80,0x3ec4bf35,0x3f0e8000,0x3f7bbf6d,0x3e48bf35,0xbf553ec4
.long 0x3f358000,0x3f35bf80,0xbf358000,0xbf353f80,0x3f558000,0x3e48bf6d,0xbf7b3f35,0x3f0e3ec4
.long 0x3f6d8000,0xbec4bf35,0xbec43f80,0x3f6dbf35,0x3f7b8000,0xbf55bec4,0x3f0e3f35,0xbe48bf6d
.long 0x3f808000,0xbf808000,0x3f808000,0xbf808000,0x3f7b8000,0xbf553ec4,0x3f0ebf35,0xbe483f6d
.long 0x3f6d8000,0xbec43f35,0xbec4bf80,0x3f6d3f35,0x3f558000,0x3e483f6d,0xbf7bbf35,0x3f0ebec4
.long 0x3f358000,0x3f353f80,0xbf358000,0xbf35bf80,0x3f0e8000,0x3f7b3f6d,0x3e483f35,0xbf55bec4
.long 0x3ec48000,0x3f6d3f35,0x3f6d3f80,0x3ec43f35,0x3e488000,0x3f0e3ec4,0x3f553f35,0x3f7b3f6d
.long 0x80008000,0x80008000,0x80008000,0x80008000,0xbf7bbf80,0xbf55bf6d,0xbf0ebf35,0xbe48bec4
.long 0x3ec48000,0x3f6d3f35,0x3f6d3f80,0x3ec43f35,0x3f553f80,0xbe483ec4,0xbf7bbf35,0xbf0ebf6d
.long 0xbf358000,0xbf35bf80,0x3f358000,0x3f353f80,0xbf0ebf80,0x3f7b3ec4,0xbe483f35,0xbf55bf6d
.long 0x3f6d8000,0xbec43f35,0xbec4bf80,0x3f6d3f35,0x3e483f80,0xbf0ebf6d,0x3f553f35,0xbf7bbec4
.long 0xbf808000,0x3f808000,0xbf808000,0x3f808000,0x3e48bf80,0xbf0e3f6d,0x3f55bf35,0xbf7b3ec4
.long 0x3f6d8000,0xbec4bf35,0xbec43f80,0x3f6dbf35,0xbf0e3f80,0x3f7bbec4,0xbe48bf35,0xbf553f6d
.long 0xbf358000,0xbf353f80,0x3f358000,0x3f35bf80,0x3f55bf80,0xbe48bec4,0xbf7b3f35,0xbf0e3f6d
.long 0x3ec48000,0x3f6dbf35,0x3f6dbf80,0x3ec4bf35,0xbf7b3f80,0xbf553f6d,0xbf0e3f35,0xbe483ec4
.long 0x80008000,0x80008000,0x80008000,0x80008000,0x3f7bbf80,0x3f55bf6d,0x3f0ebf35,0x3e48bec4
.long 0xbec48000,0xbf6d3f35,0xbf6d3f80,0xbec43f35,0xbf553f80,0x3e483ec4,0x3f7bbf35,0x3f0ebf6d
.long 0x3f358000,0x3f35bf80,0xbf358000,0xbf353f80,0x3f0ebf80,0xbf7b3ec4,0x3e483f35,0x3f55bf6d
.long 0xbf6d8000,0x3ec43f35,0x3ec4bf80,0xbf6d3f35,0xbe483f80,0x3f0ebf6d,0xbf553f35,0x3f7bbec4
.long 0x3f808000,0xbf808000,0x3f808000,0xbf808000,0xbe48bf80,0x3f0e3f6d,0xbf55bf35,0x3f7b3ec4
.long 0xbf6d8000,0x3ec4bf35,0x3ec43f80,0xbf6dbf35,0x3f0e3f80,0xbf7bbec4,0x3e48bf35,0x3f553f6d
.long 0x3f358000,0x3f353f80,0xbf358000,0xbf35bf80,0xbf55bf80,0x3e48bec4,0x3f7b3f35,0x3f0e3f6d
.long 0xbec48000,0xbf6dbf35,0xbf6dbf80,0xbec4bf35,0x3f7b3f80,0x3f553f6d,0x3f0e3f35,0x3e483ec4
.long 0x80008000,0x80008000,0x80008000,0x80008000,0x3e488000,0x3f0e3ec4,0x3f553f35,0x3f7b3f6d
.long 0xbec48000,0xbf6dbf35,0xbf6dbf80,0xbec4bf35,0x3f0e8000,0x3f7b3f6d,0x3e483f35,0xbf55bec4
.long 0xbf358000,0xbf35bf80,0x3f358000,0x3f353f80,0x3f558000,0x3e483f6d,0xbf7bbf35,0x3f0ebec4
.long 0xbf6d8000,0x3ec4bf35,0x3ec43f80,0xbf6dbf35,0x3f7b8000,0xbf553ec4,0x3f0ebf35,0xbe483f6d
.long 0xbf808000,0x3f808000,0xbf808000,0x3f808000,0x3f7b8000,0xbf55bec4,0x3f0e3f35,0xbe48bf6d
.long 0xbf6d8000,0x3ec43f35,0x3ec4bf80,0xbf6d3f35,0x3f558000,0x3e48bf6d,0xbf7b3f35,0x3f0e3ec4
.long 0xbf358000,0xbf353f80,0x3f358000,0x3f35bf80,0x3f0e8000,0x3f7bbf6d,0x3e48bf35,0xbf553ec4
.long 0xbec48000,0xbf6d3f35,0xbf6d3f80,0xbec43f35,0x3e488000,0x3f0ebec4,0x3f55bf35,0x3f7bbf6d
.long 0x80008000,0x80008000,0x80008000,0x80008000,0xbe488000,0xbf0e3ec4,0xbf553f35,0xbf7b3f6d
.long 0x3ec48000,0x3f6dbf35,0x3f6dbf80,0x3ec4bf35,0xbf0e8000,0xbf7b3f6d,0xbe483f35,0x3f55bec4
.long 0x3f358000,0x3f35bf80,0xbf358000,0xbf353f80,0xbf558000,0xbe483f6d,0x3f7bbf35,0xbf0ebec4
.long 0x3f6d8000,0xbec4bf35,0xbec43f80,0x3f6dbf35,0xbf7b8000,0x3f553ec4,0xbf0ebf35,0x3e483f6d
.long 0x3f808000,0xbf808000,0x3f808000,0xbf808000,0xbf7b8000,0x3f55bec4,0xbf0e3f35,0x3e48bf6d
.long 0x3f6d8000,0xbec43f35,0xbec4bf80,0x3f6d3f35,0xbf558000,0xbe48bf6d,0x3f7b3f35,0xbf0e3ec4
.long 0x3f358000,0x3f353f80,0xbf358000,0xbf35bf80,0xbf0e8000,0xbf7bbf6d,0xbe48bf35,0x3f553ec4
.long 0x3ec48000,0x3f6d3f35,0x3f6d3f80,0x3ec43f35,0xbe488000,0xbf0ebec4,0xbf55bf35,0xbf7bbf6d
.long 0x80008000,0x80008000,0x80008000,0x80008000,0x3f7b3f80,0x3f553f6d,0x3f0e3f35,0x3e483ec4
.long 0x3ec48000,0x3f6d3f35,0x3f6d3f80,0x3ec43f35,0xbf55bf80,0x3e48bec4,0x3f7b3f35,0x3f0e3f6d
.long 0xbf358000,0xbf35bf80,0x3f358000,0x3f353f80,0x3f0e3f80,0xbf7bbec4,0x3e48bf35,0x3f553f6d
.long 0x3f6d8000,0xbec43f35,0xbec4bf80,0x3f6d3f35,0xbe48bf80,0x3f0e3f6d,0xbf55bf35,0x3f7b3ec4
.long 0xbf808000,0x3f808000,0xbf808000,0x3f808000,0xbe483f80,0x3f0ebf6d,0xbf553f35,0x3f7bbec4
.long 0x3f6d8000,0xbec4bf35,0xbec43f80,0x3f6dbf35,0x3f0ebf80,0xbf7b3ec4,0x3e483f35,0x3f55bf6d
.long 0xbf358000,0xbf353f80,0x3f358000,0x3f35bf80,0xbf553f80,0x3e483ec4,0x3f7bbf35,0x3f0ebf6d
.long 0x3ec48000,0x3f6dbf35,0x3f6dbf80,0x3ec4bf35,0x3f7bbf80,0x3f55bf6d,0x3f0ebf35,0x3e48bec4
.long 0x80008000,0x80008000,0x80008000,0x80008000,0xbf7b3f80,0xbf553f6d,0xbf0e3f35,0xbe483ec4
.long 0xbec48000,0xbf6d3f35,0xbf6d3f80,0xbec43f35,0x3f55bf80,0xbe48bec4,0xbf7b3f35,0xbf0e3f6d
.long 0x3f358000,0x3f35bf80,0xbf358000,0xbf353f80,0xbf0e3f80,0x3f7bbec4,0xbe48bf35,0xbf553f6d
.long 0xbf6d8000,0x3ec43f35,0x3ec4bf80,0xbf6d3f35,0x3e48bf80,0xbf0e3f6d,0x3f55bf35,0xbf7b3ec4
.long 0x3f808000,0xbf808000,0x3f808000,0xbf808000,0x3e483f80,0xbf0ebf6d,0x3f553f35,0xbf7bbec4
.long 0xbf6d8000,0x3ec4bf35,0x3ec43f80,0xbf6dbf35,0xbf0ebf80,0x3f7b3ec4,0xbe483f35,0xbf55bf6d
.long 0x3f358000,0x3f353f80,0xbf358000,0xbf35bf80,0x3f553f80,0xbe483ec4,0xbf7bbf35,0xbf0ebf6d
.long 0xbec48000,0xbf6dbf35,0xbf6dbf80,0xbec4bf35,0xbf7bbf80,0xbf55bf6d,0xbf0ebf35,0xbe48bec4
.long 0x3f803f80,0x3f803f80,0x0,0x0,0x3f7b3f80,0x3f553f6d,0x3e480000,0x3f0e3ec4
.long 0x3f6d3f80,0x3ec43f35,0x3ec40000,0x3f6d3f35,0x3f553f80,0xbe483ec4,0x3f0e0000,0x3f7b3f6d
.long 0x3f353f80,0xbf350000,0x3f350000,0x3f353f80,0x3f0e3f80,0xbf7bbec4,0x3f550000,0x3e483f6d
.long 0x3ec43f80,0xbf6dbf35,0x3f6d0000,0xbec43f35,0x3e483f80,0xbf0ebf6d,0x3f7b0000,0xbf553ec4
.long 0x3f80,0xbf80,0x3f800000,0xbf800000,0xbe483f80,0x3f0ebf6d,0x3f7b0000,0xbf55bec4
.long 0xbec43f80,0x3f6dbf35,0x3f6d0000,0xbec4bf35,0xbf0e3f80,0x3f7bbec4,0x3f550000,0x3e48bf6d
.long 0xbf353f80,0x3f350000,0x3f350000,0x3f35bf80,0xbf553f80,0x3e483ec4,0x3f0e0000,0x3f7bbf6d
.long 0xbf6d3f80,0xbec43f35,0x3ec40000,0x3f6dbf35,0xbf7b3f80,0xbf553f6d,0x3e480000,0x3f0ebec4
.long 0x0,0x0,0x3f803f80,0x3f803f80,0xbe480000,0xbf0ebec4,0x3f7b3f80,0x3f553f6d
.long 0xbec40000,0xbf6dbf35,0x3f6d3f80,0x3ec43f35,0xbf0e0000,0xbf7bbf6d,0x3f553f80,0xbe483ec4
.long 0xbf350000,0xbf35bf80,0x3f353f80,0xbf350000,0xbf550000,0xbe48bf6d,0x3f0e3f80,0xbf7bbec4
.long 0xbf6d0000,0x3ec4bf35,0x3ec43f80,0xbf6dbf35,0xbf7b0000,0x3f55bec4,0x3e483f80,0xbf0ebf6d
.long 0xbf800000,0x3f800000,0x3f80,0xbf80,0xbf7b0000,0x3f553ec4,0xbe483f80,0x3f0ebf6d
.long 0xbf6d0000,0x3ec43f35,0xbec43f80,0x3f6dbf35,0xbf550000,0xbe483f6d,0xbf0e3f80,0x3f7bbec4
.long 0xbf350000,0xbf353f80,0xbf353f80,0x3f350000,0xbf0e0000,0xbf7b3f6d,0xbf553f80,0x3e483ec4
.long 0xbec40000,0xbf6d3f35,0xbf6d3f80,0xbec43f35,0xbe480000,0xbf0e3ec4,0xbf7b3f80,0xbf553f6d
.long 0x3f803f80,0x3f803f80,0x0,0x0,0x3f0e3f35,0x3e483ec4,0x3f553f35,0x3f7b3f6d
.long 0xbec40000,0xbf6dbf35,0x3f6d3f80,0x3ec43f35,0xbf7bbf35,0xbf0ebf6d,0x3e483f35,0xbf55bec4
.long 0xbf35bf80,0x3f350000,0xbf350000,0xbf35bf80,0x3e48bf35,0x3f553f6d,0xbf7bbf35,0x3f0ebec4
.long 0x3f6d0000,0xbec43f35,0xbec4bf80,0x3f6d3f35,0x3f553f35,0xbf7bbec4,0x3f0ebf35,0xbe483f6d
.long 0x3f80,0xbf80,0x3f800000,0xbf800000,0xbf553f35,0x3f7bbec4,0x3f0e3f35,0xbe48bf6d
.long 0xbf6d0000,0x3ec43f35,0xbec43f80,0x3f6dbf35,0xbe48bf35,0xbf553f6d,0xbf7b3f35,0x3f0e3ec4
.long 0x3f35bf80,0xbf350000,0xbf350000,0xbf353f80,0x3f7bbf35,0x3f0ebf6d,0x3e48bf35,0xbf553ec4
.long 0x3ec40000,0x3f6dbf35,0x3f6dbf80,0x3ec4bf35,0xbf0e3f35,0xbe483ec4,0x3f55bf35,0x3f7bbf6d
.long 0x0,0x0,0x3f803f80,0x3f803f80,0xbf55bf35,0xbf7bbf6d,0x3f0e3f35,0x3e483ec4
.long 0xbf6dbf80,0xbec4bf35,0xbec40000,0xbf6dbf35,0xbe48bf35,0x3f553ec4,0xbf7bbf35,0xbf0ebf6d
.long 0x3f350000,0x3f353f80,0xbf35bf80,0x3f350000,0x3f7b3f35,0xbf0e3ec4,0x3e48bf35,0x3f553f6d
.long 0x3ec43f80,0xbf6dbf35,0x3f6d0000,0xbec43f35,0xbf0e3f35,0x3e48bf6d,0x3f553f35,0xbf7bbec4
.long 0xbf800000,0x3f800000,0x3f80,0xbf80,0xbf0ebf35,0x3e483f6d,0xbf553f35,0x3f7bbec4
.long 0x3ec4bf80,0xbf6d3f35,0xbf6d0000,0x3ec43f35,0x3f7bbf35,0xbf0ebec4,0xbe48bf35,0xbf553f6d
.long 0x3f350000,0x3f35bf80,0x3f35bf80,0xbf350000,0xbe483f35,0x3f55bec4,0x3f7bbf35,0x3f0ebf6d
.long 0xbf6d3f80,0xbec43f35,0x3ec40000,0x3f6dbf35,0xbf553f35,0xbf7b3f6d,0xbf0e3f35,0xbe483ec4
.long 0x3f803f80,0x3f803f80,0x0,0x0,0xbe480000,0xbf0ebec4,0x3f7b3f80,0x3f553f6d
.long 0xbf6dbf80,0xbec4bf35,0xbec40000,0xbf6dbf35,0x3f0e0000,0x3f7b3f6d,0xbf55bf80,0x3e48bec4
.long 0x3f353f80,0xbf350000,0x3f350000,0x3f353f80,0xbf550000,0xbe48bf6d,0x3f0e3f80,0xbf7bbec4
.long 0xbec4bf80,0x3f6d3f35,0xbf6d0000,0x3ec4bf35,0x3f7b0000,0xbf553ec4,0xbe48bf80,0x3f0e3f6d
.long 0x3f80,0xbf80,0x3f800000,0xbf800000,0xbf7b0000,0x3f553ec4,0xbe483f80,0x3f0ebf6d
.long 0x3ec4bf80,0xbf6d3f35,0xbf6d0000,0x3ec43f35,0x3f550000,0x3e48bf6d,0x3f0ebf80,0xbf7b3ec4
.long 0xbf353f80,0x3f350000,0x3f350000,0x3f35bf80,0xbf0e0000,0xbf7b3f6d,0xbf553f80,0x3e483ec4
.long 0x3f6dbf80,0x3ec4bf35,0xbec40000,0xbf6d3f35,0x3e480000,0x3f0ebec4,0x3f7bbf80,0x3f55bf6d
.long 0x0,0x0,0x3f803f80,0x3f803f80,0xbf7bbf80,0xbf55bf6d,0xbe480000,0xbf0ebec4
.long 0x3ec40000,0x3f6d3f35,0xbf6dbf80,0xbec4bf35,0x3f553f80,0xbe483ec4,0x3f0e0000,0x3f7b3f6d
.long 0xbf350000,0xbf35bf80,0x3f353f80,0xbf350000,0xbf0ebf80,0x3f7b3ec4,0xbf550000,0xbe48bf6d
.long 0x3f6d0000,0xbec43f35,0xbec4bf80,0x3f6d3f35,0x3e483f80,0xbf0ebf6d,0x3f7b0000,0xbf553ec4
.long 0xbf800000,0x3f800000,0x3f80,0xbf80,0x3e48bf80,0xbf0e3f6d,0xbf7b0000,0x3f553ec4
.long 0x3f6d0000,0xbec4bf35,0x3ec4bf80,0xbf6d3f35,0xbf0e3f80,0x3f7bbec4,0x3f550000,0x3e48bf6d
.long 0xbf350000,0xbf353f80,0xbf353f80,0x3f350000,0x3f55bf80,0xbe48bec4,0xbf0e0000,0xbf7b3f6d
.long 0x3ec40000,0x3f6dbf35,0x3f6dbf80,0x3ec4bf35,0xbf7b3f80,0xbf553f6d,0x3e480000,0x3f0ebec4
.long 0x3f803f80,0x3f803f80,0x0,0x0,0xbf55bf35,0xbf7bbf6d,0x3f0e3f35,0x3e483ec4
.long 0x3ec40000,0x3f6d3f35,0xbf6dbf80,0xbec4bf35,0x3e483f35,0xbf55bec4,0x3f7b3f35,0x3f0e3f6d
.long 0xbf35bf80,0x3f350000,0xbf350000,0xbf35bf80,0x3f7b3f35,0xbf0e3ec4,0x3e48bf35,0x3f553f6d
.long 0xbf6d0000,0x3ec4bf35,0x3ec43f80,0xbf6dbf35,0x3f0ebf35,0xbe483f6d,0xbf55bf35,0x3f7b3ec4
.long 0x3f80,0xbf80,0x3f800000,0xbf800000,0xbf0ebf35,0x3e483f6d,0xbf553f35,0x3f7bbec4
.long 0x3f6d0000,0xbec4bf35,0x3ec4bf80,0xbf6d3f35,0xbf7b3f35,0x3f0e3ec4,0x3e483f35,0x3f55bf6d
.long 0x3f35bf80,0xbf350000,0xbf350000,0xbf353f80,0xbe483f35,0x3f55bec4,0x3f7bbf35,0x3f0ebf6d
.long 0xbec40000,0xbf6d3f35,0xbf6d3f80,0xbec43f35,0x3f55bf35,0x3f7bbf6d,0x3f0ebf35,0x3e48bec4
.long 0x0,0x0,0x3f803f80,0x3f803f80,0xbf0ebf35,0xbe48bec4,0xbf55bf35,0xbf7bbf6d
.long 0x3f6d3f80,0x3ec43f35,0x3ec40000,0x3f6d3f35,0xbf7bbf35,0xbf0ebf6d,0x3e483f35,0xbf55bec4
.long 0x3f350000,0x3f353f80,0xbf35bf80,0x3f350000,0xbe483f35,0xbf55bf6d,0x3f7b3f35,0xbf0e3ec4
.long 0xbec4bf80,0x3f6d3f35,0xbf6d0000,0x3ec4bf35,0x3f553f35,0xbf7bbec4,0x3f0ebf35,0xbe483f6d
.long 0xbf800000,0x3f800000,0x3f80,0xbf80,0x3f55bf35,0xbf7b3ec4,0xbf0ebf35,0x3e483f6d
.long 0xbec43f80,0x3f6dbf35,0x3f6d0000,0xbec4bf35,0xbe48bf35,0xbf553f6d,0xbf7b3f35,0x3f0e3ec4
.long 0x3f350000,0x3f35bf80,0x3f35bf80,0xbf350000,0xbf7b3f35,0xbf0e3f6d,0xbe483f35,0x3f55bec4
.long 0x3f6dbf80,0x3ec4bf35,0xbec40000,0xbf6d3f35,0xbf0e3f35,0xbe483ec4,0x3f55bf35,0x3f7bbf6d
.long 0x3f803f80,0x3f803f80,0x0,0x0,0xbf7bbf80,0xbf55bf6d,0xbe480000,0xbf0ebec4
.long 0x3f6d3f80,0x3ec43f35,0x3ec40000,0x3f6d3f35,0xbf55bf80,0x3e48bec4,0xbf0e0000,0xbf7bbf6d
.long 0x3f353f80,0xbf350000,0x3f350000,0x3f353f80,0xbf0ebf80,0x3f7b3ec4,0xbf550000,0xbe48bf6d
.long 0x3ec43f80,0xbf6dbf35,0x3f6d0000,0xbec43f35,0xbe48bf80,0x3f0e3f6d,0xbf7b0000,0x3f55bec4
.long 0x3f80,0xbf80,0x3f800000,0xbf800000,0x3e48bf80,0xbf0e3f6d,0xbf7b0000,0x3f553ec4
.long 0xbec43f80,0x3f6dbf35,0x3f6d0000,0xbec4bf35,0x3f0ebf80,0xbf7b3ec4,0xbf550000,0xbe483f6d
.long 0xbf353f80,0x3f350000,0x3f350000,0x3f35bf80,0x3f55bf80,0xbe48bec4,0xbf0e0000,0xbf7b3f6d
.long 0xbf6d3f80,0xbec43f35,0x3ec40000,0x3f6dbf35,0x3f7bbf80,0x3f55bf6d,0xbe480000,0xbf0e3ec4
.long 0x0,0x0,0x3f803f80,0x3f803f80,0x3e480000,0x3f0e3ec4,0xbf7bbf80,0xbf55bf6d
.long 0xbec40000,0xbf6dbf35,0x3f6d3f80,0x3ec43f35,0x3f0e0000,0x3f7b3f6d,0xbf55bf80,0x3e48bec4
.long 0xbf350000,0xbf35bf80,0x3f353f80,0xbf350000,0x3f550000,0x3e483f6d,0xbf0ebf80,0x3f7b3ec4
.long 0xbf6d0000,0x3ec4bf35,0x3ec43f80,0xbf6dbf35,0x3f7b0000,0xbf553ec4,0xbe48bf80,0x3f0e3f6d
.long 0xbf800000,0x3f800000,0x3f80,0xbf80,0x3f7b0000,0xbf55bec4,0x3e48bf80,0xbf0e3f6d
.long 0xbf6d0000,0x3ec43f35,0xbec43f80,0x3f6dbf35,0x3f550000,0x3e48bf6d,0x3f0ebf80,0xbf7b3ec4
.long 0xbf350000,0xbf353f80,0xbf353f80,0x3f350000,0x3f0e0000,0x3f7bbf6d,0x3f55bf80,0xbe48bec4
.long 0xbec40000,0xbf6d3f35,0xbf6d3f80,0xbec43f35,0x3e480000,0x3f0ebec4,0x3f7bbf80,0x3f55bf6d
.long 0x3f803f80,0x3f803f80,0x0,0x0,0xbf0ebf35,0xbe48bec4,0xbf55bf35,0xbf7bbf6d
.long 0xbec40000,0xbf6dbf35,0x3f6d3f80,0x3ec43f35,0x3f7b3f35,0x3f0e3f6d,0xbe48bf35,0x3f553ec4
.long 0xbf35bf80,0x3f350000,0xbf350000,0xbf35bf80,0xbe483f35,0xbf55bf6d,0x3f7b3f35,0xbf0e3ec4
.long 0x3f6d0000,0xbec43f35,0xbec4bf80,0x3f6d3f35,0xbf55bf35,0x3f7b3ec4,0xbf0e3f35,0x3e48bf6d
.long 0x3f80,0xbf80,0x3f800000,0xbf800000,0x3f55bf35,0xbf7b3ec4,0xbf0ebf35,0x3e483f6d
.long 0xbf6d0000,0x3ec43f35,0xbec43f80,0x3f6dbf35,0x3e483f35,0x3f55bf6d,0x3f7bbf35,0xbf0ebec4
.long 0x3f35bf80,0xbf350000,0xbf350000,0xbf353f80,0xbf7b3f35,0xbf0e3f6d,0xbe483f35,0x3f55bec4
.long 0x3ec40000,0x3f6dbf35,0x3f6dbf80,0x3ec4bf35,0x3f0ebf35,0x3e48bec4,0xbf553f35,0xbf7b3f6d
.long 0x0,0x0,0x3f803f80,0x3f803f80,0x3f553f35,0x3f7b3f6d,0xbf0ebf35,0xbe48bec4
.long 0xbf6dbf80,0xbec4bf35,0xbec40000,0xbf6dbf35,0x3e483f35,0xbf55bec4,0x3f7b3f35,0x3f0e3f6d
.long 0x3f350000,0x3f353f80,0xbf35bf80,0x3f350000,0xbf7bbf35,0x3f0ebec4,0xbe483f35,0xbf55bf6d
.long 0x3ec43f80,0xbf6dbf35,0x3f6d0000,0xbec43f35,0x3f0ebf35,0xbe483f6d,0xbf55bf35,0x3f7b3ec4
.long 0xbf800000,0x3f800000,0x3f80,0xbf80,0x3f0e3f35,0xbe48bf6d,0x3f55bf35,0xbf7b3ec4
.long 0x3ec4bf80,0xbf6d3f35,0xbf6d0000,0x3ec43f35,0xbf7b3f35,0x3f0e3ec4,0x3e483f35,0x3f55bf6d
.long 0x3f350000,0x3f35bf80,0x3f35bf80,0xbf350000,0x3e48bf35,0xbf553ec4,0xbf7b3f35,0xbf0e3f6d
.long 0xbf6d3f80,0xbec43f35,0x3ec40000,0x3f6dbf35,0x3f55bf35,0x3f7bbf6d,0x3f0ebf35,0x3e48bec4
.long 0x3f803f80,0x3f803f80,0x0,0x0,0x3e480000,0x3f0e3ec4,0xbf7bbf80,0xbf55bf6d
.long 0xbf6dbf80,0xbec4bf35,0xbec40000,0xbf6dbf35,0xbf0e0000,0xbf7bbf6d,0x3f553f80,0xbe483ec4
.long 0x3f353f80,0xbf350000,0x3f350000,0x3f353f80,0x3f550000,0x3e483f6d,0xbf0ebf80,0x3f7b3ec4
.long 0xbec4bf80,0x3f6d3f35,0xbf6d0000,0x3ec4bf35,0xbf7b0000,0x3f55bec4,0x3e483f80,0xbf0ebf6d
.long 0x3f80,0xbf80,0x3f800000,0xbf800000,0x3f7b0000,0xbf55bec4,0x3e48bf80,0xbf0e3f6d
.long 0x3ec4bf80,0xbf6d3f35,0xbf6d0000,0x3ec43f35,0xbf550000,0xbe483f6d,0xbf0e3f80,0x3f7bbec4
.long 0xbf353f80,0x3f350000,0x3f350000,0x3f35bf80,0x3f0e0000,0x3f7bbf6d,0x3f55bf80,0xbe48bec4
.long 0x3f6dbf80,0x3ec4bf35,0xbec40000,0xbf6d3f35,0xbe480000,0xbf0e3ec4,0xbf7b3f80,0xbf553f6d
.long 0x0,0x0,0x3f803f80,0x3f803f80,0x3f7b3f80,0x3f553f6d,0x3e480000,0x3f0e3ec4
.long 0x3ec40000,0x3f6d3f35,0xbf6dbf80,0xbec4bf35,0xbf55bf80,0x3e48bec4,0xbf0e0000,0xbf7bbf6d
.long 0xbf350000,0xbf35bf80,0x3f353f80,0xbf350000,0x3f0e3f80,0xbf7bbec4,0x3f550000,0x3e483f6d
.long 0x3f6d0000,0xbec43f35,0xbec4bf80,0x3f6d3f35,0xbe48bf80,0x3f0e3f6d,0xbf7b0000,0x3f55bec4
.long 0xbf800000,0x3f800000,0x3f80,0xbf80,0xbe483f80,0x3f0ebf6d,0x3f7b0000,0xbf55bec4
.long 0x3f6d0000,0xbec4bf35,0x3ec4bf80,0xbf6d3f35,0x3f0ebf80,0xbf7b3ec4,0xbf550000,0xbe483f6d
.long 0xbf350000,0xbf353f80,0xbf353f80,0x3f350000,0xbf553f80,0x3e483ec4,0x3f0e0000,0x3f7bbf6d
.long 0x3ec40000,0x3f6dbf35,0x3f6dbf80,0x3ec4bf35,0x3f7bbf80,0x3f55bf6d,0xbe480000,0xbf0e3ec4
.long 0x3f803f80,0x3f803f80,0x0,0x0,0x3f553f35,0x3f7b3f6d,0xbf0ebf35,0xbe48bec4
.long 0x3ec40000,0x3f6d3f35,0xbf6dbf80,0xbec4bf35,0xbe48bf35,0x3f553ec4,0xbf7bbf35,0xbf0ebf6d
.long 0xbf35bf80,0x3f350000,0xbf350000,0xbf35bf80,0xbf7bbf35,0x3f0ebec4,0xbe483f35,0xbf55bf6d
.long 0xbf6d0000,0x3ec4bf35,0x3ec43f80,0xbf6dbf35,0xbf0e3f35,0x3e48bf6d,0x3f553f35,0xbf7bbec4
.long 0x3f80,0xbf80,0x3f800000,0xbf800000,0x3f0e3f35,0xbe48bf6d,0x3f55bf35,0xbf7b3ec4
.long 0x3f6d0000,0xbec4bf35,0x3ec4bf80,0xbf6d3f35,0x3f7bbf35,0xbf0ebec4,0xbe48bf35,0xbf553f6d
.long 0x3f35bf80,0xbf350000,0xbf350000,0xbf353f80,0x3e48bf35,0xbf553ec4,0xbf7b3f35,0xbf0e3f6d
.long 0xbec40000,0xbf6d3f35,0xbf6d3f80,0xbec43f35,0xbf553f35,0xbf7b3f6d,0xbf0e3f35,0xbe483ec4
.long 0x0,0x0,0x3f803f80,0x3f803f80,0x3f0e3f35,0x3e483ec4,0x3f553f35,0x3f7b3f6d
.long 0x3f6d3f80,0x3ec43f35,0x3ec40000,0x3f6d3f35,0x3f7b3f35,0x3f0e3f6d,0xbe48bf35,0x3f553ec4
.long 0x3f350000,0x3f353f80,0xbf35bf80,0x3f350000,0x3e48bf35,0x3f553f6d,0xbf7bbf35,0x3f0ebec4
.long 0xbec4bf80,0x3f6d3f35,0xbf6d0000,0x3ec4bf35,0xbf55bf35,0x3f7b3ec4,0xbf0e3f35,0x3e48bf6d
.long 0xbf800000,0x3f800000,0x3f80,0xbf80,0xbf553f35,0x3f7bbec4,0x3f0e3f35,0xbe48bf6d
.long 0xbec43f80,0x3f6dbf35,0x3f6d0000,0xbec4bf35,0x3e483f35,0x3f55bf6d,0x3f7bbf35,0xbf0ebec4
.long 0x3f350000,0x3f35bf80,0x3f35bf80,0xbf350000,0x3f7bbf35,0x3f0ebf6d,0x3e48bf35,0xbf553ec4
.long 0x3f6dbf80,0x3ec4bf35,0xbec40000,0xbf6d3f35,0x3f0ebf35,0x3e48bec4,0xbf553f35,0xbf7b3f6d
.long 0x3f800000,0x3f800000,0x3f800000,0x3f800000,0x3f800000,0x3f7ffec4,0x3f7ffb11,0x3f7ff4e6
.long 0x3f800000,0x3f7ffb11,0x3f7fec43,0x3f7fd397,0x3f800000,0x3f7ff4e6,0x3f7fd397,0x3f7f9c18
.long 0x3f800000,0x3f7fec43,0x3f7fb10f,0x3f7f4e6d,0x3f800000,0x3f7fe129,0x3f7f84ab,0x3f7eea9d
.long 0x3f800000,0x3f7fd397,0x3f7f4e6d,0x3f7e70b0,0x3f800000,0x3f7fc38f,0x3f7f0e58,0x3f7de0b1
.long 0x3f800000,0x3f7fb10f,0x3f7ec46d,0x3f7d3aac,0x3f800000,0x3f7f9c18,0x3f7e70b0,0x3f7c7eb0
.long 0x3f800000,0x3f7f84ab,0x3f7e1324,0x3f7baccd,0x3f800000,0x3f7f6ac7,0x3f7dabcc,0x3f7ac516
.long 0x3f800000,0x3f7f4e6d,0x3f7d3aac,0x3f79c79d,0x3f800000,0x3f7f2f9d,0x3f7cbfc9,0x3f78b47b
.long 0x3f800000,0x3f7f0e58,0x3f7c3b28,0x3f778bc5,0x3f800000,0x3f7eea9d,0x3f7baccd,0x3f764d97
.long 0x3f800000,0x3f7ec46d,0x3f7b14be,0x3f74fa0b,0x3f800000,0x3f7e9bc9,0x3f7a7302,0x3f73913f
.long 0x3f800000,0x3f7e70b0,0x3f79c79d,0x3f721352,0x3f800000,0x3f7e4323,0x3f791298,0x3f708066
.long 0x3f800000,0x3f7e1324,0x3f7853f8,0x3f6ed89e,0x3f800000,0x3f7de0b1,0x3f778bc5,0x3f6d1c1d
.long 0x3f800000,0x3f7dabcc,0x3f76ba07,0x3f6b4b0c,0x3f800000,0x3f7d7474,0x3f75dec6,0x3f696591
.long 0x3f800000,0x3f7d3aac,0x3f74fa0b,0x3f676bd8,0x3f800000,0x3f7cfe73,0x3f740bdd,0x3f655e0b
.long 0x3f800000,0x3f7cbfc9,0x3f731447,0x3f633c5a,0x3f800000,0x3f7c7eb0,0x3f721352,0x3f6106f2
.long 0x3f800000,0x3f7c3b28,0x3f710908,0x3f5ebe05,0x3f800000,0x3f7bf531,0x3f6ff573,0x3f5c61c7
.long 0x3f800000,0x3f7baccd,0x3f6ed89e,0x3f59f26a,0x3f800000,0x3f7b61fc,0x3f6db293,0x3f577026
.long 0x3f800000,0x3f800000,0x3f800000,0x3f800000,0x3f7fec43,0x3f7fe129,0x3f7fd397,0x3f7fc38f
.long 0x3f7fb10f,0x3f7f84ab,0x3f7f4e6d,0x3f7f0e58,0x3f7f4e6d,0x3f7eea9d,0x3f7e70b0,0x3f7de0b1
.long 0x3f7ec46d,0x3f7e1324,0x3f7d3aac,0x3f7c3b28,0x3f7e1324,0x3f7cfe73,0x3f7baccd,0x3f7a1e84
.long 0x3f7d3aac,0x3f7baccd,0x3f79c79d,0x3f778bc5,0x3f7c3b28,0x3f7a1e84,0x3f778bc5,0x3f748422
.long 0x3f7b14be,0x3f7853f8,0x3f74fa0b,0x3f710908,0x3f79c79d,0x3f764d97,0x3f721352,0x3f6d1c1d
.long 0x3f7853f8,0x3f740bdd,0x3f6ed89e,0x3f68bf3c,0x3f76ba07,0x3f718f57,0x3f6b4b0c,0x3f63f473
.long 0x3f74fa0b,0x3f6ed89e,0x3f676bd8,0x3f5ebe05,0x3f731447,0x3f6be858,0x3f633c5a,0x3f591e6a
.long 0x3f710908,0x3f68bf3c,0x3f5ebe05,0x3f531849,0x3f6ed89e,0x3f655e0b,0x3f59f26a,0x3f4cae79
.long 0x3f6c835e,0x3f61c598,0x3f54db31,0x3f45e403,0x3f6a09a7,0x3f5df6be,0x3f4f7a1f,0x3f3ebc1b
.long 0x3f676bd8,0x3f59f26a,0x3f49d112,0x3f373a23,0x3f64aa59,0x3f55b993,0x3f43e200,0x3f2f61a5
.long 0x3f61c598,0x3f514d3d,0x3f3daef9,0x3f273656,0x3f5ebe05,0x3f4cae79,0x3f373a23,0x3f1ebc12
.long 0x3f5b941a,0x3f47de65,0x3f3085bb,0x3f15f6d9,0x3f584853,0x3f42de29,0x3f299415,0x3f0cead0
.long 0x3f54db31,0x3f3daef9,0x3f226799,0x3f039c3d,0x3f514d3d,0x3f385216,0x3f1b02c6,0x3ef41f07
.long 0x3f4d9f02,0x3f32c8c9,0x3f13682a,0x3ee0924f,0x3f49d112,0x3f2d1469,0x3f0b9a6b,0x3ecc9b8b
.long 0x3f45e403,0x3f273656,0x3f039c3d,0x3eb8442a,0x3f41d870,0x3f212ff9,0x3ef6e0cb,0x3ea395c5
.long 0x3f3daef9,0x3f1b02c6,0x3ee63375,0x3e8e9a22,0x3f396842,0x3f14b039,0x3ed53641,0x3e72b651
.long 0x3f800000,0x3f800000,0x3f800000,0x3f800000,0x3f7fb10f,0x3f7f9c18,0x3f7f84ab,0x3f7f6ac7
.long 0x3f7ec46d,0x3f7e70b0,0x3f7e1324,0x3f7dabcc,0x3f7d3aac,0x3f7c7eb0,0x3f7baccd,0x3f7ac516
.long 0x3f7b14be,0x3f79c79d,0x3f7853f8,0x3f76ba07,0x3f7853f8,0x3f764d97,0x3f740bdd,0x3f718f57
.long 0x3f74fa0b,0x3f721352,0x3f6ed89e,0x3f6b4b0c,0x3f710908,0x3f6d1c1d,0x3f68bf3c,0x3f63f473
.long 0x3f6c835e,0x3f676bd8,0x3f61c598,0x3f5b941a,0x3f676bd8,0x3f6106f2,0x3f59f26a,0x3f5233c6
.long 0x3f61c598,0x3f59f26a,0x3f514d3d,0x3f47de65,0x3f5b941a,0x3f5233c6,0x3f47de65,0x3f3ca003
.long 0x3f54db31,0x3f49d112,0x3f3daef9,0x3f3085bb,0x3f4d9f02,0x3f40d0da,0x3f32c8c9,0x3f239da9
.long 0x3f45e403,0x3f373a23,0x3f273656,0x3f15f6d9,0x3f3daef9,0x3f2d1469,0x3f1b02c6,0x3f07a136
.long 0x3f3504f3,0x3f226799,0x3f0e39da,0x3ef15aea,0x3f2beb4a,0x3f173c07,0x3f00e7e4,0x3ed25a09
.long 0x3f226799,0x3f0b9a6b,0x3ee63375,0x3eb263ef,0x3f187fc0,0x3eff17b2,0x3ec9b953,0x3e919ddd
.long 0x3f0e39da,0x3ee63375,0x3eac7cd4,0x3e605c13,0x3f039c3d,0x3ecc9b8b,0x3e8e9a22,0x3e1c76de
.long 0x3ef15aea,0x3eb263ef,0x3e605c13,0x3dafb680,0x3edae880,0x3e97a117,0x3e22abb6,0x3c96c9b6
.long 0x3ec3ef15,0x3e78cfcc,0x3dc8bd36,0xbd48fb30,0x3eac7cd4,0x3e419b37,0x3d16c32c,0xbdee3876
.long 0x3e94a031,0x3e09cf86,0xbcc90ab0,0xbe3b6ecf,0x3e78cfcc,0x3da3308c,0xbdafb680,0xbe7ee6e1
.long 0x3e47c5c2,0x3cc90ab0,0xbe164083,0xbea09ae5,0x3e164083,0xbcfb49ba,0xbe541501,0xbec1071e
.long 0x3dc8bd36,0xbdafb680,0xbe888e93,0xbee0924f,0x3d48fb30,0xbe1008b7,0xbea68f12,0xbeff17b2
.long 0x3f800000,0x3f800000,0x3f800000,0x3f800000,0x3f7f4e6d,0x3f7f2f9d,0x3f7f0e58,0x3f7eea9d
.long 0x3f7d3aac,0x3f7cbfc9,0x3f7c3b28,0x3f7baccd,0x3f79c79d,0x3f78b47b,0x3f778bc5,0x3f764d97
.long 0x3f74fa0b,0x3f731447,0x3f710908,0x3f6ed89e,0x3f6ed89e,0x3f6be858,0x3f68bf3c,0x3f655e0b
.long 0x3f676bd8,0x3f633c5a,0x3f5ebe05,0x3f59f26a,0x3f5ebe05,0x3f591e6a,0x3f531849,0x3f4cae79
.long 0x3f54db31,0x3f4d9f02,0x3f45e403,0x3f3daef9,0x3f49d112,0x3f40d0da,0x3f373a23,0x3f2d1469
.long 0x3f3daef9,0x3f32c8c9,0x3f273656,0x3f1b02c6,0x3f3085bb,0x3f239da9,0x3f15f6d9,0x3f07a136
.long 0x3f226799,0x3f13682a,0x3f039c3d,0x3ee63375,0x3f13682a,0x3f0242b1,0x3ee0924f,0x3ebb31a0
.long 0x3f039c3d,0x3ee0924f,0x3eb8442a,0x3e8e9a22,0x3ee63375,0x3ebb31a0,0x3e8e9a22,0x3e419b37
.long 0x3ec3ef15,0x3e94a031,0x3e47c5c2,0x3dc8bd36,0x3ea09ae5,0x3e5a3997,0x3de1bc2e,0x3bc90f88
.long 0x3e78cfcc,0x3e09cf86,0x3cc90ab0,0xbdafb680,0x3e2f10a2,0x3d621469,0xbd7b2b74,0xbe354098
.long 0x3dc8bd36,0xbcc90ab0,0xbe164083,0xbe888e93,0x3cc90ab0,0xbdd53db9,0xbe6c9a7f,0xbeb554ec
.long 0xbd48fb30,0xbe3b6ecf,0xbea09ae5,0xbee0924f,0xbdfab273,0xbe8586ce,0xbec9b953,0xbf04f484
.long 0xbe47c5c2,0xbeac7cd4,0xbef15aea,0xbf187fc0,0xbe888e93,0xbed25a09,0xbf0b9a6b,0xbf2ac082
.long 0xbeac7cd4,0xbef6e0cb,0xbf1d7fd1,0xbf3b8f3b,0xbecf7bca,0xbf0cead0,0xbf2e3bde,0xbf4ac77f
.long 0xbef15aea,0xbf1d7fd1,0xbf3daef9,0xbf584853,0xbf08f59b,0xbf2d1469,0xbf4bbbf8,0xbf63f473
.long 0xbf187fc0,0xbf3b8f3b,0xbf584853,0xbf6db293,0xbf273656,0xbf48d8b3,0xbf633c5a,0xbf756d97
.long 0x3f800000,0x3f800000,0x3f800000,0x3f800000,0x3f7ec46d,0x3f7e9bc9,0x3f7e70b0,0x3f7e4323
.long 0x3f7b14be,0x3f7a7302,0x3f79c79d,0x3f791298,0x3f74fa0b,0x3f73913f,0x3f721352,0x3f708066
.long 0x3f6c835e,0x3f6a09a7,0x3f676bd8,0x3f64aa59,0x3f61c598,0x3f5df6be,0x3f59f26a,0x3f55b993
.long 0x3f54db31,0x3f4f7a1f,0x3f49d112,0x3f43e200,0x3f45e403,0x3f3ebc1b,0x3f373a23,0x3f2f61a5
.long 0x3f3504f3,0x3f2beb4a,0x3f226799,0x3f187fc0,0x3f226799,0x3f173c07,0x3f0b9a6b,0x3eff17b2
.long 0x3f0e39da,0x3f00e7e4,0x3ee63375,0x3ec9b953,0x3ef15aea,0x3ed25a09,0x3eb263ef,0x3e919ddd
.long 0x3ec3ef15,0x3ea09ae5,0x3e78cfcc,0x3e2f10a2,0x3e94a031,0x3e5a3997,0x3e09cf86,0x3d621469
.long 0x3e47c5c2,0x3de1bc2e,0x3cc90ab0,0xbd7b2b74,0x3dc8bd36,0x3bc90f88,0xbdafb680,0xbe354098
.long 0x0,0xbdc8bd36,0xbe47c5c2,0xbe94a031,0xbdc8bd36,0xbe4dee60,0xbe9aa086,0xbecc9b8b
.long 0xbe47c5c2,0xbe9aa086,0xbecf7bca,0xbf00e7e4,0xbe94a031,0xbecc9b8b,0xbf00e7e4,0xbf19c200
.long 0xbec3ef15,0xbefc5d27,0xbf187fc0,0xbf3085bb,0xbef15aea,0xbf14b039,0xbf2e3bde,0xbf44e3f5
.long 0xbf0e39da,0xbf299415,0xbf41d870,0xbf5695e5,0xbf226799,0xbf3ca003,0xbf531849,0xbf655e0b
.long 0xbf3504f3,0xbf4d9f02,0xbf61c598,0xbf710908,0xbf45e403,0xbf5c61c7,0xbf6db293,0xbf796e4e
.long 0xbf54db31,0xbf68bf3c,0xbf76ba07,0xbf7e70b0,0xbf61c598,0xbf7294f8,0xbf7cbfc9,0xbf7ffec4
.long 0xbf6c835e,0xbf79c79d,0xbf7fb10f,0xbf7e1324,0xbf74fa0b,0xbf7e4323,0xbf7f84ab,0xbf78b47b
.long 0xbf7b14be,0xbf7ffb11,0xbf7c3b28,0xbf6ff573,0xbf7ec46d,0xbf7eea9d,0xbf75dec6,0xbf63f473
.long 0x3f800000,0x3f800000,0x3f800000,0x3f800000,0x3f7e1324,0x3f7de0b1,0x3f7dabcc,0x3f7d7474
.long 0x3f7853f8,0x3f778bc5,0x3f76ba07,0x3f75dec6,0x3f6ed89e,0x3f6d1c1d,0x3f6b4b0c,0x3f696591
.long 0x3f61c598,0x3f5ebe05,0x3f5b941a,0x3f584853,0x3f514d3d,0x3f4cae79,0x3f47de65,0x3f42de29
.long 0x3f3daef9,0x3f373a23,0x3f3085bb,0x3f299415,0x3f273656,0x3f1ebc12,0x3f15f6d9,0x3f0cead0
.long 0x3f0e39da,0x3f039c3d,0x3ef15aea,0x3edae880,0x3ee63375,0x3ecc9b8b,0x3eb263ef,0x3e97a117
.long 0x3eac7cd4,0x3e8e9a22,0x3e605c13,0x3e22abb6,0x3e605c13,0x3e1c76de,0x3dafb680,0x3c96c9b6
.long 0x3dc8bd36,0x3cc90ab0,0xbd48fb30,0xbdfab273,0xbcc90ab0,0xbdd53db9,0xbe3b6ecf,0xbe8586ce
.long 0xbe164083,0xbe6c9a7f,0xbea09ae5,0xbec9b953,0xbe888e93,0xbeb554ec,0xbee0924f,0xbf04f484
.long 0xbec3ef15,0xbef15aea,0xbf0e39da,0xbf226799,0xbefc5d27,0xbf14b039,0xbf299415,0xbf3ca003
.long 0xbf187fc0,0xbf2e3bde,0xbf41d870,0xbf531849,0xbf3085bb,0xbf44e3f5,0xbf5695e5,0xbf655e0b
.long 0xbf45e403,0xbf584853,0xbf676bd8,0xbf731447,0xbf584853,0xbf6816a8,0xbf740bdd,0xbf7bf531
.long 0xbf676bd8,0xbf740bdd,0xbf7c3b28,0xbf7fd397,0xbf731447,0xbf7bf531,0xbf7fd397,0xbf7e9bc9
.long 0xbf7b14be,0xbf7fb10f,0xbf7ec46d,0xbf7853f8,0xbf7f4e6d,0xbf7f2f9d,0xbf791298,0xbf6d1c1d
.long 0xbf7fb10f,0xbf7a7302,0xbf6ed89e,0xbf5d2d53,0xbf7c3b28,0xbf718f57,0xbf604621,0xbf48d8b3
.long 0xbf74fa0b,0xbf64aa59,0xbf4d9f02,0xbf3085bb,0xbf6a09a7,0xbf53fac3,0xbf373a23,0xbf14b039
.long 0xbf5b941a,0xbf3fc767,0xbf1d7fd1,0xbeebcbbb,0xbf49d112,0xbf286605,0xbf00e7e4,0xbea986c4
.long 0x3f800000,0x3f800000,0x3f800000,0x3f800000,0x3f7d3aac,0x3f7cfe73,0x3f7cbfc9,0x3f7c7eb0
.long 0x3f74fa0b,0x3f740bdd,0x3f731447,0x3f721352,0x3f676bd8,0x3f655e0b,0x3f633c5a,0x3f6106f2
.long 0x3f54db31,0x3f514d3d,0x3f4d9f02,0x3f49d112,0x3f3daef9,0x3f385216,0x3f32c8c9,0x3f2d1469
.long 0x3f226799,0x3f1b02c6,0x3f13682a,0x3f0b9a6b,0x3f039c3d,0x3ef41f07,0x3ee0924f,0x3ecc9b8b
.long 0x3ec3ef15,0x3eac7cd4,0x3e94a031,0x3e78cfcc,0x3e78cfcc,0x3e419b37,0x3e09cf86,0x3da3308c
.long 0x3dc8bd36,0x3d16c32c,0xbcc90ab0,0xbdafb680,0xbd48fb30,0xbdee3876,0xbe3b6ecf,0xbe7ee6e1
.long 0xbe47c5c2,0xbe888e93,0xbeac7cd4,0xbecf7bca,0xbeac7cd4,0xbed25a09,0xbef6e0cb,0xbf0cead0
.long 0xbef15aea,0xbf0b9a6b,0xbf1d7fd1,0xbf2e3bde,0xbf187fc0,0xbf2ac082,0xbf3b8f3b,0xbf4ac77f
.long 0xbf3504f3,0xbf45e403,0xbf54db31,0xbf61c598,0xbf4d9f02,0xbf5c61c7,0xbf68bf3c,0xbf7294f8
.long 0xbf61c598,0xbf6db293,0xbf76ba07,0xbf7cbfc9,0xbf710908,0xbf796e4e,0xbf7e70b0,0xbf7ffec4
.long 0xbf7b14be,0xbf7f4e6d,0xbf7fb10f,0xbf7c3b28,0xbf7fb10f,0xbf7f2f9d,0xbf7a7302,0xbf718f57
.long 0xbf7ec46d,0xbf791298,0xbf6ed89e,0xbf604621,0xbf7853f8,0xbf6d1c1d,0xbf5d2d53,0xbf48d8b3
.long 0xbf6c835e,0xbf5b941a,0xbf45e403,0xbf2beb4a,0xbf5b941a,0xbf44e3f5,0xbf299415,0xbf0a48ad
.long 0xbf45e403,0xbf299415,0xbf08f59b,0xbec9b953,0xbf2beb4a,0xbf0a48ad,0xbec9b953,0xbe72b651
.long 0xbf0e39da,0xbecf7bca,0xbe78cfcc,0xbd96a905,0xbedae880,0xbe8586ce,0xbdafb680,0x3dbc3ac3
.long 0xbe94a031,0xbde1bc2e,0x3d96a905,0x3e827dc0,0xbe164083,0x3d2fe007,0x3e6c9a7f,0x3ed25a09
.long 0x3f800000,0x3f800000,0x3f800000,0x3f800000,0x3f7c3b28,0x3f7bf531,0x3f7baccd,0x3f7b61fc
.long 0x3f710908,0x3f6ff573,0x3f6ed89e,0x3f6db293,0x3f5ebe05,0x3f5c61c7,0x3f59f26a,0x3f577026
.long 0x3f45e403,0x3f41d870,0x3f3daef9,0x3f396842,0x3f273656,0x3f212ff9,0x3f1b02c6,0x3f14b039
.long 0x3f039c3d,0x3ef6e0cb,0x3ee63375,0x3ed53641,0x3eb8442a,0x3ea395c5,0x3e8e9a22,0x3e72b651
.long 0x3e47c5c2,0x3e164083,0x3dc8bd36,0x3d48fb30,0x3cc90ab0,0xbcfb49ba,0xbdafb680,0xbe1008b7
.long 0xbe164083,0xbe541501,0xbe888e93,0xbea68f12,0xbea09ae5,0xbec1071e,0xbee0924f,0xbeff17b2
.long 0xbef15aea,0xbf08f59b,0xbf187fc0,0xbf273656,0xbf1d7fd1,0xbf2d1469,0xbf3b8f3b,0xbf48d8b3
.long 0xbf3daef9,0xbf4bbbf8,0xbf584853,0xbf633c5a,0xbf584853,0xbf63f473,0xbf6db293,0xbf756d97
.long 0xbf6c835e,0xbf74fa0b,0xbf7b14be,0xbf7ec46d,0xbf79c79d,0xbf7e4323,0xbf7ffb11,0xbf7eea9d
.long 0xbf7fb10f,0xbf7f84ab,0xbf7c3b28,0xbf75dec6,0xbf7e1324,0xbf78b47b,0xbf6ff573,0xbf63f473
.long 0xbf74fa0b,0xbf6a09a7,0xbf5b941a,0xbf49d112,0xbf64aa59,0xbf53fac3,0xbf3fc767,0xbf286605
.long 0xbf4d9f02,0xbf373a23,0xbf1d7fd1,0xbf00e7e4,0xbf3085bb,0xbf14b039,0xbeebcbbb,0xbea986c4
.long 0xbf0e39da,0xbedae880,0xbe94a031,0xbe164083,0xbecf7bca,0xbe8586ce,0xbde1bc2e,0x3d2fe007
.long 0xbe78cfcc,0xbdafb680,0x3d96a905,0x3e6c9a7f,0xbd96a905,0x3dbc3ac3,0x3e827dc0,0x3ed25a09
.long 0x3dc8bd36,0x3e888e93,0x3edae880,0x3f13682a,0x3e888e93,0x3eddbe79,0x3f15f6d9,0x3f385216
.long 0x3edae880,0x3f15f6d9,0x3f396842,0x3f5695e5,0x3f13682a,0x3f385216,0x3f5695e5,0x3f6d1c1d
.long 0x0,0x0,0x0,0x0,0x0,0x3bc90f88,0x3c490e90,0x3c96c9b6
.long 0x0,0x3c490e90,0x3cc90ab0,0x3d16c32c,0x0,0x3c96c9b6,0x3d16c32c,0x3d621469
.long 0x0,0x3cc90ab0,0x3d48fb30,0x3d96a905,0x0,0x3cfb49ba,0x3d7b2b74,0x3dbc3ac3
.long 0x0,0x3d16c32c,0x3d96a905,0x3de1bc2e,0x0,0x3d2fe007,0x3dafb680,0x3e039502
.long 0x0,0x3d48fb30,0x3dc8bd36,0x3e164083,0x0,0x3d621469,0x3de1bc2e,0x3e28defc
.long 0x0,0x3d7b2b74,0x3dfab273,0x3e3b6ecf,0x0,0x3d8a200a,0x3e09cf86,0x3e4dee60
.long 0x0,0x3d96a905,0x3e164083,0x3e605c13,0x0,0x3da3308c,0x3e22abb6,0x3e72b651
.long 0x0,0x3dafb680,0x3e2f10a2,0x3e827dc0,0x0,0x3dbc3ac3,0x3e3b6ecf,0x3e8b9507
.long 0x0,0x3dc8bd36,0x3e47c5c2,0x3e94a031,0x0,0x3dd53db9,0x3e541501,0x3e9d9e78
.long 0x0,0x3de1bc2e,0x3e605c13,0x3ea68f12,0x0,0x3dee3876,0x3e6c9a7f,0x3eaf713a
.long 0x0,0x3dfab273,0x3e78cfcc,0x3eb8442a,0x0,0x3e039502,0x3e827dc0,0x3ec1071e
.long 0x0,0x3e09cf86,0x3e888e93,0x3ec9b953,0x0,0x3e1008b7,0x3e8e9a22,0x3ed25a09
.long 0x0,0x3e164083,0x3e94a031,0x3edae880,0x0,0x3e1c76de,0x3e9aa086,0x3ee363fa
.long 0x0,0x3e22abb6,0x3ea09ae5,0x3eebcbbb,0x0,0x3e28defc,0x3ea68f12,0x3ef41f07
.long 0x0,0x3e2f10a2,0x3eac7cd4,0x3efc5d27,0x0,0x3e354098,0x3eb263ef,0x3f0242b1
.long 0x0,0x3e3b6ecf,0x3eb8442a,0x3f064b82,0x0,0x3e419b37,0x3ebe1d4a,0x3f0a48ad
.long 0x0,0x0,0x0,0x0,0x3cc90ab0,0x3cfb49ba,0x3d16c32c,0x3d2fe007
.long 0x3d48fb30,0x3d7b2b74,0x3d96a905,0x3dafb680,0x3d96a905,0x3dbc3ac3,0x3de1bc2e,0x3e039502
.long 0x3dc8bd36,0x3dfab273,0x3e164083,0x3e2f10a2,0x3dfab273,0x3e1c76de,0x3e3b6ecf,0x3e5a3997
.long 0x3e164083,0x3e3b6ecf,0x3e605c13,0x3e827dc0,0x3e2f10a2,0x3e5a3997,0x3e827dc0,0x3e97a117
.long 0x3e47c5c2,0x3e78cfcc,0x3e94a031,0x3eac7cd4,0x3e605c13,0x3e8b9507,0x3ea68f12,0x3ec1071e
.long 0x3e78cfcc,0x3e9aa086,0x3eb8442a,0x3ed53641,0x3e888e93,0x3ea986c4,0x3ec9b953,0x3ee900b7
.long 0x3e94a031,0x3eb8442a,0x3edae880,0x3efc5d27,0x3ea09ae5,0x3ec6d529,0x3eebcbbb,0x3f07a136
.long 0x3eac7cd4,0x3ed53641,0x3efc5d27,0x3f10d3cd,0x3eb8442a,0x3ee363fa,0x3f064b82,0x3f19c200
.long 0x3ec3ef15,0x3ef15aea,0x3f0e39da,0x3f226799,0x3ecf7bca,0x3eff17b2,0x3f15f6d9,0x3f2ac082
.long 0x3edae880,0x3f064b82,0x3f1d7fd1,0x3f32c8c9,0x3ee63375,0x3f0cead0,0x3f24d225,0x3f3a7ca4
.long 0x3ef15aea,0x3f13682a,0x3f2beb4a,0x3f41d870,0x3efc5d27,0x3f19c200,0x3f32c8c9,0x3f48d8b3
.long 0x3f039c3d,0x3f1ff6cb,0x3f396842,0x3f4f7a1f,0x3f08f59b,0x3f26050a,0x3f3fc767,0x3f55b993
.long 0x3f0e39da,0x3f2beb4a,0x3f45e403,0x3f5b941a,0x3f13682a,0x3f31a81d,0x3f4bbbf8,0x3f6106f2
.long 0x3f187fc0,0x3f373a23,0x3f514d3d,0x3f660f88,0x3f1d7fd1,0x3f3ca003,0x3f5695e5,0x3f6aab7b
.long 0x3f226799,0x3f41d870,0x3f5b941a,0x3f6ed89e,0x3f273656,0x3f46e22a,0x3f604621,0x3f7294f8
.long 0x3f2beb4a,0x3f4bbbf8,0x3f64aa59,0x3f75dec6,0x3f3085bb,0x3f5064af,0x3f68bf3c,0x3f78b47b
.long 0x0,0x0,0x0,0x0,0x3d48fb30,0x3d621469,0x3d7b2b74,0x3d8a200a
.long 0x3dc8bd36,0x3de1bc2e,0x3dfab273,0x3e09cf86,0x3e164083,0x3e28defc,0x3e3b6ecf,0x3e4dee60
.long 0x3e47c5c2,0x3e605c13,0x3e78cfcc,0x3e888e93,0x3e78cfcc,0x3e8b9507,0x3e9aa086,0x3ea986c4
.long 0x3e94a031,0x3ea68f12,0x3eb8442a,0x3ec9b953,0x3eac7cd4,0x3ec1071e,0x3ed53641,0x3ee900b7
.long 0x3ec3ef15,0x3edae880,0x3ef15aea,0x3f039c3d,0x3edae880,0x3ef41f07,0x3f064b82,0x3f121eb0
.long 0x3ef15aea,0x3f064b82,0x3f13682a,0x3f1ff6cb,0x3f039c3d,0x3f121eb0,0x3f1ff6cb,0x3f2d1469
.long 0x3f0e39da,0x3f1d7fd1,0x3f2beb4a,0x3f396842,0x3f187fc0,0x3f286605,0x3f373a23,0x3f44e3f5
.long 0x3f226799,0x3f32c8c9,0x3f41d870,0x3f4f7a1f,0x3f2beb4a,0x3f3ca003,0x3f4bbbf8,0x3f591e6a
.long 0x3f3504f3,0x3f45e403,0x3f54db31,0x3f61c598,0x3f3daef9,0x3f4e8d90,0x3f5d2d53,0x3f696591
.long 0x3f45e403,0x3f5695e5,0x3f64aa59,0x3f6ff573,0x3f4d9f02,0x3f5df6be,0x3f6b4b0c,0x3f756d97
.long 0x3f54db31,0x3f64aa59,0x3f710908,0x3f79c79d,0x3f5b941a,0x3f6aab7b,0x3f75dec6,0x3f7cfe73
.long 0x3f61c598,0x3f6ff573,0x3f79c79d,0x3f7f0e58,0x3f676bd8,0x3f748422,0x3f7cbfc9,0x3f7ff4e6
.long 0x3f6c835e,0x3f7853f8,0x3f7ec46d,0x3f7fb10f,0x3f710908,0x3f7b61fc,0x3f7fd397,0x3f7e4323
.long 0x3f74fa0b,0x3f7dabcc,0x3f7fec43,0x3f7baccd,0x3f7853f8,0x3f7f2f9d,0x3f7f0e58,0x3f77f110
.long 0x3f7b14be,0x3f7fec43,0x3f7d3aac,0x3f731447,0x3f7d3aac,0x3f7fe129,0x3f7a7302,0x3f6d1c1d
.long 0x3f7ec46d,0x3f7f0e58,0x3f76ba07,0x3f660f88,0x3f7fb10f,0x3f7d7474,0x3f721352,0x3f5df6be
.long 0x0,0x0,0x0,0x0,0x3d96a905,0x3da3308c,0x3dafb680,0x3dbc3ac3
.long 0x3e164083,0x3e22abb6,0x3e2f10a2,0x3e3b6ecf,0x3e605c13,0x3e72b651,0x3e827dc0,0x3e8b9507
.long 0x3e94a031,0x3ea09ae5,0x3eac7cd4,0x3eb8442a,0x3eb8442a,0x3ec6d529,0x3ed53641,0x3ee363fa
.long 0x3edae880,0x3eebcbbb,0x3efc5d27,0x3f064b82,0x3efc5d27,0x3f07a136,0x3f10d3cd,0x3f19c200
.long 0x3f0e39da,0x3f187fc0,0x3f226799,0x3f2beb4a,0x3f1d7fd1,0x3f286605,0x3f32c8c9,0x3f3ca003
.long 0x3f2beb4a,0x3f373a23,0x3f41d870,0x3f4bbbf8,0x3f396842,0x3f44e3f5,0x3f4f7a1f,0x3f591e6a
.long 0x3f45e403,0x3f514d3d,0x3f5b941a,0x3f64aa59,0x3f514d3d,0x3f5c61c7,0x3f660f88,0x3f6e46be
.long 0x3f5b941a,0x3f660f88,0x3f6ed89e,0x3f75dec6,0x3f64aa59,0x3f6e46be,0x3f75dec6,0x3f7b61fc
.long 0x3f6c835e,0x3f74fa0b,0x3f7b14be,0x3f7ec46d,0x3f731447,0x3f7a1e84,0x3f7e70b0,0x3f7ffec4
.long 0x3f7853f8,0x3f7dabcc,0x3f7fec43,0x3f7f0e58,0x3f7c3b28,0x3f7f9c18,0x3f7f84ab,0x3f7bf531
.long 0x3f7ec46d,0x3f7fec43,0x3f7d3aac,0x3f76ba07,0x3f7fec43,0x3f7e9bc9,0x3f791298,0x3f6f6830
.long 0x3f7fb10f,0x3f7baccd,0x3f731447,0x3f660f88,0x3f7e1324,0x3f772417,0x3f6b4b0c,0x3f5ac450
.long 0x3f7b14be,0x3f710908,0x3f61c598,0x3f4d9f02,0x3f76ba07,0x3f696591,0x3f5695e5,0x3f3ebc1b
.long 0x3f710908,0x3f604621,0x3f49d112,0x3f2e3bde,0x3f6a09a7,0x3f55b993,0x3f3b8f3b,0x3f1c420c
.long 0x3f61c598,0x3f49d112,0x3f2beb4a,0x3f08f59b,0x3f584853,0x3f3ca003,0x3f1b02c6,0x3ee900b7
.long 0x3f4d9f02,0x3f2e3bde,0x3f08f59b,0x3ebe1d4a,0x3f41d870,0x3f1ebc12,0x3eebcbbb,0x3e919ddd
.long 0x0,0x0,0x0,0x0,0x3dc8bd36,0x3dd53db9,0x3de1bc2e,0x3dee3876
.long 0x3e47c5c2,0x3e541501,0x3e605c13,0x3e6c9a7f,0x3e94a031,0x3e9d9e78,0x3ea68f12,0x3eaf713a
.long 0x3ec3ef15,0x3ecf7bca,0x3edae880,0x3ee63375,0x3ef15aea,0x3eff17b2,0x3f064b82,0x3f0cead0
.long 0x3f0e39da,0x3f15f6d9,0x3f1d7fd1,0x3f24d225,0x3f226799,0x3f2ac082,0x3f32c8c9,0x3f3a7ca4
.long 0x3f3504f3,0x3f3daef9,0x3f45e403,0x3f4d9f02,0x3f45e403,0x3f4e8d90,0x3f5695e5,0x3f5df6be
.long 0x3f54db31,0x3f5d2d53,0x3f64aa59,0x3f6b4b0c,0x3f61c598,0x3f696591,0x3f6ff573,0x3f756d97
.long 0x3f6c835e,0x3f731447,0x3f7853f8,0x3f7c3b28,0x3f74fa0b,0x3f7a1e84,0x3f7dabcc,0x3f7f9c18
.long 0x3f7b14be,0x3f7e70b0,0x3f7fec43,0x3f7f84ab,0x3f7ec46d,0x3f7ffec4,0x3f7f0e58,0x3f7bf531
.long 0x3f800000,0x3f7ec46d,0x3f7b14be,0x3f74fa0b,0x3f7ec46d,0x3f7ac516,0x3f740bdd,0x3f6aab7b
.long 0x3f7b14be,0x3f740bdd,0x3f6a09a7,0x3f5d2d53,0x3f74fa0b,0x3f6aab7b,0x3f5d2d53,0x3f4cae79
.long 0x3f6c835e,0x3f5ebe05,0x3f4d9f02,0x3f396842,0x3f61c598,0x3f5064af,0x3f3b8f3b,0x3f239da9
.long 0x3f54db31,0x3f3fc767,0x3f273656,0x3f0b9a6b,0x3f45e403,0x3f2d1469,0x3f10d3cd,0x3ee363fa
.long 0x3f3504f3,0x3f187fc0,0x3ef15aea,0x3eac7cd4,0x3f226799,0x3f0242b1,0x3ebe1d4a,0x3e667c66
.long 0x3f0e39da,0x3ed53641,0x3e888e93,0x3de1bc2e,0x3ef15aea,0x3ea395c5,0x3e22abb6,0xbbc90f88
.long 0x3ec3ef15,0x3e605c13,0x3d48fb30,0xbdfab273,0x3e94a031,0x3dee3876,0xbd7b2b74,0xbe72b651
.long 0x3e47c5c2,0x3c490e90,0xbe2f10a2,0xbeb263ef,0x3dc8bd36,0xbdbc3ac3,0xbe8e9a22,0xbee900b7
.long 0x0,0x0,0x0,0x0,0x3dfab273,0x3e039502,0x3e09cf86,0x3e1008b7
.long 0x3e78cfcc,0x3e827dc0,0x3e888e93,0x3e8e9a22,0x3eb8442a,0x3ec1071e,0x3ec9b953,0x3ed25a09
.long 0x3ef15aea,0x3efc5d27,0x3f039c3d,0x3f08f59b,0x3f13682a,0x3f19c200,0x3f1ff6cb,0x3f26050a
.long 0x3f2beb4a,0x3f32c8c9,0x3f396842,0x3f3fc767,0x3f41d870,0x3f48d8b3,0x3f4f7a1f,0x3f55b993
.long 0x3f54db31,0x3f5b941a,0x3f61c598,0x3f676bd8,0x3f64aa59,0x3f6aab7b,0x3f6ff573,0x3f748422
.long 0x3f710908,0x3f75dec6,0x3f79c79d,0x3f7cbfc9,0x3f79c79d,0x3f7cfe73,0x3f7f0e58,0x3f7ff4e6
.long 0x3f7ec46d,0x3f7fec43,0x3f7fb10f,0x3f7e1324,0x3f7fec43,0x3f7e9bc9,0x3f7baccd,0x3f772417
.long 0x3f7d3aac,0x3f791298,0x3f731447,0x3f6b4b0c,0x3f76ba07,0x3f6f6830,0x3f660f88,0x3f5ac450
.long 0x3f6c835e,0x3f61c598,0x3f54db31,0x3f45e403,0x3f5ebe05,0x3f5064af,0x3f3fc767,0x3f2d1469
.long 0x3f4d9f02,0x3f3b8f3b,0x3f273656,0x3f10d3cd,0x3f396842,0x3f239da9,0x3f0b9a6b,0x3ee363fa
.long 0x3f226799,0x3f08f59b,0x3edae880,0x3ea09ae5,0x3f08f59b,0x3ed8106b,0x3e9aa086,0x3e354098
.long 0x3edae880,0x3e9aa086,0x3e2f10a2,0x3d16c32c,0x3ea09ae5,0x3e354098,0x3d16c32c,0xbdd53db9
.long 0x3e47c5c2,0x3d48fb30,0xbdc8bd36,0xbe78cfcc,0x3d96a905,0xbda3308c,0xbe6c9a7f,0xbec1071e
.long 0xbd48fb30,0xbe541501,0xbeb8442a,0xbf00e7e4,0xbe2f10a2,0xbea986c4,0xbef6e0cb,0xbf1ebc12
.long 0xbe94a031,0xbee63375,0xbf187fc0,0xbf396842,0xbecf7bca,0xbf0f8784,0xbf32c8c9,0xbf5064af
.long 0xbf039c3d,0xbf299415,0xbf49d112,0xbf633c5a,0xbf1d7fd1,0xbf40d0da,0xbf5d2d53,0xbf718f57
.long 0x0,0x0,0x0,0x0,0x3e164083,0x3e1c76de,0x3e22abb6,0x3e28defc
.long 0x3e94a031,0x3e9aa086,0x3ea09ae5,0x3ea68f12,0x3edae880,0x3ee363fa,0x3eebcbbb,0x3ef41f07
.long 0x3f0e39da,0x3f13682a,0x3f187fc0,0x3f1d7fd1,0x3f2beb4a,0x3f31a81d,0x3f373a23,0x3f3ca003
.long 0x3f45e403,0x3f4bbbf8,0x3f514d3d,0x3f5695e5,0x3f5b941a,0x3f6106f2,0x3f660f88,0x3f6aab7b
.long 0x3f6c835e,0x3f710908,0x3f74fa0b,0x3f7853f8,0x3f7853f8,0x3f7b61fc,0x3f7dabcc,0x3f7f2f9d
.long 0x3f7ec46d,0x3f7fd397,0x3f7fec43,0x3f7f0e58,0x3f7fb10f,0x3f7e4323,0x3f7baccd,0x3f77f110
.long 0x3f7b14be,0x3f76ba07,0x3f710908,0x3f6a09a7,0x3f710908,0x3f696591,0x3f604621,0x3f55b993
.long 0x3f61c598,0x3f5695e5,0x3f49d112,0x3f3b8f3b,0x3f4d9f02,0x3f3ebc1b,0x3f2e3bde,0x3f1c420c
.long 0x3f3504f3,0x3f226799,0x3f0e39da,0x3ef15aea,0x3f187fc0,0x3f0242b1,0x3ed53641,0x3ea395c5
.long 0x3ef15aea,0x3ebe1d4a,0x3e888e93,0x3e22abb6,0x3eac7cd4,0x3e667c66,0x3de1bc2e,0xbbc90f88
.long 0x3e47c5c2,0x3d96a905,0xbd48fb30,0xbe2f10a2,0x3d48fb30,0xbda3308c,0xbe541501,0xbea986c4
.long 0xbdc8bd36,0xbe6c9a7f,0xbeb8442a,0xbef6e0cb,0xbe78cfcc,0xbec1071e,0xbf00e7e4,0xbf1ebc12
.long 0xbec3ef15,0xbf039c3d,0xbf226799,0xbf3daef9,0xbf039c3d,0xbf239da9,0xbf3fc767,0xbf577026
.long 0xbf226799,0xbf3fc767,0xbf584853,0xbf6b4b0c,0xbf3daef9,0xbf577026,0xbf6b4b0c,0xbf78b47b
.long 0xbf54db31,0xbf6a09a7,0xbf7853f8,0xbf7f4e6d,0xbf676bd8,0xbf772417,0xbf7f0e58,0xbf7eea9d
.long 0xbf74fa0b,0xbf7e70b0,0xbf7f4e6d,0xbf778bc5,0xbf7d3aac,0xbf7fc38f,0xbf791298,0xbf696591
.long 0x0,0x0,0x0,0x0,0x3e2f10a2,0x3e354098,0x3e3b6ecf,0x3e419b37
.long 0x3eac7cd4,0x3eb263ef,0x3eb8442a,0x3ebe1d4a,0x3efc5d27,0x3f0242b1,0x3f064b82,0x3f0a48ad
.long 0x3f226799,0x3f273656,0x3f2beb4a,0x3f3085bb,0x3f41d870,0x3f46e22a,0x3f4bbbf8,0x3f5064af
.long 0x3f5b941a,0x3f604621,0x3f64aa59,0x3f68bf3c,0x3f6ed89e,0x3f7294f8,0x3f75dec6,0x3f78b47b
.long 0x3f7b14be,0x3f7d3aac,0x3f7ec46d,0x3f7fb10f,0x3f7fec43,0x3f7fe129,0x3f7f0e58,0x3f7d7474
.long 0x3f7d3aac,0x3f7a7302,0x3f76ba07,0x3f721352,0x3f731447,0x3f6d1c1d,0x3f660f88,0x3f5df6be
.long 0x3f61c598,0x3f584853,0x3f4d9f02,0x3f41d870,0x3f49d112,0x3f3ca003,0x3f2e3bde,0x3f1ebc12
.long 0x3f2beb4a,0x3f1b02c6,0x3f08f59b,0x3eebcbbb,0x3f08f59b,0x3ee900b7,0x3ebe1d4a,0x3e919ddd
.long 0x3ec3ef15,0x3e94a031,0x3e47c5c2,0x3dc8bd36,0x3e605c13,0x3dee3876,0x3c490e90,0xbdbc3ac3
.long 0x3d48fb30,0xbd7b2b74,0xbe2f10a2,0xbe8e9a22,0xbdfab273,0xbe72b651,0xbeb263ef,0xbee900b7
.long 0xbe94a031,0xbecf7bca,0xbf039c3d,0xbf1d7fd1,0xbee63375,0xbf0f8784,0xbf299415,0xbf40d0da
.long 0xbf187fc0,0xbf32c8c9,0xbf49d112,0xbf5d2d53,0xbf396842,0xbf5064af,0xbf633c5a,0xbf718f57
.long 0xbf54db31,0xbf676bd8,0xbf74fa0b,0xbf7d3aac,0xbf6a09a7,0xbf772417,0xbf7e70b0,0xbf7fc38f
.long 0xbf7853f8,0xbf7f0e58,0xbf7f4e6d,0xbf791298,0xbf7f4e6d,0xbf7eea9d,0xbf778bc5,0xbf696591
.long 0xbf7ec46d,0xbf76ba07,0xbf676bd8,0xbf514d3d,0xbf76ba07,0xbf66becc,0xbf4f7a1f,0xbf31a81d
.long 0xbf676bd8,0xbf4f7a1f,0xbf3085bb,0xbf0b9a6b,0xbf514d3d,0xbf31a81d,0xbf0b9a6b,0xbec1071e
.long 0x3f803f80,0x3f803f80,0x0,0x0,0x3f7b3f80,0x3f553f6d,0x3e480000,0x3f0e3ec4
.long 0x3f6d3f80,0x3ec43f35,0x3ec40000,0x3f6d3f35,0x3f553f80,0xbe483ec4,0x3f0e0000,0x3f7b3f6d
.long 0x3f353f80,0xbf350000,0x3f350000,0x3f353f80,0x3f0e3f80,0xbf7bbec4,0x3f550000,0x3e483f6d
.long 0x3ec43f80,0xbf6dbf35,0x3f6d0000,0xbec43f35,0x3e483f80,0xbf0ebf6d,0x3f7b0000,0xbf553ec4
.long 0x3f80,0xbf80,0x3f800000,0xbf800000,0xbe483f80,0x3f0ebf6d,0x3f7b0000,0xbf55bec4
.long 0xbec43f80,0x3f6dbf35,0x3f6d0000,0xbec4bf35,0xbf0e3f80,0x3f7bbec4,0x3f550000,0x3e48bf6d
.long 0xbf353f80,0x3f350000,0x3f350000,0x3f35bf80,0xbf553f80,0x3e483ec4,0x3f0e0000,0x3f7bbf6d
.long 0xbf6d3f80,0xbec43f35,0x3ec40000,0x3f6dbf35,0xbf7b3f80,0xbf553f6d,0x3e480000,0x3f0ebec4
.long 0xbf803f80,0xbf803f80,0x0,0x0,0xbf7b3f80,0xbf553f6d,0xbe480000,0xbf0e3ec4
.long 0xbf6d3f80,0xbec43f35,0xbec40000,0xbf6d3f35,0xbf553f80,0x3e483ec4,0xbf0e0000,0xbf7b3f6d
.long 0xbf353f80,0x3f350000,0xbf350000,0xbf353f80,0xbf0e3f80,0x3f7bbec4,0xbf550000,0xbe483f6d
.long 0xbec43f80,0x3f6dbf35,0xbf6d0000,0x3ec43f35,0xbe483f80,0x3f0ebf6d,0xbf7b0000,0x3f553ec4
.long 0x3f80,0xbf80,0xbf800000,0x3f800000,0x3e483f80,0xbf0ebf6d,0xbf7b0000,0x3f55bec4
.long 0x3ec43f80,0xbf6dbf35,0xbf6d0000,0x3ec4bf35,0x3f0e3f80,0xbf7bbec4,0xbf550000,0xbe48bf6d
.long 0x3f353f80,0xbf350000,0xbf350000,0xbf35bf80,0x3f553f80,0xbe483ec4,0xbf0e0000,0xbf7bbf6d
.long 0x3f6d3f80,0x3ec43f35,0xbec40000,0xbf6dbf35,0x3f7b3f80,0x3f553f6d,0xbe480000,0xbf0ebec4
.long 0x3f803f80,0x3f803f80,0x0,0x0,0x3f0e3f35,0x3e483ec4,0x3f553f35,0x3f7b3f6d
.long 0xbec40000,0xbf6dbf35,0x3f6d3f80,0x3ec43f35,0xbf7bbf35,0xbf0ebf6d,0x3e483f35,0xbf55bec4
.long 0xbf35bf80,0x3f350000,0xbf350000,0xbf35bf80,0x3e48bf35,0x3f553f6d,0xbf7bbf35,0x3f0ebec4
.long 0x3f6d0000,0xbec43f35,0xbec4bf80,0x3f6d3f35,0x3f553f35,0xbf7bbec4,0x3f0ebf35,0xbe483f6d
.long 0x3f80,0xbf80,0x3f800000,0xbf800000,0xbf553f35,0x3f7bbec4,0x3f0e3f35,0xbe48bf6d
.long 0xbf6d0000,0x3ec43f35,0xbec43f80,0x3f6dbf35,0xbe48bf35,0xbf553f6d,0xbf7b3f35,0x3f0e3ec4
.long 0x3f35bf80,0xbf350000,0xbf350000,0xbf353f80,0x3f7bbf35,0x3f0ebf6d,0x3e48bf35,0xbf553ec4
.long 0x3ec40000,0x3f6dbf35,0x3f6dbf80,0x3ec4bf35,0xbf0e3f35,0xbe483ec4,0x3f55bf35,0x3f7bbf6d
.long 0xbf803f80,0xbf803f80,0x0,0x0,0xbf0e3f35,0xbe483ec4,0xbf553f35,0xbf7b3f6d
.long 0x3ec40000,0x3f6dbf35,0xbf6d3f80,0xbec43f35,0x3f7bbf35,0x3f0ebf6d,0xbe483f35,0x3f55bec4
.long 0x3f35bf80,0xbf350000,0x3f350000,0x3f35bf80,0xbe48bf35,0xbf553f6d,0x3f7bbf35,0xbf0ebec4
.long 0xbf6d0000,0x3ec43f35,0x3ec4bf80,0xbf6d3f35,0xbf553f35,0x3f7bbec4,0xbf0ebf35,0x3e483f6d
.long 0x3f80,0xbf80,0xbf800000,0x3f800000,0x3f553f35,0xbf7bbec4,0xbf0e3f35,0x3e48bf6d
.long 0x3f6d0000,0xbec43f35,0x3ec43f80,0xbf6dbf35,0x3e48bf35,0x3f553f6d,0x3f7b3f35,0xbf0e3ec4
.long 0xbf35bf80,0x3f350000,0x3f350000,0x3f353f80,0xbf7bbf35,0xbf0ebf6d,0xbe48bf35,0x3f553ec4
.long 0xbec40000,0xbf6dbf35,0xbf6dbf80,0xbec4bf35,0x3f0e3f35,0x3e483ec4,0xbf55bf35,0xbf7bbf6d
.long 0x3f803f80,0x3f803f80,0x0,0x0,0xbe480000,0xbf0ebec4,0x3f7b3f80,0x3f553f6d
.long 0xbf6dbf80,0xbec4bf35,0xbec40000,0xbf6dbf35,0x3f0e0000,0x3f7b3f6d,0xbf55bf80,0x3e48bec4
.long 0x3f353f80,0xbf350000,0x3f350000,0x3f353f80,0xbf550000,0xbe48bf6d,0x3f0e3f80,0xbf7bbec4
.long 0xbec4bf80,0x3f6d3f35,0xbf6d0000,0x3ec4bf35,0x3f7b0000,0xbf553ec4,0xbe48bf80,0x3f0e3f6d
.long 0x3f80,0xbf80,0x3f800000,0xbf800000,0xbf7b0000,0x3f553ec4,0xbe483f80,0x3f0ebf6d
.long 0x3ec4bf80,0xbf6d3f35,0xbf6d0000,0x3ec43f35,0x3f550000,0x3e48bf6d,0x3f0ebf80,0xbf7b3ec4
.long 0xbf353f80,0x3f350000,0x3f350000,0x3f35bf80,0xbf0e0000,0xbf7b3f6d,0xbf553f80,0x3e483ec4
.long 0x3f6dbf80,0x3ec4bf35,0xbec40000,0xbf6d3f35,0x3e480000,0x3f0ebec4,0x3f7bbf80,0x3f55bf6d
.long 0xbf803f80,0xbf803f80,0x0,0x0,0x3e480000,0x3f0ebec4,0xbf7b3f80,0xbf553f6d
.long 0x3f6dbf80,0x3ec4bf35,0x3ec40000,0x3f6dbf35,0xbf0e0000,0xbf7b3f6d,0x3f55bf80,0xbe48bec4
.long 0xbf353f80,0x3f350000,0xbf350000,0xbf353f80,0x3f550000,0x3e48bf6d,0xbf0e3f80,0x3f7bbec4
.long 0x3ec4bf80,0xbf6d3f35,0x3f6d0000,0xbec4bf35,0xbf7b0000,0x3f553ec4,0x3e48bf80,0xbf0e3f6d
.long 0x3f80,0xbf80,0xbf800000,0x3f800000,0x3f7b0000,0xbf553ec4,0x3e483f80,0xbf0ebf6d
.long 0xbec4bf80,0x3f6d3f35,0x3f6d0000,0xbec43f35,0xbf550000,0xbe48bf6d,0xbf0ebf80,0x3f7b3ec4
.long 0x3f353f80,0xbf350000,0xbf350000,0xbf35bf80,0x3f0e0000,0x3f7b3f6d,0x3f553f80,0xbe483ec4
.long 0xbf6dbf80,0xbec4bf35,0x3ec40000,0x3f6d3f35,0xbe480000,0xbf0ebec4,0xbf7bbf80,0xbf55bf6d
.long 0x3f803f80,0x3f803f80,0x0,0x0,0xbf55bf35,0xbf7bbf6d,0x3f0e3f35,0x3e483ec4
.long 0x3ec40000,0x3f6d3f35,0xbf6dbf80,0xbec4bf35,0x3e483f35,0xbf55bec4,0x3f7b3f35,0x3f0e3f6d
.long 0xbf35bf80,0x3f350000,0xbf350000,0xbf35bf80,0x3f7b3f35,0xbf0e3ec4,0x3e48bf35,0x3f553f6d
.long 0xbf6d0000,0x3ec4bf35,0x3ec43f80,0xbf6dbf35,0x3f0ebf35,0xbe483f6d,0xbf55bf35,0x3f7b3ec4
.long 0x3f80,0xbf80,0x3f800000,0xbf800000,0xbf0ebf35,0x3e483f6d,0xbf553f35,0x3f7bbec4
.long 0x3f6d0000,0xbec4bf35,0x3ec4bf80,0xbf6d3f35,0xbf7b3f35,0x3f0e3ec4,0x3e483f35,0x3f55bf6d
.long 0x3f35bf80,0xbf350000,0xbf350000,0xbf353f80,0xbe483f35,0x3f55bec4,0x3f7bbf35,0x3f0ebf6d
.long 0xbec40000,0xbf6d3f35,0xbf6d3f80,0xbec43f35,0x3f55bf35,0x3f7bbf6d,0x3f0ebf35,0x3e48bec4
.long 0xbf803f80,0xbf803f80,0x0,0x0,0x3f55bf35,0x3f7bbf6d,0xbf0e3f35,0xbe483ec4
.long 0xbec40000,0xbf6d3f35,0x3f6dbf80,0x3ec4bf35,0xbe483f35,0x3f55bec4,0xbf7b3f35,0xbf0e3f6d
.long 0x3f35bf80,0xbf350000,0x3f350000,0x3f35bf80,0xbf7b3f35,0x3f0e3ec4,0xbe48bf35,0xbf553f6d
.long 0x3f6d0000,0xbec4bf35,0xbec43f80,0x3f6dbf35,0xbf0ebf35,0x3e483f6d,0x3f55bf35,0xbf7b3ec4
.long 0x3f80,0xbf80,0xbf800000,0x3f800000,0x3f0ebf35,0xbe483f6d,0x3f553f35,0xbf7bbec4
.long 0xbf6d0000,0x3ec4bf35,0xbec4bf80,0x3f6d3f35,0x3f7b3f35,0xbf0e3ec4,0xbe483f35,0xbf55bf6d
.long 0xbf35bf80,0x3f350000,0x3f350000,0x3f353f80,0x3e483f35,0xbf55bec4,0xbf7bbf35,0xbf0ebf6d
.long 0x3ec40000,0x3f6d3f35,0x3f6d3f80,0x3ec43f35,0xbf55bf35,0xbf7bbf6d,0xbf0ebf35,0xbe48bec4
.long 0x3f803f80,0x3f803f80,0x0,0x0,0xbf7bbf80,0xbf55bf6d,0xbe480000,0xbf0ebec4
.long 0x3f6d3f80,0x3ec43f35,0x3ec40000,0x3f6d3f35,0xbf55bf80,0x3e48bec4,0xbf0e0000,0xbf7bbf6d
.long 0x3f353f80,0xbf350000,0x3f350000,0x3f353f80,0xbf0ebf80,0x3f7b3ec4,0xbf550000,0xbe48bf6d
.long 0x3ec43f80,0xbf6dbf35,0x3f6d0000,0xbec43f35,0xbe48bf80,0x3f0e3f6d,0xbf7b0000,0x3f55bec4
.long 0x3f80,0xbf80,0x3f800000,0xbf800000,0x3e48bf80,0xbf0e3f6d,0xbf7b0000,0x3f553ec4
.long 0xbec43f80,0x3f6dbf35,0x3f6d0000,0xbec4bf35,0x3f0ebf80,0xbf7b3ec4,0xbf550000,0xbe483f6d
.long 0xbf353f80,0x3f350000,0x3f350000,0x3f35bf80,0x3f55bf80,0xbe48bec4,0xbf0e0000,0xbf7b3f6d
.long 0xbf6d3f80,0xbec43f35,0x3ec40000,0x3f6dbf35,0x3f7bbf80,0x3f55bf6d,0xbe480000,0xbf0e3ec4
.long 0xbf803f80,0xbf803f80,0x0,0x0,0x3f7bbf80,0x3f55bf6d,0x3e480000,0x3f0ebec4
.long 0xbf6d3f80,0xbec43f35,0xbec40000,0xbf6d3f35,0x3f55bf80,0xbe48bec4,0x3f0e0000,0x3f7bbf6d
.long 0xbf353f80,0x3f350000,0xbf350000,0xbf353f80,0x3f0ebf80,0xbf7b3ec4,0x3f550000,0x3e48bf6d
.long 0xbec43f80,0x3f6dbf35,0xbf6d0000,0x3ec43f35,0x3e48bf80,0xbf0e3f6d,0x3f7b0000,0xbf55bec4
.long 0x3f80,0xbf80,0xbf800000,0x3f800000,0xbe48bf80,0x3f0e3f6d,0x3f7b0000,0xbf553ec4
.long 0x3ec43f80,0xbf6dbf35,0xbf6d0000,0x3ec4bf35,0xbf0ebf80,0x3f7b3ec4,0x3f550000,0x3e483f6d
.long 0x3f353f80,0xbf350000,0xbf350000,0xbf35bf80,0xbf55bf80,0x3e48bec4,0x3f0e0000,0x3f7b3f6d
.long 0x3f6d3f80,0x3ec43f35,0xbec40000,0xbf6dbf35,0xbf7bbf80,0xbf55bf6d,0x3e480000,0x3f0e3ec4
.long 0x3f803f80,0x3f803f80,0x0,0x0,0xbf0ebf35,0xbe48bec4,0xbf55bf35,0xbf7bbf6d
.long 0xbec40000,0xbf6dbf35,0x3f6d3f80,0x3ec43f35,0x3f7b3f35,0x3f0e3f6d,0xbe48bf35,0x3f553ec4
.long 0xbf35bf80,0x3f350000,0xbf350000,0xbf35bf80,0xbe483f35,0xbf55bf6d,0x3f7b3f35,0xbf0e3ec4
.long 0x3f6d0000,0xbec43f35,0xbec4bf80,0x3f6d3f35,0xbf55bf35,0x3f7b3ec4,0xbf0e3f35,0x3e48bf6d
.long 0x3f80,0xbf80,0x3f800000,0xbf800000,0x3f55bf35,0xbf7b3ec4,0xbf0ebf35,0x3e483f6d
.long 0xbf6d0000,0x3ec43f35,0xbec43f80,0x3f6dbf35,0x3e483f35,0x3f55bf6d,0x3f7bbf35,0xbf0ebec4
.long 0x3f35bf80,0xbf350000,0xbf350000,0xbf353f80,0xbf7b3f35,0xbf0e3f6d,0xbe483f35,0x3f55bec4
.long 0x3ec40000,0x3f6dbf35,0x3f6dbf80,0x3ec4bf35,0x3f0ebf35,0x3e48bec4,0xbf553f35,0xbf7b3f6d
.long 0xbf803f80,0xbf803f80,0x0,0x0,0x3f0ebf35,0x3e48bec4,0x3f55bf35,0x3f7bbf6d
.long 0x3ec40000,0x3f6dbf35,0xbf6d3f80,0xbec43f35,0xbf7b3f35,0xbf0e3f6d,0x3e48bf35,0xbf553ec4
.long 0x3f35bf80,0xbf350000,0x3f350000,0x3f35bf80,0x3e483f35,0x3f55bf6d,0xbf7b3f35,0x3f0e3ec4
.long 0xbf6d0000,0x3ec43f35,0x3ec4bf80,0xbf6d3f35,0x3f55bf35,0xbf7b3ec4,0x3f0e3f35,0xbe48bf6d
.long 0x3f80,0xbf80,0xbf800000,0x3f800000,0xbf55bf35,0x3f7b3ec4,0x3f0ebf35,0xbe483f6d
.long 0x3f6d0000,0xbec43f35,0x3ec43f80,0xbf6dbf35,0xbe483f35,0xbf55bf6d,0xbf7bbf35,0x3f0ebec4
.long 0xbf35bf80,0x3f350000,0x3f350000,0x3f353f80,0x3f7b3f35,0x3f0e3f6d,0x3e483f35,0xbf55bec4
.long 0xbec40000,0xbf6dbf35,0xbf6dbf80,0xbec4bf35,0xbf0ebf35,0xbe48bec4,0x3f553f35,0x3f7b3f6d
.long 0x3f803f80,0x3f803f80,0x0,0x0,0x3e480000,0x3f0e3ec4,0xbf7bbf80,0xbf55bf6d
.long 0xbf6dbf80,0xbec4bf35,0xbec40000,0xbf6dbf35,0xbf0e0000,0xbf7bbf6d,0x3f553f80,0xbe483ec4
.long 0x3f353f80,0xbf350000,0x3f350000,0x3f353f80,0x3f550000,0x3e483f6d,0xbf0ebf80,0x3f7b3ec4
.long 0xbec4bf80,0x3f6d3f35,0xbf6d0000,0x3ec4bf35,0xbf7b0000,0x3f55bec4,0x3e483f80,0xbf0ebf6d
.long 0x3f80,0xbf80,0x3f800000,0xbf800000,0x3f7b0000,0xbf55bec4,0x3e48bf80,0xbf0e3f6d
.long 0x3ec4bf80,0xbf6d3f35,0xbf6d0000,0x3ec43f35,0xbf550000,0xbe483f6d,0xbf0e3f80,0x3f7bbec4
.long 0xbf353f80,0x3f350000,0x3f350000,0x3f35bf80,0x3f0e0000,0x3f7bbf6d,0x3f55bf80,0xbe48bec4
.long 0x3f6dbf80,0x3ec4bf35,0xbec40000,0xbf6d3f35,0xbe480000,0xbf0e3ec4,0xbf7b3f80,0xbf553f6d
.long 0xbf803f80,0xbf803f80,0x0,0x0,0xbe480000,0xbf0e3ec4,0x3f7bbf80,0x3f55bf6d
.long 0x3f6dbf80,0x3ec4bf35,0x3ec40000,0x3f6dbf35,0x3f0e0000,0x3f7bbf6d,0xbf553f80,0x3e483ec4
.long 0xbf353f80,0x3f350000,0xbf350000,0xbf353f80,0xbf550000,0xbe483f6d,0x3f0ebf80,0xbf7b3ec4
.long 0x3ec4bf80,0xbf6d3f35,0x3f6d0000,0xbec4bf35,0x3f7b0000,0xbf55bec4,0xbe483f80,0x3f0ebf6d
.long 0x3f80,0xbf80,0xbf800000,0x3f800000,0xbf7b0000,0x3f55bec4,0xbe48bf80,0x3f0e3f6d
.long 0xbec4bf80,0x3f6d3f35,0x3f6d0000,0xbec43f35,0x3f550000,0x3e483f6d,0x3f0e3f80,0xbf7bbec4
.long 0x3f353f80,0xbf350000,0xbf350000,0xbf35bf80,0xbf0e0000,0xbf7bbf6d,0xbf55bf80,0x3e48bec4
.long 0xbf6dbf80,0xbec4bf35,0x3ec40000,0x3f6d3f35,0x3e480000,0x3f0e3ec4,0x3f7b3f80,0x3f553f6d
.long 0x3f803f80,0x3f803f80,0x0,0x0,0x3f553f35,0x3f7b3f6d,0xbf0ebf35,0xbe48bec4
.long 0x3ec40000,0x3f6d3f35,0xbf6dbf80,0xbec4bf35,0xbe48bf35,0x3f553ec4,0xbf7bbf35,0xbf0ebf6d
.long 0xbf35bf80,0x3f350000,0xbf350000,0xbf35bf80,0xbf7bbf35,0x3f0ebec4,0xbe483f35,0xbf55bf6d
.long 0xbf6d0000,0x3ec4bf35,0x3ec43f80,0xbf6dbf35,0xbf0e3f35,0x3e48bf6d,0x3f553f35,0xbf7bbec4
.long 0x3f80,0xbf80,0x3f800000,0xbf800000,0x3f0e3f35,0xbe48bf6d,0x3f55bf35,0xbf7b3ec4
.long 0x3f6d0000,0xbec4bf35,0x3ec4bf80,0xbf6d3f35,0x3f7bbf35,0xbf0ebec4,0xbe48bf35,0xbf553f6d
.long 0x3f35bf80,0xbf350000,0xbf350000,0xbf353f80,0x3e48bf35,0xbf553ec4,0xbf7b3f35,0xbf0e3f6d
.long 0xbec40000,0xbf6d3f35,0xbf6d3f80,0xbec43f35,0xbf553f35,0xbf7b3f6d,0xbf0e3f35,0xbe483ec4
.long 0xbf803f80,0xbf803f80,0x0,0x0,0xbf553f35,0xbf7b3f6d,0x3f0ebf35,0x3e48bec4
.long 0xbec40000,0xbf6d3f35,0x3f6dbf80,0x3ec4bf35,0x3e48bf35,0xbf553ec4,0x3f7bbf35,0x3f0ebf6d
.long 0x3f35bf80,0xbf350000,0x3f350000,0x3f35bf80,0x3f7bbf35,0xbf0ebec4,0x3e483f35,0x3f55bf6d
.long 0x3f6d0000,0xbec4bf35,0xbec43f80,0x3f6dbf35,0x3f0e3f35,0xbe48bf6d,0xbf553f35,0x3f7bbec4
.long 0x3f80,0xbf80,0xbf800000,0x3f800000,0xbf0e3f35,0x3e48bf6d,0xbf55bf35,0x3f7b3ec4
.long 0xbf6d0000,0x3ec4bf35,0xbec4bf80,0x3f6d3f35,0xbf7bbf35,0x3f0ebec4,0x3e48bf35,0x3f553f6d
.long 0xbf35bf80,0x3f350000,0x3f350000,0x3f353f80,0xbe48bf35,0x3f553ec4,0x3f7b3f35,0x3f0e3f6d
.long 0x3ec40000,0x3f6d3f35,0x3f6d3f80,0x3ec43f35,0x3f553f35,0x3f7b3f6d,0x3f0e3f35,0x3e483ec4
.long 0x80008000,0x80008000,0x3f803f80,0x3f803f80,0xbe488000,0xbf0ebec4,0x3f7b3f80,0x3f553f6d
.long 0xbec48000,0xbf6dbf35,0x3f6d3f80,0x3ec43f35,0xbf0e8000,0xbf7bbf6d,0x3f553f80,0xbe483ec4
.long 0xbf358000,0xbf35bf80,0x3f353f80,0xbf350000,0xbf558000,0xbe48bf6d,0x3f0e3f80,0xbf7bbec4
.long 0xbf6d8000,0x3ec4bf35,0x3ec43f80,0xbf6dbf35,0xbf7b8000,0x3f55bec4,0x3e483f80,0xbf0ebf6d
.long 0xbf808000,0x3f808000,0x3f80,0xbf80,0xbf7b8000,0x3f553ec4,0xbe483f80,0x3f0ebf6d
.long 0xbf6d8000,0x3ec43f35,0xbec43f80,0x3f6dbf35,0xbf558000,0xbe483f6d,0xbf0e3f80,0x3f7bbec4
.long 0xbf358000,0xbf353f80,0xbf353f80,0x3f350000,0xbf0e8000,0xbf7b3f6d,0xbf553f80,0x3e483ec4
.long 0xbec48000,0xbf6d3f35,0xbf6d3f80,0xbec43f35,0xbe488000,0xbf0e3ec4,0xbf7b3f80,0xbf553f6d
.long 0x80008000,0x80008000,0xbf803f80,0xbf803f80,0x3e488000,0x3f0ebec4,0xbf7b3f80,0xbf553f6d
.long 0x3ec48000,0x3f6dbf35,0xbf6d3f80,0xbec43f35,0x3f0e8000,0x3f7bbf6d,0xbf553f80,0x3e483ec4
.long 0x3f358000,0x3f35bf80,0xbf353f80,0x3f350000,0x3f558000,0x3e48bf6d,0xbf0e3f80,0x3f7bbec4
.long 0x3f6d8000,0xbec4bf35,0xbec43f80,0x3f6dbf35,0x3f7b8000,0xbf55bec4,0xbe483f80,0x3f0ebf6d
.long 0x3f808000,0xbf808000,0x3f80,0xbf80,0x3f7b8000,0xbf553ec4,0x3e483f80,0xbf0ebf6d
.long 0x3f6d8000,0xbec43f35,0x3ec43f80,0xbf6dbf35,0x3f558000,0x3e483f6d,0x3f0e3f80,0xbf7bbec4
.long 0x3f358000,0x3f353f80,0x3f353f80,0xbf350000,0x3f0e8000,0x3f7b3f6d,0x3f553f80,0xbe483ec4
.long 0x3ec48000,0x3f6d3f35,0x3f6d3f80,0x3ec43f35,0x3e488000,0x3f0e3ec4,0x3f7b3f80,0x3f553f6d
.long 0x80008000,0x80008000,0x3f803f80,0x3f803f80,0xbf55bf35,0xbf7bbf6d,0x3f0e3f35,0x3e483ec4
.long 0xbf6dbf80,0xbec4bf35,0xbec40000,0xbf6dbf35,0xbe48bf35,0x3f553ec4,0xbf7bbf35,0xbf0ebf6d
.long 0x3f358000,0x3f353f80,0xbf35bf80,0x3f350000,0x3f7b3f35,0xbf0e3ec4,0x3e48bf35,0x3f553f6d
.long 0x3ec43f80,0xbf6dbf35,0x3f6d0000,0xbec43f35,0xbf0e3f35,0x3e48bf6d,0x3f553f35,0xbf7bbec4
.long 0xbf808000,0x3f808000,0x3f80,0xbf80,0xbf0ebf35,0x3e483f6d,0xbf553f35,0x3f7bbec4
.long 0x3ec4bf80,0xbf6d3f35,0xbf6d0000,0x3ec43f35,0x3f7bbf35,0xbf0ebec4,0xbe48bf35,0xbf553f6d
.long 0x3f358000,0x3f35bf80,0x3f35bf80,0xbf350000,0xbe483f35,0x3f55bec4,0x3f7bbf35,0x3f0ebf6d
.long 0xbf6d3f80,0xbec43f35,0x3ec40000,0x3f6dbf35,0xbf553f35,0xbf7b3f6d,0xbf0e3f35,0xbe483ec4
.long 0x80008000,0x80008000,0xbf803f80,0xbf803f80,0x3f55bf35,0x3f7bbf6d,0xbf0e3f35,0xbe483ec4
.long 0x3f6dbf80,0x3ec4bf35,0x3ec40000,0x3f6dbf35,0x3e48bf35,0xbf553ec4,0x3f7bbf35,0x3f0ebf6d
.long 0xbf358000,0xbf353f80,0x3f35bf80,0xbf350000,0xbf7b3f35,0x3f0e3ec4,0xbe48bf35,0xbf553f6d
.long 0xbec43f80,0x3f6dbf35,0xbf6d0000,0x3ec43f35,0x3f0e3f35,0xbe48bf6d,0xbf553f35,0x3f7bbec4
.long 0x3f808000,0xbf808000,0x3f80,0xbf80,0x3f0ebf35,0xbe483f6d,0x3f553f35,0xbf7bbec4
.long 0xbec4bf80,0x3f6d3f35,0x3f6d0000,0xbec43f35,0xbf7bbf35,0x3f0ebec4,0x3e48bf35,0x3f553f6d
.long 0xbf358000,0xbf35bf80,0xbf35bf80,0x3f350000,0x3e483f35,0xbf55bec4,0xbf7bbf35,0xbf0ebf6d
.long 0x3f6d3f80,0x3ec43f35,0xbec40000,0xbf6dbf35,0x3f553f35,0x3f7b3f6d,0x3f0e3f35,0x3e483ec4
.long 0x80008000,0x80008000,0x3f803f80,0x3f803f80,0xbf7bbf80,0xbf55bf6d,0xbe480000,0xbf0ebec4
.long 0x3ec48000,0x3f6d3f35,0xbf6dbf80,0xbec4bf35,0x3f553f80,0xbe483ec4,0x3f0e0000,0x3f7b3f6d
.long 0xbf358000,0xbf35bf80,0x3f353f80,0xbf350000,0xbf0ebf80,0x3f7b3ec4,0xbf550000,0xbe48bf6d
.long 0x3f6d8000,0xbec43f35,0xbec4bf80,0x3f6d3f35,0x3e483f80,0xbf0ebf6d,0x3f7b0000,0xbf553ec4
.long 0xbf808000,0x3f808000,0x3f80,0xbf80,0x3e48bf80,0xbf0e3f6d,0xbf7b0000,0x3f553ec4
.long 0x3f6d8000,0xbec4bf35,0x3ec4bf80,0xbf6d3f35,0xbf0e3f80,0x3f7bbec4,0x3f550000,0x3e48bf6d
.long 0xbf358000,0xbf353f80,0xbf353f80,0x3f350000,0x3f55bf80,0xbe48bec4,0xbf0e0000,0xbf7b3f6d
.long 0x3ec48000,0x3f6dbf35,0x3f6dbf80,0x3ec4bf35,0xbf7b3f80,0xbf553f6d,0x3e480000,0x3f0ebec4
.long 0x80008000,0x80008000,0xbf803f80,0xbf803f80,0x3f7bbf80,0x3f55bf6d,0x3e480000,0x3f0ebec4
.long 0xbec48000,0xbf6d3f35,0x3f6dbf80,0x3ec4bf35,0xbf553f80,0x3e483ec4,0xbf0e0000,0xbf7b3f6d
.long 0x3f358000,0x3f35bf80,0xbf353f80,0x3f350000,0x3f0ebf80,0xbf7b3ec4,0x3f550000,0x3e48bf6d
.long 0xbf6d8000,0x3ec43f35,0x3ec4bf80,0xbf6d3f35,0xbe483f80,0x3f0ebf6d,0xbf7b0000,0x3f553ec4
.long 0x3f808000,0xbf808000,0x3f80,0xbf80,0xbe48bf80,0x3f0e3f6d,0x3f7b0000,0xbf553ec4
.long 0xbf6d8000,0x3ec4bf35,0xbec4bf80,0x3f6d3f35,0x3f0e3f80,0xbf7bbec4,0xbf550000,0xbe48bf6d
.long 0x3f358000,0x3f353f80,0x3f353f80,0xbf350000,0xbf55bf80,0x3e48bec4,0x3f0e0000,0x3f7b3f6d
.long 0xbec48000,0xbf6dbf35,0xbf6dbf80,0xbec4bf35,0x3f7b3f80,0x3f553f6d,0xbe480000,0xbf0ebec4
.long 0x80008000,0x80008000,0x3f803f80,0x3f803f80,0xbf0ebf35,0xbe48bec4,0xbf55bf35,0xbf7bbf6d
.long 0x3f6d3f80,0x3ec43f35,0x3ec40000,0x3f6d3f35,0xbf7bbf35,0xbf0ebf6d,0x3e483f35,0xbf55bec4
.long 0x3f358000,0x3f353f80,0xbf35bf80,0x3f350000,0xbe483f35,0xbf55bf6d,0x3f7b3f35,0xbf0e3ec4
.long 0xbec4bf80,0x3f6d3f35,0xbf6d0000,0x3ec4bf35,0x3f553f35,0xbf7bbec4,0x3f0ebf35,0xbe483f6d
.long 0xbf808000,0x3f808000,0x3f80,0xbf80,0x3f55bf35,0xbf7b3ec4,0xbf0ebf35,0x3e483f6d
.long 0xbec43f80,0x3f6dbf35,0x3f6d0000,0xbec4bf35,0xbe48bf35,0xbf553f6d,0xbf7b3f35,0x3f0e3ec4
.long 0x3f358000,0x3f35bf80,0x3f35bf80,0xbf350000,0xbf7b3f35,0xbf0e3f6d,0xbe483f35,0x3f55bec4
.long 0x3f6dbf80,0x3ec4bf35,0xbec40000,0xbf6d3f35,0xbf0e3f35,0xbe483ec4,0x3f55bf35,0x3f7bbf6d
.long 0x80008000,0x80008000,0xbf803f80,0xbf803f80,0x3f0ebf35,0x3e48bec4,0x3f55bf35,0x3f7bbf6d
.long 0xbf6d3f80,0xbec43f35,0xbec40000,0xbf6d3f35,0x3f7bbf35,0x3f0ebf6d,0xbe483f35,0x3f55bec4
.long 0xbf358000,0xbf353f80,0x3f35bf80,0xbf350000,0x3e483f35,0x3f55bf6d,0xbf7b3f35,0x3f0e3ec4
.long 0x3ec4bf80,0xbf6d3f35,0x3f6d0000,0xbec4bf35,0xbf553f35,0x3f7bbec4,0xbf0ebf35,0x3e483f6d
.long 0x3f808000,0xbf808000,0x3f80,0xbf80,0xbf55bf35,0x3f7b3ec4,0x3f0ebf35,0xbe483f6d
.long 0x3ec43f80,0xbf6dbf35,0xbf6d0000,0x3ec4bf35,0x3e48bf35,0x3f553f6d,0x3f7b3f35,0xbf0e3ec4
.long 0xbf358000,0xbf35bf80,0xbf35bf80,0x3f350000,0x3f7b3f35,0x3f0e3f6d,0x3e483f35,0xbf55bec4
.long 0xbf6dbf80,0xbec4bf35,0x3ec40000,0x3f6d3f35,0x3f0e3f35,0x3e483ec4,0xbf55bf35,0xbf7bbf6d
.long 0x80008000,0x80008000,0x3f803f80,0x3f803f80,0x3e488000,0x3f0e3ec4,0xbf7bbf80,0xbf55bf6d
.long 0xbec48000,0xbf6dbf35,0x3f6d3f80,0x3ec43f35,0x3f0e8000,0x3f7b3f6d,0xbf55bf80,0x3e48bec4
.long 0xbf358000,0xbf35bf80,0x3f353f80,0xbf350000,0x3f558000,0x3e483f6d,0xbf0ebf80,0x3f7b3ec4
.long 0xbf6d8000,0x3ec4bf35,0x3ec43f80,0xbf6dbf35,0x3f7b8000,0xbf553ec4,0xbe48bf80,0x3f0e3f6d
.long 0xbf808000,0x3f808000,0x3f80,0xbf80,0x3f7b8000,0xbf55bec4,0x3e48bf80,0xbf0e3f6d
.long 0xbf6d8000,0x3ec43f35,0xbec43f80,0x3f6dbf35,0x3f558000,0x3e48bf6d,0x3f0ebf80,0xbf7b3ec4
.long 0xbf358000,0xbf353f80,0xbf353f80,0x3f350000,0x3f0e8000,0x3f7bbf6d,0x3f55bf80,0xbe48bec4
.long 0xbec48000,0xbf6d3f35,0xbf6d3f80,0xbec43f35,0x3e488000,0x3f0ebec4,0x3f7bbf80,0x3f55bf6d
.long 0x80008000,0x80008000,0xbf803f80,0xbf803f80,0xbe488000,0xbf0e3ec4,0x3f7bbf80,0x3f55bf6d
.long 0x3ec48000,0x3f6dbf35,0xbf6d3f80,0xbec43f35,0xbf0e8000,0xbf7b3f6d,0x3f55bf80,0xbe48bec4
.long 0x3f358000,0x3f35bf80,0xbf353f80,0x3f350000,0xbf558000,0xbe483f6d,0x3f0ebf80,0xbf7b3ec4
.long 0x3f6d8000,0xbec4bf35,0xbec43f80,0x3f6dbf35,0xbf7b8000,0x3f553ec4,0x3e48bf80,0xbf0e3f6d
.long 0x3f808000,0xbf808000,0x3f80,0xbf80,0xbf7b8000,0x3f55bec4,0xbe48bf80,0x3f0e3f6d
.long 0x3f6d8000,0xbec43f35,0x3ec43f80,0xbf6dbf35,0xbf558000,0xbe48bf6d,0xbf0ebf80,0x3f7b3ec4
.long 0x3f358000,0x3f353f80,0x3f353f80,0xbf350000,0xbf0e8000,0xbf7bbf6d,0xbf55bf80,0x3e48bec4
.long 0x3ec48000,0x3f6d3f35,0x3f6d3f80,0x3ec43f35,0xbe488000,0xbf0ebec4,0xbf7bbf80,0xbf55bf6d
.long 0x80008000,0x80008000,0x3f803f80,0x3f803f80,0x3f553f35,0x3f7b3f6d,0xbf0ebf35,0xbe48bec4
.long 0xbf6dbf80,0xbec4bf35,0xbec40000,0xbf6dbf35,0x3e483f35,0xbf55bec4,0x3f7b3f35,0x3f0e3f6d
.long 0x3f358000,0x3f353f80,0xbf35bf80,0x3f350000,0xbf7bbf35,0x3f0ebec4,0xbe483f35,0xbf55bf6d
.long 0x3ec43f80,0xbf6dbf35,0x3f6d0000,0xbec43f35,0x3f0ebf35,0xbe483f6d,0xbf55bf35,0x3f7b3ec4
.long 0xbf808000,0x3f808000,0x3f80,0xbf80,0x3f0e3f35,0xbe48bf6d,0x3f55bf35,0xbf7b3ec4
.long 0x3ec4bf80,0xbf6d3f35,0xbf6d0000,0x3ec43f35,0xbf7b3f35,0x3f0e3ec4,0x3e483f35,0x3f55bf6d
.long 0x3f358000,0x3f35bf80,0x3f35bf80,0xbf350000,0x3e48bf35,0xbf553ec4,0xbf7b3f35,0xbf0e3f6d
.long 0xbf6d3f80,0xbec43f35,0x3ec40000,0x3f6dbf35,0x3f55bf35,0x3f7bbf6d,0x3f0ebf35,0x3e48bec4
.long 0x80008000,0x80008000,0xbf803f80,0xbf803f80,0xbf553f35,0xbf7b3f6d,0x3f0ebf35,0x3e48bec4
.long 0x3f6dbf80,0x3ec4bf35,0x3ec40000,0x3f6dbf35,0xbe483f35,0x3f55bec4,0xbf7b3f35,0xbf0e3f6d
.long 0xbf358000,0xbf353f80,0x3f35bf80,0xbf350000,0x3f7bbf35,0xbf0ebec4,0x3e483f35,0x3f55bf6d
.long 0xbec43f80,0x3f6dbf35,0xbf6d0000,0x3ec43f35,0xbf0ebf35,0x3e483f6d,0x3f55bf35,0xbf7b3ec4
.long 0x3f808000,0xbf808000,0x3f80,0xbf80,0xbf0e3f35,0x3e48bf6d,0xbf55bf35,0x3f7b3ec4
.long 0xbec4bf80,0x3f6d3f35,0x3f6d0000,0xbec43f35,0x3f7b3f35,0xbf0e3ec4,0xbe483f35,0xbf55bf6d
.long 0xbf358000,0xbf35bf80,0xbf35bf80,0x3f350000,0xbe48bf35,0x3f553ec4,0x3f7b3f35,0x3f0e3f6d
.long 0x3f6d3f80,0x3ec43f35,0xbec40000,0xbf6dbf35,0xbf55bf35,0xbf7bbf6d,0xbf0ebf35,0xbe48bec4
.long 0x80008000,0x80008000,0x3f803f80,0x3f803f80,0x3f7b3f80,0x3f553f6d,0x3e480000,0x3f0e3ec4
.long 0x3ec48000,0x3f6d3f35,0xbf6dbf80,0xbec4bf35,0xbf55bf80,0x3e48bec4,0xbf0e0000,0xbf7bbf6d
.long 0xbf358000,0xbf35bf80,0x3f353f80,0xbf350000,0x3f0e3f80,0xbf7bbec4,0x3f550000,0x3e483f6d
.long 0x3f6d8000,0xbec43f35,0xbec4bf80,0x3f6d3f35,0xbe48bf80,0x3f0e3f6d,0xbf7b0000,0x3f55bec4
.long 0xbf808000,0x3f808000,0x3f80,0xbf80,0xbe483f80,0x3f0ebf6d,0x3f7b0000,0xbf55bec4
.long 0x3f6d8000,0xbec4bf35,0x3ec4bf80,0xbf6d3f35,0x3f0ebf80,0xbf7b3ec4,0xbf550000,0xbe483f6d
.long 0xbf358000,0xbf353f80,0xbf353f80,0x3f350000,0xbf553f80,0x3e483ec4,0x3f0e0000,0x3f7bbf6d
.long 0x3ec48000,0x3f6dbf35,0x3f6dbf80,0x3ec4bf35,0x3f7bbf80,0x3f55bf6d,0xbe480000,0xbf0e3ec4
.long 0x80008000,0x80008000,0xbf803f80,0xbf803f80,0xbf7b3f80,0xbf553f6d,0xbe480000,0xbf0e3ec4
.long 0xbec48000,0xbf6d3f35,0x3f6dbf80,0x3ec4bf35,0x3f55bf80,0xbe48bec4,0x3f0e0000,0x3f7bbf6d
.long 0x3f358000,0x3f35bf80,0xbf353f80,0x3f350000,0xbf0e3f80,0x3f7bbec4,0xbf550000,0xbe483f6d
.long 0xbf6d8000,0x3ec43f35,0x3ec4bf80,0xbf6d3f35,0x3e48bf80,0xbf0e3f6d,0x3f7b0000,0xbf55bec4
.long 0x3f808000,0xbf808000,0x3f80,0xbf80,0x3e483f80,0xbf0ebf6d,0xbf7b0000,0x3f55bec4
.long 0xbf6d8000,0x3ec4bf35,0xbec4bf80,0x3f6d3f35,0xbf0ebf80,0x3f7b3ec4,0x3f550000,0x3e483f6d
.long 0x3f358000,0x3f353f80,0x3f353f80,0xbf350000,0x3f553f80,0xbe483ec4,0xbf0e0000,0xbf7bbf6d
.long 0xbec48000,0xbf6dbf35,0xbf6dbf80,0xbec4bf35,0xbf7bbf80,0xbf55bf6d,0x3e480000,0x3f0e3ec4
.long 0x80008000,0x80008000,0x3f803f80,0x3f803f80,0x3f0e3f35,0x3e483ec4,0x3f553f35,0x3f7b3f6d
.long 0x3f6d3f80,0x3ec43f35,0x3ec40000,0x3f6d3f35,0x3f7b3f35,0x3f0e3f6d,0xbe48bf35,0x3f553ec4
.long 0x3f358000,0x3f353f80,0xbf35bf80,0x3f350000,0x3e48bf35,0x3f553f6d,0xbf7bbf35,0x3f0ebec4
.long 0xbec4bf80,0x3f6d3f35,0xbf6d0000,0x3ec4bf35,0xbf55bf35,0x3f7b3ec4,0xbf0e3f35,0x3e48bf6d
.long 0xbf808000,0x3f808000,0x3f80,0xbf80,0xbf553f35,0x3f7bbec4,0x3f0e3f35,0xbe48bf6d
.long 0xbec43f80,0x3f6dbf35,0x3f6d0000,0xbec4bf35,0x3e483f35,0x3f55bf6d,0x3f7bbf35,0xbf0ebec4
.long 0x3f358000,0x3f35bf80,0x3f35bf80,0xbf350000,0x3f7bbf35,0x3f0ebf6d,0x3e48bf35,0xbf553ec4
.long 0x3f6dbf80,0x3ec4bf35,0xbec40000,0xbf6d3f35,0x3f0ebf35,0x3e48bec4,0xbf553f35,0xbf7b3f6d
.long 0x80008000,0x80008000,0xbf803f80,0xbf803f80,0xbf0e3f35,0xbe483ec4,0xbf553f35,0xbf7b3f6d
.long 0xbf6d3f80,0xbec43f35,0xbec40000,0xbf6d3f35,0xbf7b3f35,0xbf0e3f6d,0x3e48bf35,0xbf553ec4
.long 0xbf358000,0xbf353f80,0x3f35bf80,0xbf350000,0xbe48bf35,0xbf553f6d,0x3f7bbf35,0xbf0ebec4
.long 0x3ec4bf80,0xbf6d3f35,0x3f6d0000,0xbec4bf35,0x3f55bf35,0xbf7b3ec4,0x3f0e3f35,0xbe48bf6d
.long 0x3f808000,0xbf808000,0x3f80,0xbf80,0x3f553f35,0xbf7bbec4,0xbf0e3f35,0x3e48bf6d
.long 0x3ec43f80,0xbf6dbf35,0xbf6d0000,0x3ec4bf35,0xbe483f35,0xbf55bf6d,0xbf7bbf35,0x3f0ebec4
.long 0xbf358000,0xbf35bf80,0xbf35bf80,0x3f350000,0xbf7bbf35,0xbf0ebf6d,0xbe48bf35,0x3f553ec4
.long 0xbf6dbf80,0xbec4bf35,0x3ec40000,0x3f6d3f35,0xbf0ebf35,0xbe48bec4,0x3f553f35,0x3f7b3f6d
.long 0x3f800000,0x3f7ec46d,0x3f7b14be,0x3f74fa0b,0x3f7fffb1,0x3f7eb069,0x3f7aed37,0x3f74bf62
.long 0x3f7ffec4,0x3f7e9bc9,0x3f7ac516,0x3f748422,0x3f7ffd39,0x3f7e868b,0x3f7a9c59,0x3f74484b
.long 0x3f7ffb11,0x3f7e70b0,0x3f7a7302,0x3f740bdd,0x3f7ff84a,0x3f7e5a38,0x3f7a4910,0x3f73ced9
.long 0x3f7ff4e6,0x3f7e4323,0x3f7a1e84,0x3f73913f,0x3f7ff0e3,0x3f7e2b72,0x3f79f35e,0x3f73530e
.long 0x3f7fec43,0x3f7e1324,0x3f79c79d,0x3f731447,0x3f7fe705,0x3f7dfa38,0x3f799b43,0x3f72d4eb
.long 0x3f7fe129,0x3f7de0b1,0x3f796e4e,0x3f7294f8,0x3f7fdaaf,0x3f7dc68c,0x3f7940c0,0x3f725470
.long 0x3f7fd397,0x3f7dabcc,0x3f791298,0x3f721352,0x3f7fcbe2,0x3f7d906e,0x3f78e3d6,0x3f71d19f
.long 0x3f7fc38f,0x3f7d7474,0x3f78b47b,0x3f718f57,0x3f7fba9e,0x3f7d57de,0x3f788486,0x3f714c7a
.long 0x3f7fb10f,0x3f7d3aac,0x3f7853f8,0x3f710908,0x3f7fa6e3,0x3f7d1cdd,0x3f7822d1,0x3f70c501
.long 0x3f7f9c18,0x3f7cfe73,0x3f77f110,0x3f708066,0x3f7f90b1,0x3f7cdf6c,0x3f77beb7,0x3f703b37
.long 0x3f7f84ab,0x3f7cbfc9,0x3f778bc5,0x3f6ff573,0x3f7f7808,0x3f7c9f8a,0x3f77583a,0x3f6faf1b
.long 0x3f7f6ac7,0x3f7c7eb0,0x3f772417,0x3f6f6830,0x3f7f5ce9,0x3f7c5d3a,0x3f76ef5b,0x3f6f20b0
.long 0x3f7f4e6d,0x3f7c3b28,0x3f76ba07,0x3f6ed89e,0x3f7f3f54,0x3f7c187a,0x3f76841b,0x3f6e8ff8
.long 0x3f7f2f9d,0x3f7bf531,0x3f764d97,0x3f6e46be,0x3f7f1f49,0x3f7bd14d,0x3f76167a,0x3f6dfcf2
.long 0x3f7f0e58,0x3f7baccd,0x3f75dec6,0x3f6db293,0x3f7efcc9,0x3f7b87b2,0x3f75a67b,0x3f6d67a1
.long 0x3f7eea9d,0x3f7b61fc,0x3f756d97,0x3f6d1c1d,0x3f7ed7d4,0x3f7b3bab,0x3f75341d,0x3f6cd007
.long 0x3f6c835e,0x3f61c598,0x3f54db31,0x3f45e403,0x3f6c3624,0x3f61668a,0x3f546b3b,0x3f456439
.long 0x3f6be858,0x3f6106f2,0x3f53fac3,0x3f44e3f5,0x3f6b99fb,0x3f60a6cf,0x3f5389c7,0x3f446337
.long 0x3f6b4b0c,0x3f604621,0x3f531849,0x3f43e200,0x3f6afb8c,0x3f5fe4e9,0x3f52a649,0x3f436051
.long 0x3f6aab7b,0x3f5f8327,0x3f5233c6,0x3f42de29,0x3f6a5ad9,0x3f5f20db,0x3f51c0c2,0x3f425b89
.long 0x3f6a09a7,0x3f5ebe05,0x3f514d3d,0x3f41d870,0x3f69b7e4,0x3f5e5aa6,0x3f50d937,0x3f4154e1
.long 0x3f696591,0x3f5df6be,0x3f5064af,0x3f40d0da,0x3f6912ae,0x3f5d924d,0x3f4fefa8,0x3f404c5c
.long 0x3f68bf3c,0x3f5d2d53,0x3f4f7a1f,0x3f3fc767,0x3f686b39,0x3f5cc7d1,0x3f4f0417,0x3f3f41fc
.long 0x3f6816a8,0x3f5c61c7,0x3f4e8d90,0x3f3ebc1b,0x3f67c187,0x3f5bfb34,0x3f4e1689,0x3f3e35c5
.long 0x3f676bd8,0x3f5b941a,0x3f4d9f02,0x3f3daef9,0x3f671599,0x3f5b2c79,0x3f4d26fd,0x3f3d27b8
.long 0x3f66becc,0x3f5ac450,0x3f4cae79,0x3f3ca003,0x3f666771,0x3f5a5ba0,0x3f4c3578,0x3f3c17d9
.long 0x3f660f88,0x3f59f26a,0x3f4bbbf8,0x3f3b8f3b,0x3f65b710,0x3f5988ad,0x3f4b41fa,0x3f3b0629
.long 0x3f655e0b,0x3f591e6a,0x3f4ac77f,0x3f3a7ca4,0x3f650479,0x3f58b3a1,0x3f4a4c87,0x3f39f2ac
.long 0x3f64aa59,0x3f584853,0x3f49d112,0x3f396842,0x3f644fac,0x3f57dc7f,0x3f495521,0x3f38dd65
.long 0x3f63f473,0x3f577026,0x3f48d8b3,0x3f385216,0x3f6398ac,0x3f570348,0x3f485bca,0x3f37c655
.long 0x3f633c5a,0x3f5695e5,0x3f47de65,0x3f373a23,0x3f62df7b,0x3f5627fe,0x3f476085,0x3f36ad7f
.long 0x3f628210,0x3f55b993,0x3f46e22a,0x3f36206c,0x3f62241a,0x3f554aa4,0x3f466354,0x3f3592e7
.long 0x3f3504f3,0x3f226799,0x3f0e39da,0x3ef15aea,0x3f34768f,0x3f21cbfb,0x3f0d9281,0x3eeff7fb
.long 0x3f33e7bc,0x3f212ff9,0x3f0cead0,0x3eee9479,0x3f33587a,0x3f209393,0x3f0c42c9,0x3eed3063
.long 0x3f32c8c9,0x3f1ff6cb,0x3f0b9a6b,0x3eebcbbb,0x3f3238aa,0x3f1f599f,0x3f0af1b7,0x3eea6681
.long 0x3f31a81d,0x3f1ebc12,0x3f0a48ad,0x3ee900b7,0x3f311722,0x3f1e1e22,0x3f099f4e,0x3ee79a5d
.long 0x3f3085bb,0x3f1d7fd1,0x3f08f59b,0x3ee63375,0x3f2ff3e6,0x3f1ce11f,0x3f084b92,0x3ee4cbfe
.long 0x3f2f61a5,0x3f1c420c,0x3f07a136,0x3ee363fa,0x3f2ecef7,0x3f1ba299,0x3f06f686,0x3ee1fb6a
.long 0x3f2e3bde,0x3f1b02c6,0x3f064b82,0x3ee0924f,0x3f2da859,0x3f1a6293,0x3f05a02c,0x3edf28a9
.long 0x3f2d1469,0x3f19c200,0x3f04f484,0x3eddbe79,0x3f2c800f,0x3f19210f,0x3f044889,0x3edc53c1
.long 0x3f2beb4a,0x3f187fc0,0x3f039c3d,0x3edae880,0x3f2b561b,0x3f17de12,0x3f02ef9f,0x3ed97cb9
.long 0x3f2ac082,0x3f173c07,0x3f0242b1,0x3ed8106b,0x3f2a2a80,0x3f16999f,0x3f019573,0x3ed6a399
.long 0x3f299415,0x3f15f6d9,0x3f00e7e4,0x3ed53641,0x3f28fd41,0x3f1553b7,0x3f003a06,0x3ed3c867
.long 0x3f286605,0x3f14b039,0x3eff17b2,0x3ed25a09,0x3f27ce61,0x3f140c5f,0x3efdbabb,0x3ed0eb2a
.long 0x3f273656,0x3f13682a,0x3efc5d27,0x3ecf7bca,0x3f269de3,0x3f12c39a,0x3efafef7,0x3ece0bea
.long 0x3f26050a,0x3f121eb0,0x3ef9a02d,0x3ecc9b8b,0x3f256bcb,0x3f11796b,0x3ef840c8,0x3ecb2aae
.long 0x3f24d225,0x3f10d3cd,0x3ef6e0cb,0x3ec9b953,0x3f24381a,0x3f102dd5,0x3ef58035,0x3ec8477c
.long 0x3f239da9,0x3f0f8784,0x3ef41f07,0x3ec6d529,0x3f2302d3,0x3f0ee0db,0x3ef2bd43,0x3ec5625c
.long 0x3ec3ef15,0x3e94a031,0x3e47c5c2,0x3dc8bd36,0x3ec27b55,0x3e931f35,0x3e44b0b9,0x3dc27c39
.long 0x3ec1071e,0x3e919ddd,0x3e419b37,0x3dbc3ac3,0x3ebf926f,0x3e901c2c,0x3e3e853e,0x3db5f8da
.long 0x3ebe1d4a,0x3e8e9a22,0x3e3b6ecf,0x3dafb680,0x3ebca7af,0x3e8d17c0,0x3e3857ec,0x3da973ba
.long 0x3ebb31a0,0x3e8b9507,0x3e354098,0x3da3308c,0x3eb9bb1e,0x3e8a11f7,0x3e3228d4,0x3d9cecf9
.long 0x3eb8442a,0x3e888e93,0x3e2f10a2,0x3d96a905,0x3eb6ccc3,0x3e870ada,0x3e2bf804,0x3d9064b4
.long 0x3eb554ec,0x3e8586ce,0x3e28defc,0x3d8a200a,0x3eb3dca5,0x3e840270,0x3e25c58c,0x3d83db0a
.long 0x3eb263ef,0x3e827dc0,0x3e22abb6,0x3d7b2b74,0x3eb0eacb,0x3e80f8c0,0x3e1f917b,0x3d6ea038
.long 0x3eaf713a,0x3e7ee6e1,0x3e1c76de,0x3d621469,0x3eadf73c,0x3e7bdba4,0x3e195be0,0x3d55880e
.long 0x3eac7cd4,0x3e78cfcc,0x3e164083,0x3d48fb30,0x3eab0201,0x3e75c35a,0x3e1324ca,0x3d3c6dd5
.long 0x3ea986c4,0x3e72b651,0x3e1008b7,0x3d2fe007,0x3ea80b1f,0x3e6fa8b2,0x3e0cec4a,0x3d2351cb
.long 0x3ea68f12,0x3e6c9a7f,0x3e09cf86,0x3d16c32c,0x3ea5129f,0x3e698bba,0x3e06b26e,0x3d0a342f
.long 0x3ea395c5,0x3e667c66,0x3e039502,0x3cfb49ba,0x3ea21887,0x3e636c83,0x3e007745,0x3ce22a7a
.long 0x3ea09ae5,0x3e605c13,0x3dfab273,0x3cc90ab0,0x3e9f1cdf,0x3e5d4b1a,0x3df475c0,0x3cafea69
.long 0x3e9d9e78,0x3e5a3997,0x3dee3876,0x3c96c9b6,0x3e9c1faf,0x3e57278f,0x3de7fa9a,0x3c7b514b
.long 0x3e9aa086,0x3e541501,0x3de1bc2e,0x3c490e90,0x3e9920fe,0x3e5101f1,0x3ddb7d37,0x3c16cb58
.long 0x3e97a117,0x3e4dee60,0x3dd53db9,0x3bc90f88,0x3e9620d2,0x3e4ada4f,0x3dcefdb7,0x3b490fc6
.long 0x0,0xbdc8bd36,0xbe47c5c2,0xbe94a031,0xbb490fc6,0xbdcefdb7,0xbe4ada4f,0xbe9620d2
.long 0xbbc90f88,0xbdd53db9,0xbe4dee60,0xbe97a117,0xbc16cb58,0xbddb7d37,0xbe5101f1,0xbe9920fe
.long 0xbc490e90,0xbde1bc2e,0xbe541501,0xbe9aa086,0xbc7b514b,0xbde7fa9a,0xbe57278f,0xbe9c1faf
.long 0xbc96c9b6,0xbdee3876,0xbe5a3997,0xbe9d9e78,0xbcafea69,0xbdf475c0,0xbe5d4b1a,0xbe9f1cdf
.long 0xbcc90ab0,0xbdfab273,0xbe605c13,0xbea09ae5,0xbce22a7a,0xbe007745,0xbe636c83,0xbea21887
.long 0xbcfb49ba,0xbe039502,0xbe667c66,0xbea395c5,0xbd0a342f,0xbe06b26e,0xbe698bba,0xbea5129f
.long 0xbd16c32c,0xbe09cf86,0xbe6c9a7f,0xbea68f12,0xbd2351cb,0xbe0cec4a,0xbe6fa8b2,0xbea80b1f
.long 0xbd2fe007,0xbe1008b7,0xbe72b651,0xbea986c4,0xbd3c6dd5,0xbe1324ca,0xbe75c35a,0xbeab0201
.long 0xbd48fb30,0xbe164083,0xbe78cfcc,0xbeac7cd4,0xbd55880e,0xbe195be0,0xbe7bdba4,0xbeadf73c
.long 0xbd621469,0xbe1c76de,0xbe7ee6e1,0xbeaf713a,0xbd6ea038,0xbe1f917b,0xbe80f8c0,0xbeb0eacb
.long 0xbd7b2b74,0xbe22abb6,0xbe827dc0,0xbeb263ef,0xbd83db0a,0xbe25c58c,0xbe840270,0xbeb3dca5
.long 0xbd8a200a,0xbe28defc,0xbe8586ce,0xbeb554ec,0xbd9064b4,0xbe2bf804,0xbe870ada,0xbeb6ccc3
.long 0xbd96a905,0xbe2f10a2,0xbe888e93,0xbeb8442a,0xbd9cecf9,0xbe3228d4,0xbe8a11f7,0xbeb9bb1e
.long 0xbda3308c,0xbe354098,0xbe8b9507,0xbebb31a0,0xbda973ba,0xbe3857ec,0xbe8d17c0,0xbebca7af
.long 0xbdafb680,0xbe3b6ecf,0xbe8e9a22,0xbebe1d4a,0xbdb5f8da,0xbe3e853e,0xbe901c2c,0xbebf926f
.long 0xbdbc3ac3,0xbe419b37,0xbe919ddd,0xbec1071e,0xbdc27c39,0xbe44b0b9,0xbe931f35,0xbec27b55
.long 0xbec3ef15,0xbef15aea,0xbf0e39da,0xbf226799,0xbec5625c,0xbef2bd43,0xbf0ee0db,0xbf2302d3
.long 0xbec6d529,0xbef41f07,0xbf0f8784,0xbf239da9,0xbec8477c,0xbef58035,0xbf102dd5,0xbf24381a
.long 0xbec9b953,0xbef6e0cb,0xbf10d3cd,0xbf24d225,0xbecb2aae,0xbef840c8,0xbf11796b,0xbf256bcb
.long 0xbecc9b8b,0xbef9a02d,0xbf121eb0,0xbf26050a,0xbece0bea,0xbefafef7,0xbf12c39a,0xbf269de3
.long 0xbecf7bca,0xbefc5d27,0xbf13682a,0xbf273656,0xbed0eb2a,0xbefdbabb,0xbf140c5f,0xbf27ce61
.long 0xbed25a09,0xbeff17b2,0xbf14b039,0xbf286605,0xbed3c867,0xbf003a06,0xbf1553b7,0xbf28fd41
.long 0xbed53641,0xbf00e7e4,0xbf15f6d9,0xbf299415,0xbed6a399,0xbf019573,0xbf16999f,0xbf2a2a80
.long 0xbed8106b,0xbf0242b1,0xbf173c07,0xbf2ac082,0xbed97cb9,0xbf02ef9f,0xbf17de12,0xbf2b561b
.long 0xbedae880,0xbf039c3d,0xbf187fc0,0xbf2beb4a,0xbedc53c1,0xbf044889,0xbf19210f,0xbf2c800f
.long 0xbeddbe79,0xbf04f484,0xbf19c200,0xbf2d1469,0xbedf28a9,0xbf05a02c,0xbf1a6293,0xbf2da859
.long 0xbee0924f,0xbf064b82,0xbf1b02c6,0xbf2e3bde,0xbee1fb6a,0xbf06f686,0xbf1ba299,0xbf2ecef7
.long 0xbee363fa,0xbf07a136,0xbf1c420c,0xbf2f61a5,0xbee4cbfe,0xbf084b92,0xbf1ce11f,0xbf2ff3e6
.long 0xbee63375,0xbf08f59b,0xbf1d7fd1,0xbf3085bb,0xbee79a5d,0xbf099f4e,0xbf1e1e22,0xbf311722
.long 0xbee900b7,0xbf0a48ad,0xbf1ebc12,0xbf31a81d,0xbeea6681,0xbf0af1b7,0xbf1f599f,0xbf3238aa
.long 0xbeebcbbb,0xbf0b9a6b,0xbf1ff6cb,0xbf32c8c9,0xbeed3063,0xbf0c42c9,0xbf209393,0xbf33587a
.long 0xbeee9479,0xbf0cead0,0xbf212ff9,0xbf33e7bc,0xbeeff7fb,0xbf0d9281,0xbf21cbfb,0xbf34768f
.long 0xbf3504f3,0xbf45e403,0xbf54db31,0xbf61c598,0xbf3592e7,0xbf466354,0xbf554aa4,0xbf62241a
.long 0xbf36206c,0xbf46e22a,0xbf55b993,0xbf628210,0xbf36ad7f,0xbf476085,0xbf5627fe,0xbf62df7b
.long 0xbf373a23,0xbf47de65,0xbf5695e5,0xbf633c5a,0xbf37c655,0xbf485bca,0xbf570348,0xbf6398ac
.long 0xbf385216,0xbf48d8b3,0xbf577026,0xbf63f473,0xbf38dd65,0xbf495521,0xbf57dc7f,0xbf644fac
.long 0xbf396842,0xbf49d112,0xbf584853,0xbf64aa59,0xbf39f2ac,0xbf4a4c87,0xbf58b3a1,0xbf650479
.long 0xbf3a7ca4,0xbf4ac77f,0xbf591e6a,0xbf655e0b,0xbf3b0629,0xbf4b41fa,0xbf5988ad,0xbf65b710
.long 0xbf3b8f3b,0xbf4bbbf8,0xbf59f26a,0xbf660f88,0xbf3c17d9,0xbf4c3578,0xbf5a5ba0,0xbf666771
.long 0xbf3ca003,0xbf4cae79,0xbf5ac450,0xbf66becc,0xbf3d27b8,0xbf4d26fd,0xbf5b2c79,0xbf671599
.long 0xbf3daef9,0xbf4d9f02,0xbf5b941a,0xbf676bd8,0xbf3e35c5,0xbf4e1689,0xbf5bfb34,0xbf67c187
.long 0xbf3ebc1b,0xbf4e8d90,0xbf5c61c7,0xbf6816a8,0xbf3f41fc,0xbf4f0417,0xbf5cc7d1,0xbf686b39
.long 0xbf3fc767,0xbf4f7a1f,0xbf5d2d53,0xbf68bf3c,0xbf404c5c,0xbf4fefa8,0xbf5d924d,0xbf6912ae
.long 0xbf40d0da,0xbf5064af,0xbf5df6be,0xbf696591,0xbf4154e1,0xbf50d937,0xbf5e5aa6,0xbf69b7e4
.long 0xbf41d870,0xbf514d3d,0xbf5ebe05,0xbf6a09a7,0xbf425b89,0xbf51c0c2,0xbf5f20db,0xbf6a5ad9
.long 0xbf42de29,0xbf5233c6,0xbf5f8327,0xbf6aab7b,0xbf436051,0xbf52a649,0xbf5fe4e9,0xbf6afb8c
.long 0xbf43e200,0xbf531849,0xbf604621,0xbf6b4b0c,0xbf446337,0xbf5389c7,0xbf60a6cf,0xbf6b99fb
.long 0xbf44e3f5,0xbf53fac3,0xbf6106f2,0xbf6be858,0xbf456439,0xbf546b3b,0xbf61668a,0xbf6c3624
.long 0xbf6c835e,0xbf74fa0b,0xbf7b14be,0xbf7ec46d,0xbf6cd007,0xbf75341d,0xbf7b3bab,0xbf7ed7d4
.long 0xbf6d1c1d,0xbf756d97,0xbf7b61fc,0xbf7eea9d,0xbf6d67a1,0xbf75a67b,0xbf7b87b2,0xbf7efcc9
.long 0xbf6db293,0xbf75dec6,0xbf7baccd,0xbf7f0e58,0xbf6dfcf2,0xbf76167a,0xbf7bd14d,0xbf7f1f49
.long 0xbf6e46be,0xbf764d97,0xbf7bf531,0xbf7f2f9d,0xbf6e8ff8,0xbf76841b,0xbf7c187a,0xbf7f3f54
.long 0xbf6ed89e,0xbf76ba07,0xbf7c3b28,0xbf7f4e6d,0xbf6f20b0,0xbf76ef5b,0xbf7c5d3a,0xbf7f5ce9
.long 0xbf6f6830,0xbf772417,0xbf7c7eb0,0xbf7f6ac7,0xbf6faf1b,0xbf77583a,0xbf7c9f8a,0xbf7f7808
.long 0xbf6ff573,0xbf778bc5,0xbf7cbfc9,0xbf7f84ab,0xbf703b37,0xbf77beb7,0xbf7cdf6c,0xbf7f90b1
.long 0xbf708066,0xbf77f110,0xbf7cfe73,0xbf7f9c18,0xbf70c501,0xbf7822d1,0xbf7d1cdd,0xbf7fa6e3
.long 0xbf710908,0xbf7853f8,0xbf7d3aac,0xbf7fb10f,0xbf714c7a,0xbf788486,0xbf7d57de,0xbf7fba9e
.long 0xbf718f57,0xbf78b47b,0xbf7d7474,0xbf7fc38f,0xbf71d19f,0xbf78e3d6,0xbf7d906e,0xbf7fcbe2
.long 0xbf721352,0xbf791298,0xbf7dabcc,0xbf7fd397,0xbf725470,0xbf7940c0,0xbf7dc68c,0xbf7fdaaf
.long 0xbf7294f8,0xbf796e4e,0xbf7de0b1,0xbf7fe129,0xbf72d4eb,0xbf799b43,0xbf7dfa38,0xbf7fe705
.long 0xbf731447,0xbf79c79d,0xbf7e1324,0xbf7fec43,0xbf73530e,0xbf79f35e,0xbf7e2b72,0xbf7ff0e3
.long 0xbf73913f,0xbf7a1e84,0xbf7e4323,0xbf7ff4e6,0xbf73ced9,0xbf7a4910,0xbf7e5a38,0xbf7ff84a
.long 0xbf740bdd,0xbf7a7302,0xbf7e70b0,0xbf7ffb11,0xbf74484b,0xbf7a9c59,0xbf7e868b,0xbf7ffd39
.long 0xbf748422,0xbf7ac516,0xbf7e9bc9,0xbf7ffec4,0xbf74bf62,0xbf7aed37,0xbf7eb069,0xbf7fffb1
.long 0x0,0x3dc8bd36,0x3e47c5c2,0x3e94a031,0x3b490fc6,0x3dcefdb7,0x3e4ada4f,0x3e9620d2
.long 0x3bc90f88,0x3dd53db9,0x3e4dee60,0x3e97a117,0x3c16cb58,0x3ddb7d37,0x3e5101f1,0x3e9920fe
.long 0x3c490e90,0x3de1bc2e,0x3e541501,0x3e9aa086,0x3c7b514b,0x3de7fa9a,0x3e57278f,0x3e9c1faf
.long 0x3c96c9b6,0x3dee3876,0x3e5a3997,0x3e9d9e78,0x3cafea69,0x3df475c0,0x3e5d4b1a,0x3e9f1cdf
.long 0x3cc90ab0,0x3dfab273,0x3e605c13,0x3ea09ae5,0x3ce22a7a,0x3e007745,0x3e636c83,0x3ea21887
.long 0x3cfb49ba,0x3e039502,0x3e667c66,0x3ea395c5,0x3d0a342f,0x3e06b26e,0x3e698bba,0x3ea5129f
.long 0x3d16c32c,0x3e09cf86,0x3e6c9a7f,0x3ea68f12,0x3d2351cb,0x3e0cec4a,0x3e6fa8b2,0x3ea80b1f
.long 0x3d2fe007,0x3e1008b7,0x3e72b651,0x3ea986c4,0x3d3c6dd5,0x3e1324ca,0x3e75c35a,0x3eab0201
.long 0x3d48fb30,0x3e164083,0x3e78cfcc,0x3eac7cd4,0x3d55880e,0x3e195be0,0x3e7bdba4,0x3eadf73c
.long 0x3d621469,0x3e1c76de,0x3e7ee6e1,0x3eaf713a,0x3d6ea038,0x3e1f917b,0x3e80f8c0,0x3eb0eacb
.long 0x3d7b2b74,0x3e22abb6,0x3e827dc0,0x3eb263ef,0x3d83db0a,0x3e25c58c,0x3e840270,0x3eb3dca5
.long 0x3d8a200a,0x3e28defc,0x3e8586ce,0x3eb554ec,0x3d9064b4,0x3e2bf804,0x3e870ada,0x3eb6ccc3
.long 0x3d96a905,0x3e2f10a2,0x3e888e93,0x3eb8442a,0x3d9cecf9,0x3e3228d4,0x3e8a11f7,0x3eb9bb1e
.long 0x3da3308c,0x3e354098,0x3e8b9507,0x3ebb31a0,0x3da973ba,0x3e3857ec,0x3e8d17c0,0x3ebca7af
.long 0x3dafb680,0x3e3b6ecf,0x3e8e9a22,0x3ebe1d4a,0x3db5f8da,0x3e3e853e,0x3e901c2c,0x3ebf926f
.long 0x3dbc3ac3,0x3e419b37,0x3e919ddd,0x3ec1071e,0x3dc27c39,0x3e44b0b9,0x3e931f35,0x3ec27b55
.long 0x3ec3ef15,0x3ef15aea,0x3f0e39da,0x3f226799,0x3ec5625c,0x3ef2bd43,0x3f0ee0db,0x3f2302d3
.long 0x3ec6d529,0x3ef41f07,0x3f0f8784,0x3f239da9,0x3ec8477c,0x3ef58035,0x3f102dd5,0x3f24381a
.long 0x3ec9b953,0x3ef6e0cb,0x3f10d3cd,0x3f24d225,0x3ecb2aae,0x3ef840c8,0x3f11796b,0x3f256bcb
.long 0x3ecc9b8b,0x3ef9a02d,0x3f121eb0,0x3f26050a,0x3ece0bea,0x3efafef7,0x3f12c39a,0x3f269de3
.long 0x3ecf7bca,0x3efc5d27,0x3f13682a,0x3f273656,0x3ed0eb2a,0x3efdbabb,0x3f140c5f,0x3f27ce61
.long 0x3ed25a09,0x3eff17b2,0x3f14b039,0x3f286605,0x3ed3c867,0x3f003a06,0x3f1553b7,0x3f28fd41
.long 0x3ed53641,0x3f00e7e4,0x3f15f6d9,0x3f299415,0x3ed6a399,0x3f019573,0x3f16999f,0x3f2a2a80
.long 0x3ed8106b,0x3f0242b1,0x3f173c07,0x3f2ac082,0x3ed97cb9,0x3f02ef9f,0x3f17de12,0x3f2b561b
.long 0x3edae880,0x3f039c3d,0x3f187fc0,0x3f2beb4a,0x3edc53c1,0x3f044889,0x3f19210f,0x3f2c800f
.long 0x3eddbe79,0x3f04f484,0x3f19c200,0x3f2d1469,0x3edf28a9,0x3f05a02c,0x3f1a6293,0x3f2da859
.long 0x3ee0924f,0x3f064b82,0x3f1b02c6,0x3f2e3bde,0x3ee1fb6a,0x3f06f686,0x3f1ba299,0x3f2ecef7
.long 0x3ee363fa,0x3f07a136,0x3f1c420c,0x3f2f61a5,0x3ee4cbfe,0x3f084b92,0x3f1ce11f,0x3f2ff3e6
.long 0x3ee63375,0x3f08f59b,0x3f1d7fd1,0x3f3085bb,0x3ee79a5d,0x3f099f4e,0x3f1e1e22,0x3f311722
.long 0x3ee900b7,0x3f0a48ad,0x3f1ebc12,0x3f31a81d,0x3eea6681,0x3f0af1b7,0x3f1f599f,0x3f3238aa
.long 0x3eebcbbb,0x3f0b9a6b,0x3f1ff6cb,0x3f32c8c9,0x3eed3063,0x3f0c42c9,0x3f209393,0x3f33587a
.long 0x3eee9479,0x3f0cead0,0x3f212ff9,0x3f33e7bc,0x3eeff7fb,0x3f0d9281,0x3f21cbfb,0x3f34768f
.long 0x3f3504f3,0x3f45e403,0x3f54db31,0x3f61c598,0x3f3592e7,0x3f466354,0x3f554aa4,0x3f62241a
.long 0x3f36206c,0x3f46e22a,0x3f55b993,0x3f628210,0x3f36ad7f,0x3f476085,0x3f5627fe,0x3f62df7b
.long 0x3f373a23,0x3f47de65,0x3f5695e5,0x3f633c5a,0x3f37c655,0x3f485bca,0x3f570348,0x3f6398ac
.long 0x3f385216,0x3f48d8b3,0x3f577026,0x3f63f473,0x3f38dd65,0x3f495521,0x3f57dc7f,0x3f644fac
.long 0x3f396842,0x3f49d112,0x3f584853,0x3f64aa59,0x3f39f2ac,0x3f4a4c87,0x3f58b3a1,0x3f650479
.long 0x3f3a7ca4,0x3f4ac77f,0x3f591e6a,0x3f655e0b,0x3f3b0629,0x3f4b41fa,0x3f5988ad,0x3f65b710
.long 0x3f3b8f3b,0x3f4bbbf8,0x3f59f26a,0x3f660f88,0x3f3c17d9,0x3f4c3578,0x3f5a5ba0,0x3f666771
.long 0x3f3ca003,0x3f4cae79,0x3f5ac450,0x3f66becc,0x3f3d27b8,0x3f4d26fd,0x3f5b2c79,0x3f671599
.long 0x3f3daef9,0x3f4d9f02,0x3f5b941a,0x3f676bd8,0x3f3e35c5,0x3f4e1689,0x3f5bfb34,0x3f67c187
.long 0x3f3ebc1b,0x3f4e8d90,0x3f5c61c7,0x3f6816a8,0x3f3f41fc,0x3f4f0417,0x3f5cc7d1,0x3f686b39
.long 0x3f3fc767,0x3f4f7a1f,0x3f5d2d53,0x3f68bf3c,0x3f404c5c,0x3f4fefa8,0x3f5d924d,0x3f6912ae
.long 0x3f40d0da,0x3f5064af,0x3f5df6be,0x3f696591,0x3f4154e1,0x3f50d937,0x3f5e5aa6,0x3f69b7e4
.long 0x3f41d870,0x3f514d3d,0x3f5ebe05,0x3f6a09a7,0x3f425b89,0x3f51c0c2,0x3f5f20db,0x3f6a5ad9
.long 0x3f42de29,0x3f5233c6,0x3f5f8327,0x3f6aab7b,0x3f436051,0x3f52a649,0x3f5fe4e9,0x3f6afb8c
.long 0x3f43e200,0x3f531849,0x3f604621,0x3f6b4b0c,0x3f446337,0x3f5389c7,0x3f60a6cf,0x3f6b99fb
.long 0x3f44e3f5,0x3f53fac3,0x3f6106f2,0x3f6be858,0x3f456439,0x3f546b3b,0x3f61668a,0x3f6c3624
.long 0x3f6c835e,0x3f74fa0b,0x3f7b14be,0x3f7ec46d,0x3f6cd007,0x3f75341d,0x3f7b3bab,0x3f7ed7d4
.long 0x3f6d1c1d,0x3f756d97,0x3f7b61fc,0x3f7eea9d,0x3f6d67a1,0x3f75a67b,0x3f7b87b2,0x3f7efcc9
.long 0x3f6db293,0x3f75dec6,0x3f7baccd,0x3f7f0e58,0x3f6dfcf2,0x3f76167a,0x3f7bd14d,0x3f7f1f49
.long 0x3f6e46be,0x3f764d97,0x3f7bf531,0x3f7f2f9d,0x3f6e8ff8,0x3f76841b,0x3f7c187a,0x3f7f3f54
.long 0x3f6ed89e,0x3f76ba07,0x3f7c3b28,0x3f7f4e6d,0x3f6f20b0,0x3f76ef5b,0x3f7c5d3a,0x3f7f5ce9
.long 0x3f6f6830,0x3f772417,0x3f7c7eb0,0x3f7f6ac7,0x3f6faf1b,0x3f77583a,0x3f7c9f8a,0x3f7f7808
.long 0x3f6ff573,0x3f778bc5,0x3f7cbfc9,0x3f7f84ab,0x3f703b37,0x3f77beb7,0x3f7cdf6c,0x3f7f90b1
.long 0x3f708066,0x3f77f110,0x3f7cfe73,0x3f7f9c18,0x3f70c501,0x3f7822d1,0x3f7d1cdd,0x3f7fa6e3
.long 0x3f710908,0x3f7853f8,0x3f7d3aac,0x3f7fb10f,0x3f714c7a,0x3f788486,0x3f7d57de,0x3f7fba9e
.long 0x3f718f57,0x3f78b47b,0x3f7d7474,0x3f7fc38f,0x3f71d19f,0x3f78e3d6,0x3f7d906e,0x3f7fcbe2
.long 0x3f721352,0x3f791298,0x3f7dabcc,0x3f7fd397,0x3f725470,0x3f7940c0,0x3f7dc68c,0x3f7fdaaf
.long 0x3f7294f8,0x3f796e4e,0x3f7de0b1,0x3f7fe129,0x3f72d4eb,0x3f799b43,0x3f7dfa38,0x3f7fe705
.long 0x3f731447,0x3f79c79d,0x3f7e1324,0x3f7fec43,0x3f73530e,0x3f79f35e,0x3f7e2b72,0x3f7ff0e3
.long 0x3f73913f,0x3f7a1e84,0x3f7e4323,0x3f7ff4e6,0x3f73ced9,0x3f7a4910,0x3f7e5a38,0x3f7ff84a
.long 0x3f740bdd,0x3f7a7302,0x3f7e70b0,0x3f7ffb11,0x3f74484b,0x3f7a9c59,0x3f7e868b,0x3f7ffd39
.long 0x3f748422,0x3f7ac516,0x3f7e9bc9,0x3f7ffec4,0x3f74bf62,0x3f7aed37,0x3f7eb069,0x3f7fffb1
.long 0x3f800000,0x3f7ec46d,0x3f7b14be,0x3f74fa0b,0x3f7fffb1,0x3f7eb069,0x3f7aed37,0x3f74bf62
.long 0x3f7ffec4,0x3f7e9bc9,0x3f7ac516,0x3f748422,0x3f7ffd39,0x3f7e868b,0x3f7a9c59,0x3f74484b
.long 0x3f7ffb11,0x3f7e70b0,0x3f7a7302,0x3f740bdd,0x3f7ff84a,0x3f7e5a38,0x3f7a4910,0x3f73ced9
.long 0x3f7ff4e6,0x3f7e4323,0x3f7a1e84,0x3f73913f,0x3f7ff0e3,0x3f7e2b72,0x3f79f35e,0x3f73530e
.long 0x3f7fec43,0x3f7e1324,0x3f79c79d,0x3f731447,0x3f7fe705,0x3f7dfa38,0x3f799b43,0x3f72d4eb
.long 0x3f7fe129,0x3f7de0b1,0x3f796e4e,0x3f7294f8,0x3f7fdaaf,0x3f7dc68c,0x3f7940c0,0x3f725470
.long 0x3f7fd397,0x3f7dabcc,0x3f791298,0x3f721352,0x3f7fcbe2,0x3f7d906e,0x3f78e3d6,0x3f71d19f
.long 0x3f7fc38f,0x3f7d7474,0x3f78b47b,0x3f718f57,0x3f7fba9e,0x3f7d57de,0x3f788486,0x3f714c7a
.long 0x3f7fb10f,0x3f7d3aac,0x3f7853f8,0x3f710908,0x3f7fa6e3,0x3f7d1cdd,0x3f7822d1,0x3f70c501
.long 0x3f7f9c18,0x3f7cfe73,0x3f77f110,0x3f708066,0x3f7f90b1,0x3f7cdf6c,0x3f77beb7,0x3f703b37
.long 0x3f7f84ab,0x3f7cbfc9,0x3f778bc5,0x3f6ff573,0x3f7f7808,0x3f7c9f8a,0x3f77583a,0x3f6faf1b
.long 0x3f7f6ac7,0x3f7c7eb0,0x3f772417,0x3f6f6830,0x3f7f5ce9,0x3f7c5d3a,0x3f76ef5b,0x3f6f20b0
.long 0x3f7f4e6d,0x3f7c3b28,0x3f76ba07,0x3f6ed89e,0x3f7f3f54,0x3f7c187a,0x3f76841b,0x3f6e8ff8
.long 0x3f7f2f9d,0x3f7bf531,0x3f764d97,0x3f6e46be,0x3f7f1f49,0x3f7bd14d,0x3f76167a,0x3f6dfcf2
.long 0x3f7f0e58,0x3f7baccd,0x3f75dec6,0x3f6db293,0x3f7efcc9,0x3f7b87b2,0x3f75a67b,0x3f6d67a1
.long 0x3f7eea9d,0x3f7b61fc,0x3f756d97,0x3f6d1c1d,0x3f7ed7d4,0x3f7b3bab,0x3f75341d,0x3f6cd007
.long 0x3f6c835e,0x3f61c598,0x3f54db31,0x3f45e403,0x3f6c3624,0x3f61668a,0x3f546b3b,0x3f456439
.long 0x3f6be858,0x3f6106f2,0x3f53fac3,0x3f44e3f5,0x3f6b99fb,0x3f60a6cf,0x3f5389c7,0x3f446337
.long 0x3f6b4b0c,0x3f604621,0x3f531849,0x3f43e200,0x3f6afb8c,0x3f5fe4e9,0x3f52a649,0x3f436051
.long 0x3f6aab7b,0x3f5f8327,0x3f5233c6,0x3f42de29,0x3f6a5ad9,0x3f5f20db,0x3f51c0c2,0x3f425b89
.long 0x3f6a09a7,0x3f5ebe05,0x3f514d3d,0x3f41d870,0x3f69b7e4,0x3f5e5aa6,0x3f50d937,0x3f4154e1
.long 0x3f696591,0x3f5df6be,0x3f5064af,0x3f40d0da,0x3f6912ae,0x3f5d924d,0x3f4fefa8,0x3f404c5c
.long 0x3f68bf3c,0x3f5d2d53,0x3f4f7a1f,0x3f3fc767,0x3f686b39,0x3f5cc7d1,0x3f4f0417,0x3f3f41fc
.long 0x3f6816a8,0x3f5c61c7,0x3f4e8d90,0x3f3ebc1b,0x3f67c187,0x3f5bfb34,0x3f4e1689,0x3f3e35c5
.long 0x3f676bd8,0x3f5b941a,0x3f4d9f02,0x3f3daef9,0x3f671599,0x3f5b2c79,0x3f4d26fd,0x3f3d27b8
.long 0x3f66becc,0x3f5ac450,0x3f4cae79,0x3f3ca003,0x3f666771,0x3f5a5ba0,0x3f4c3578,0x3f3c17d9
.long 0x3f660f88,0x3f59f26a,0x3f4bbbf8,0x3f3b8f3b,0x3f65b710,0x3f5988ad,0x3f4b41fa,0x3f3b0629
.long 0x3f655e0b,0x3f591e6a,0x3f4ac77f,0x3f3a7ca4,0x3f650479,0x3f58b3a1,0x3f4a4c87,0x3f39f2ac
.long 0x3f64aa59,0x3f584853,0x3f49d112,0x3f396842,0x3f644fac,0x3f57dc7f,0x3f495521,0x3f38dd65
.long 0x3f63f473,0x3f577026,0x3f48d8b3,0x3f385216,0x3f6398ac,0x3f570348,0x3f485bca,0x3f37c655
.long 0x3f633c5a,0x3f5695e5,0x3f47de65,0x3f373a23,0x3f62df7b,0x3f5627fe,0x3f476085,0x3f36ad7f
.long 0x3f628210,0x3f55b993,0x3f46e22a,0x3f36206c,0x3f62241a,0x3f554aa4,0x3f466354,0x3f3592e7
.long 0x3f3504f3,0x3f226799,0x3f0e39da,0x3ef15aea,0x3f34768f,0x3f21cbfb,0x3f0d9281,0x3eeff7fb
.long 0x3f33e7bc,0x3f212ff9,0x3f0cead0,0x3eee9479,0x3f33587a,0x3f209393,0x3f0c42c9,0x3eed3063
.long 0x3f32c8c9,0x3f1ff6cb,0x3f0b9a6b,0x3eebcbbb,0x3f3238aa,0x3f1f599f,0x3f0af1b7,0x3eea6681
.long 0x3f31a81d,0x3f1ebc12,0x3f0a48ad,0x3ee900b7,0x3f311722,0x3f1e1e22,0x3f099f4e,0x3ee79a5d
.long 0x3f3085bb,0x3f1d7fd1,0x3f08f59b,0x3ee63375,0x3f2ff3e6,0x3f1ce11f,0x3f084b92,0x3ee4cbfe
.long 0x3f2f61a5,0x3f1c420c,0x3f07a136,0x3ee363fa,0x3f2ecef7,0x3f1ba299,0x3f06f686,0x3ee1fb6a
.long 0x3f2e3bde,0x3f1b02c6,0x3f064b82,0x3ee0924f,0x3f2da859,0x3f1a6293,0x3f05a02c,0x3edf28a9
.long 0x3f2d1469,0x3f19c200,0x3f04f484,0x3eddbe79,0x3f2c800f,0x3f19210f,0x3f044889,0x3edc53c1
.long 0x3f2beb4a,0x3f187fc0,0x3f039c3d,0x3edae880,0x3f2b561b,0x3f17de12,0x3f02ef9f,0x3ed97cb9
.long 0x3f2ac082,0x3f173c07,0x3f0242b1,0x3ed8106b,0x3f2a2a80,0x3f16999f,0x3f019573,0x3ed6a399
.long 0x3f299415,0x3f15f6d9,0x3f00e7e4,0x3ed53641,0x3f28fd41,0x3f1553b7,0x3f003a06,0x3ed3c867
.long 0x3f286605,0x3f14b039,0x3eff17b2,0x3ed25a09,0x3f27ce61,0x3f140c5f,0x3efdbabb,0x3ed0eb2a
.long 0x3f273656,0x3f13682a,0x3efc5d27,0x3ecf7bca,0x3f269de3,0x3f12c39a,0x3efafef7,0x3ece0bea
.long 0x3f26050a,0x3f121eb0,0x3ef9a02d,0x3ecc9b8b,0x3f256bcb,0x3f11796b,0x3ef840c8,0x3ecb2aae
.long 0x3f24d225,0x3f10d3cd,0x3ef6e0cb,0x3ec9b953,0x3f24381a,0x3f102dd5,0x3ef58035,0x3ec8477c
.long 0x3f239da9,0x3f0f8784,0x3ef41f07,0x3ec6d529,0x3f2302d3,0x3f0ee0db,0x3ef2bd43,0x3ec5625c
.long 0x3ec3ef15,0x3e94a031,0x3e47c5c2,0x3dc8bd36,0x3ec27b55,0x3e931f35,0x3e44b0b9,0x3dc27c39
.long 0x3ec1071e,0x3e919ddd,0x3e419b37,0x3dbc3ac3,0x3ebf926f,0x3e901c2c,0x3e3e853e,0x3db5f8da
.long 0x3ebe1d4a,0x3e8e9a22,0x3e3b6ecf,0x3dafb680,0x3ebca7af,0x3e8d17c0,0x3e3857ec,0x3da973ba
.long 0x3ebb31a0,0x3e8b9507,0x3e354098,0x3da3308c,0x3eb9bb1e,0x3e8a11f7,0x3e3228d4,0x3d9cecf9
.long 0x3eb8442a,0x3e888e93,0x3e2f10a2,0x3d96a905,0x3eb6ccc3,0x3e870ada,0x3e2bf804,0x3d9064b4
.long 0x3eb554ec,0x3e8586ce,0x3e28defc,0x3d8a200a,0x3eb3dca5,0x3e840270,0x3e25c58c,0x3d83db0a
.long 0x3eb263ef,0x3e827dc0,0x3e22abb6,0x3d7b2b74,0x3eb0eacb,0x3e80f8c0,0x3e1f917b,0x3d6ea038
.long 0x3eaf713a,0x3e7ee6e1,0x3e1c76de,0x3d621469,0x3eadf73c,0x3e7bdba4,0x3e195be0,0x3d55880e
.long 0x3eac7cd4,0x3e78cfcc,0x3e164083,0x3d48fb30,0x3eab0201,0x3e75c35a,0x3e1324ca,0x3d3c6dd5
.long 0x3ea986c4,0x3e72b651,0x3e1008b7,0x3d2fe007,0x3ea80b1f,0x3e6fa8b2,0x3e0cec4a,0x3d2351cb
.long 0x3ea68f12,0x3e6c9a7f,0x3e09cf86,0x3d16c32c,0x3ea5129f,0x3e698bba,0x3e06b26e,0x3d0a342f
.long 0x3ea395c5,0x3e667c66,0x3e039502,0x3cfb49ba,0x3ea21887,0x3e636c83,0x3e007745,0x3ce22a7a
.long 0x3ea09ae5,0x3e605c13,0x3dfab273,0x3cc90ab0,0x3e9f1cdf,0x3e5d4b1a,0x3df475c0,0x3cafea69
.long 0x3e9d9e78,0x3e5a3997,0x3dee3876,0x3c96c9b6,0x3e9c1faf,0x3e57278f,0x3de7fa9a,0x3c7b514b
.long 0x3e9aa086,0x3e541501,0x3de1bc2e,0x3c490e90,0x3e9920fe,0x3e5101f1,0x3ddb7d37,0x3c16cb58
.long 0x3e97a117,0x3e4dee60,0x3dd53db9,0x3bc90f88,0x3e9620d2,0x3e4ada4f,0x3dcefdb7,0x3b490fc6
.long 0x35803580,0x35803580,0x0,0x0,0x357b3580,0x3555356d,0x34480000,0x350e34c4
.long 0x356d3580,0x34c43535,0x34c40000,0x356d3535,0x35553580,0xb44834c4,0x350e0000,0x357b356d
.long 0x35353580,0xb5350000,0x35350000,0x35353580,0x350e3580,0xb57bb4c4,0x35550000,0x3448356d
.long 0x34c43580,0xb56db535,0x356d0000,0xb4c43535,0x34483580,0xb50eb56d,0x357b0000,0xb55534c4
.long 0x3580,0xb580,0x35800000,0xb5800000,0xb4483580,0x350eb56d,0x357b0000,0xb555b4c4
.long 0xb4c43580,0x356db535,0x356d0000,0xb4c4b535,0xb50e3580,0x357bb4c4,0x35550000,0x3448b56d
.long 0xb5353580,0x35350000,0x35350000,0x3535b580,0xb5553580,0x344834c4,0x350e0000,0x357bb56d
.long 0xb56d3580,0xb4c43535,0x34c40000,0x356db535,0xb57b3580,0xb555356d,0x34480000,0x350eb4c4
.long 0xb5803580,0xb5803580,0x0,0x0,0xb57b3580,0xb555356d,0xb4480000,0xb50e34c4
.long 0xb56d3580,0xb4c43535,0xb4c40000,0xb56d3535,0xb5553580,0x344834c4,0xb50e0000,0xb57b356d
.long 0xb5353580,0x35350000,0xb5350000,0xb5353580,0xb50e3580,0x357bb4c4,0xb5550000,0xb448356d
.long 0xb4c43580,0x356db535,0xb56d0000,0x34c43535,0xb4483580,0x350eb56d,0xb57b0000,0x355534c4
.long 0x3580,0xb580,0xb5800000,0x35800000,0x34483580,0xb50eb56d,0xb57b0000,0x3555b4c4
.long 0x34c43580,0xb56db535,0xb56d0000,0x34c4b535,0x350e3580,0xb57bb4c4,0xb5550000,0xb448b56d
.long 0x35353580,0xb5350000,0xb5350000,0xb535b580,0x35553580,0xb44834c4,0xb50e0000,0xb57bb56d
.long 0x356d3580,0x34c43535,0xb4c40000,0xb56db535,0x357b3580,0x3555356d,0xb4480000,0xb50eb4c4
.long 0x35803580,0x35803580,0x0,0x0,0x350e3535,0x344834c4,0x35553535,0x357b356d
.long 0xb4c40000,0xb56db535,0x356d3580,0x34c43535,0xb57bb535,0xb50eb56d,0x34483535,0xb555b4c4
.long 0xb535b580,0x35350000,0xb5350000,0xb535b580,0x3448b535,0x3555356d,0xb57bb535,0x350eb4c4
.long 0x356d0000,0xb4c43535,0xb4c4b580,0x356d3535,0x35553535,0xb57bb4c4,0x350eb535,0xb448356d
.long 0x3580,0xb580,0x35800000,0xb5800000,0xb5553535,0x357bb4c4,0x350e3535,0xb448b56d
.long 0xb56d0000,0x34c43535,0xb4c43580,0x356db535,0xb448b535,0xb555356d,0xb57b3535,0x350e34c4
.long 0x3535b580,0xb5350000,0xb5350000,0xb5353580,0x357bb535,0x350eb56d,0x3448b535,0xb55534c4
.long 0x34c40000,0x356db535,0x356db580,0x34c4b535,0xb50e3535,0xb44834c4,0x3555b535,0x357bb56d
.long 0xb5803580,0xb5803580,0x0,0x0,0xb50e3535,0xb44834c4,0xb5553535,0xb57b356d
.long 0x34c40000,0x356db535,0xb56d3580,0xb4c43535,0x357bb535,0x350eb56d,0xb4483535,0x3555b4c4
.long 0x3535b580,0xb5350000,0x35350000,0x3535b580,0xb448b535,0xb555356d,0x357bb535,0xb50eb4c4
.long 0xb56d0000,0x34c43535,0x34c4b580,0xb56d3535,0xb5553535,0x357bb4c4,0xb50eb535,0x3448356d
.long 0x3580,0xb580,0xb5800000,0x35800000,0x35553535,0xb57bb4c4,0xb50e3535,0x3448b56d
.long 0x356d0000,0xb4c43535,0x34c43580,0xb56db535,0x3448b535,0x3555356d,0x357b3535,0xb50e34c4
.long 0xb535b580,0x35350000,0x35350000,0x35353580,0xb57bb535,0xb50eb56d,0xb448b535,0x355534c4
.long 0xb4c40000,0xb56db535,0xb56db580,0xb4c4b535,0x350e3535,0x344834c4,0xb555b535,0xb57bb56d
.long 0x35803580,0x35803580,0x0,0x0,0xb4480000,0xb50eb4c4,0x357b3580,0x3555356d
.long 0xb56db580,0xb4c4b535,0xb4c40000,0xb56db535,0x350e0000,0x357b356d,0xb555b580,0x3448b4c4
.long 0x35353580,0xb5350000,0x35350000,0x35353580,0xb5550000,0xb448b56d,0x350e3580,0xb57bb4c4
.long 0xb4c4b580,0x356d3535,0xb56d0000,0x34c4b535,0x357b0000,0xb55534c4,0xb448b580,0x350e356d
.long 0x3580,0xb580,0x35800000,0xb5800000,0xb57b0000,0x355534c4,0xb4483580,0x350eb56d
.long 0x34c4b580,0xb56d3535,0xb56d0000,0x34c43535,0x35550000,0x3448b56d,0x350eb580,0xb57b34c4
.long 0xb5353580,0x35350000,0x35350000,0x3535b580,0xb50e0000,0xb57b356d,0xb5553580,0x344834c4
.long 0x356db580,0x34c4b535,0xb4c40000,0xb56d3535,0x34480000,0x350eb4c4,0x357bb580,0x3555b56d
.long 0xb5803580,0xb5803580,0x0,0x0,0x34480000,0x350eb4c4,0xb57b3580,0xb555356d
.long 0x356db580,0x34c4b535,0x34c40000,0x356db535,0xb50e0000,0xb57b356d,0x3555b580,0xb448b4c4
.long 0xb5353580,0x35350000,0xb5350000,0xb5353580,0x35550000,0x3448b56d,0xb50e3580,0x357bb4c4
.long 0x34c4b580,0xb56d3535,0x356d0000,0xb4c4b535,0xb57b0000,0x355534c4,0x3448b580,0xb50e356d
.long 0x3580,0xb580,0xb5800000,0x35800000,0x357b0000,0xb55534c4,0x34483580,0xb50eb56d
.long 0xb4c4b580,0x356d3535,0x356d0000,0xb4c43535,0xb5550000,0xb448b56d,0xb50eb580,0x357b34c4
.long 0x35353580,0xb5350000,0xb5350000,0xb535b580,0x350e0000,0x357b356d,0x35553580,0xb44834c4
.long 0xb56db580,0xb4c4b535,0x34c40000,0x356d3535,0xb4480000,0xb50eb4c4,0xb57bb580,0xb555b56d
.long 0x35803580,0x35803580,0x0,0x0,0xb555b535,0xb57bb56d,0x350e3535,0x344834c4
.long 0x34c40000,0x356d3535,0xb56db580,0xb4c4b535,0x34483535,0xb555b4c4,0x357b3535,0x350e356d
.long 0xb535b580,0x35350000,0xb5350000,0xb535b580,0x357b3535,0xb50e34c4,0x3448b535,0x3555356d
.long 0xb56d0000,0x34c4b535,0x34c43580,0xb56db535,0x350eb535,0xb448356d,0xb555b535,0x357b34c4
.long 0x3580,0xb580,0x35800000,0xb5800000,0xb50eb535,0x3448356d,0xb5553535,0x357bb4c4
.long 0x356d0000,0xb4c4b535,0x34c4b580,0xb56d3535,0xb57b3535,0x350e34c4,0x34483535,0x3555b56d
.long 0x3535b580,0xb5350000,0xb5350000,0xb5353580,0xb4483535,0x3555b4c4,0x357bb535,0x350eb56d
.long 0xb4c40000,0xb56d3535,0xb56d3580,0xb4c43535,0x3555b535,0x357bb56d,0x350eb535,0x3448b4c4
.long 0xb5803580,0xb5803580,0x0,0x0,0x3555b535,0x357bb56d,0xb50e3535,0xb44834c4
.long 0xb4c40000,0xb56d3535,0x356db580,0x34c4b535,0xb4483535,0x3555b4c4,0xb57b3535,0xb50e356d
.long 0x3535b580,0xb5350000,0x35350000,0x3535b580,0xb57b3535,0x350e34c4,0xb448b535,0xb555356d
.long 0x356d0000,0xb4c4b535,0xb4c43580,0x356db535,0xb50eb535,0x3448356d,0x3555b535,0xb57b34c4
.long 0x3580,0xb580,0xb5800000,0x35800000,0x350eb535,0xb448356d,0x35553535,0xb57bb4c4
.long 0xb56d0000,0x34c4b535,0xb4c4b580,0x356d3535,0x357b3535,0xb50e34c4,0xb4483535,0xb555b56d
.long 0xb535b580,0x35350000,0x35350000,0x35353580,0x34483535,0xb555b4c4,0xb57bb535,0xb50eb56d
.long 0x34c40000,0x356d3535,0x356d3580,0x34c43535,0xb555b535,0xb57bb56d,0xb50eb535,0xb448b4c4
.long 0x35803580,0x35803580,0x0,0x0,0xb57bb580,0xb555b56d,0xb4480000,0xb50eb4c4
.long 0x356d3580,0x34c43535,0x34c40000,0x356d3535,0xb555b580,0x3448b4c4,0xb50e0000,0xb57bb56d
.long 0x35353580,0xb5350000,0x35350000,0x35353580,0xb50eb580,0x357b34c4,0xb5550000,0xb448b56d
.long 0x34c43580,0xb56db535,0x356d0000,0xb4c43535,0xb448b580,0x350e356d,0xb57b0000,0x3555b4c4
.long 0x3580,0xb580,0x35800000,0xb5800000,0x3448b580,0xb50e356d,0xb57b0000,0x355534c4
.long 0xb4c43580,0x356db535,0x356d0000,0xb4c4b535,0x350eb580,0xb57b34c4,0xb5550000,0xb448356d
.long 0xb5353580,0x35350000,0x35350000,0x3535b580,0x3555b580,0xb448b4c4,0xb50e0000,0xb57b356d
.long 0xb56d3580,0xb4c43535,0x34c40000,0x356db535,0x357bb580,0x3555b56d,0xb4480000,0xb50e34c4
.long 0xb5803580,0xb5803580,0x0,0x0,0x357bb580,0x3555b56d,0x34480000,0x350eb4c4
.long 0xb56d3580,0xb4c43535,0xb4c40000,0xb56d3535,0x3555b580,0xb448b4c4,0x350e0000,0x357bb56d
.long 0xb5353580,0x35350000,0xb5350000,0xb5353580,0x350eb580,0xb57b34c4,0x35550000,0x3448b56d
.long 0xb4c43580,0x356db535,0xb56d0000,0x34c43535,0x3448b580,0xb50e356d,0x357b0000,0xb555b4c4
.long 0x3580,0xb580,0xb5800000,0x35800000,0xb448b580,0x350e356d,0x357b0000,0xb55534c4
.long 0x34c43580,0xb56db535,0xb56d0000,0x34c4b535,0xb50eb580,0x357b34c4,0x35550000,0x3448356d
.long 0x35353580,0xb5350000,0xb5350000,0xb535b580,0xb555b580,0x3448b4c4,0x350e0000,0x357b356d
.long 0x356d3580,0x34c43535,0xb4c40000,0xb56db535,0xb57bb580,0xb555b56d,0x34480000,0x350e34c4
.long 0x35803580,0x35803580,0x0,0x0,0xb50eb535,0xb448b4c4,0xb555b535,0xb57bb56d
.long 0xb4c40000,0xb56db535,0x356d3580,0x34c43535,0x357b3535,0x350e356d,0xb448b535,0x355534c4
.long 0xb535b580,0x35350000,0xb5350000,0xb535b580,0xb4483535,0xb555b56d,0x357b3535,0xb50e34c4
.long 0x356d0000,0xb4c43535,0xb4c4b580,0x356d3535,0xb555b535,0x357b34c4,0xb50e3535,0x3448b56d
.long 0x3580,0xb580,0x35800000,0xb5800000,0x3555b535,0xb57b34c4,0xb50eb535,0x3448356d
.long 0xb56d0000,0x34c43535,0xb4c43580,0x356db535,0x34483535,0x3555b56d,0x357bb535,0xb50eb4c4
.long 0x3535b580,0xb5350000,0xb5350000,0xb5353580,0xb57b3535,0xb50e356d,0xb4483535,0x3555b4c4
.long 0x34c40000,0x356db535,0x356db580,0x34c4b535,0x350eb535,0x3448b4c4,0xb5553535,0xb57b356d
.long 0xb5803580,0xb5803580,0x0,0x0,0x350eb535,0x3448b4c4,0x3555b535,0x357bb56d
.long 0x34c40000,0x356db535,0xb56d3580,0xb4c43535,0xb57b3535,0xb50e356d,0x3448b535,0xb55534c4
.long 0x3535b580,0xb5350000,0x35350000,0x3535b580,0x34483535,0x3555b56d,0xb57b3535,0x350e34c4
.long 0xb56d0000,0x34c43535,0x34c4b580,0xb56d3535,0x3555b535,0xb57b34c4,0x350e3535,0xb448b56d
.long 0x3580,0xb580,0xb5800000,0x35800000,0xb555b535,0x357b34c4,0x350eb535,0xb448356d
.long 0x356d0000,0xb4c43535,0x34c43580,0xb56db535,0xb4483535,0xb555b56d,0xb57bb535,0x350eb4c4
.long 0xb535b580,0x35350000,0x35350000,0x35353580,0x357b3535,0x350e356d,0x34483535,0xb555b4c4
.long 0xb4c40000,0xb56db535,0xb56db580,0xb4c4b535,0xb50eb535,0xb448b4c4,0x35553535,0x357b356d
.long 0x35803580,0x35803580,0x0,0x0,0x34480000,0x350e34c4,0xb57bb580,0xb555b56d
.long 0xb56db580,0xb4c4b535,0xb4c40000,0xb56db535,0xb50e0000,0xb57bb56d,0x35553580,0xb44834c4
.long 0x35353580,0xb5350000,0x35350000,0x35353580,0x35550000,0x3448356d,0xb50eb580,0x357b34c4
.long 0xb4c4b580,0x356d3535,0xb56d0000,0x34c4b535,0xb57b0000,0x3555b4c4,0x34483580,0xb50eb56d
.long 0x3580,0xb580,0x35800000,0xb5800000,0x357b0000,0xb555b4c4,0x3448b580,0xb50e356d
.long 0x34c4b580,0xb56d3535,0xb56d0000,0x34c43535,0xb5550000,0xb448356d,0xb50e3580,0x357bb4c4
.long 0xb5353580,0x35350000,0x35350000,0x3535b580,0x350e0000,0x357bb56d,0x3555b580,0xb448b4c4
.long 0x356db580,0x34c4b535,0xb4c40000,0xb56d3535,0xb4480000,0xb50e34c4,0xb57b3580,0xb555356d
.long 0xb5803580,0xb5803580,0x0,0x0,0xb4480000,0xb50e34c4,0x357bb580,0x3555b56d
.long 0x356db580,0x34c4b535,0x34c40000,0x356db535,0x350e0000,0x357bb56d,0xb5553580,0x344834c4
.long 0xb5353580,0x35350000,0xb5350000,0xb5353580,0xb5550000,0xb448356d,0x350eb580,0xb57b34c4
.long 0x34c4b580,0xb56d3535,0x356d0000,0xb4c4b535,0x357b0000,0xb555b4c4,0xb4483580,0x350eb56d
.long 0x3580,0xb580,0xb5800000,0x35800000,0xb57b0000,0x3555b4c4,0xb448b580,0x350e356d
.long 0xb4c4b580,0x356d3535,0x356d0000,0xb4c43535,0x35550000,0x3448356d,0x350e3580,0xb57bb4c4
.long 0x35353580,0xb5350000,0xb5350000,0xb535b580,0xb50e0000,0xb57bb56d,0xb555b580,0x3448b4c4
.long 0xb56db580,0xb4c4b535,0x34c40000,0x356d3535,0x34480000,0x350e34c4,0x357b3580,0x3555356d
.long 0x35803580,0x35803580,0x0,0x0,0x35553535,0x357b356d,0xb50eb535,0xb448b4c4
.long 0x34c40000,0x356d3535,0xb56db580,0xb4c4b535,0xb448b535,0x355534c4,0xb57bb535,0xb50eb56d
.long 0xb535b580,0x35350000,0xb5350000,0xb535b580,0xb57bb535,0x350eb4c4,0xb4483535,0xb555b56d
.long 0xb56d0000,0x34c4b535,0x34c43580,0xb56db535,0xb50e3535,0x3448b56d,0x35553535,0xb57bb4c4
.long 0x3580,0xb580,0x35800000,0xb5800000,0x350e3535,0xb448b56d,0x3555b535,0xb57b34c4
.long 0x356d0000,0xb4c4b535,0x34c4b580,0xb56d3535,0x357bb535,0xb50eb4c4,0xb448b535,0xb555356d
.long 0x3535b580,0xb5350000,0xb5350000,0xb5353580,0x3448b535,0xb55534c4,0xb57b3535,0xb50e356d
.long 0xb4c40000,0xb56d3535,0xb56d3580,0xb4c43535,0xb5553535,0xb57b356d,0xb50e3535,0xb44834c4
.long 0xb5803580,0xb5803580,0x0,0x0,0xb5553535,0xb57b356d,0x350eb535,0x3448b4c4
.long 0xb4c40000,0xb56d3535,0x356db580,0x34c4b535,0x3448b535,0xb55534c4,0x357bb535,0x350eb56d
.long 0x3535b580,0xb5350000,0x35350000,0x3535b580,0x357bb535,0xb50eb4c4,0x34483535,0x3555b56d
.long 0x356d0000,0xb4c4b535,0xb4c43580,0x356db535,0x350e3535,0xb448b56d,0xb5553535,0x357bb4c4
.long 0x3580,0xb580,0xb5800000,0x35800000,0xb50e3535,0x3448b56d,0xb555b535,0x357b34c4
.long 0xb56d0000,0x34c4b535,0xb4c4b580,0x356d3535,0xb57bb535,0x350eb4c4,0x3448b535,0x3555356d
.long 0xb535b580,0x35350000,0x35350000,0x35353580,0xb448b535,0x355534c4,0x357b3535,0x350e356d
.long 0x34c40000,0x356d3535,0x356d3580,0x34c43535,0x35553535,0x357b356d,0x350e3535,0x344834c4
.size fft_tables, 36864
.section .rodata,"a"
.p2align 6
.amdhsa_kernel parallel_sum__spectral_gfnet__mixer_token_mlp__prompt_kernel
  .amdhsa_next_free_vgpr 256
  .amdhsa_next_free_sgpr 102
  .amdhsa_accum_offset 256
  .amdhsa_group_segment_fixed_size 0
  .amdhsa_kernarg_size 88
  .amdhsa_user_sgpr_count 2
  .amdhsa_user_sgpr_kernarg_segment_ptr 1
  .amdhsa_system_sgpr_workgroup_id_x 1
.end_amdhsa_kernel
```
